```python
import torch

def _softmax(x, axis=-1):
    return torch.softmax(x, dim=axis)
def _gelu(x):
    return torch.nn.functional.gelu(x, approximate="tanh")
def _silu(x):
    return torch.nn.functional.silu(x)
def _sigmoid(x):
    return torch.sigmoid(x)
def _layernorm(x, axis=-1, eps=1e-5):
    m = x.mean(dim=axis, keepdim=True)
    v = x.var(dim=axis, keepdim=True, unbiased=False)
    return (x - m) / torch.sqrt(v + eps)
def _scatter_add(tgt, idx, src, axis=0):
    return tgt.clone().index_add_(axis, idx, src)
def _segment_sum(src, seg, n):
    out = torch.zeros((n,) + src.shape[1:], dtype=src.dtype)
    return out.index_add_(0, seg, src)
def _pad(x, pw):
    flat = tuple(v for pair in reversed(pw) for v in pair)
    return torch.nn.functional.pad(x, flat)

kernel_name = 'gated_mix__linear_attn_block__dense_activation_gelu__prompt'

def setup_inputs():

    _w = (lambda a: (lambda t: t.to(torch.bfloat16) if t.is_floating_point() else t)(torch.as_tensor(a)))
    def _A_setup():
        B, S, D = 1, 2048, 640
        return {
            "x": _w((lambda *s: torch.randn(*s, dtype=torch.bfloat16) * 0.05)(B, S, D)),
            "wqkv": _w((lambda *s: torch.randn(*s, dtype=torch.bfloat16) * 0.8)(D, 3 * D)),
            "wo": _w((lambda *s: torch.randn(*s, dtype=torch.bfloat16) * 0.05)(D, D)),
        }
    _A_in = _A_setup()

    def _B_setup():
        B, S, D, F = 1, 2048, 640, 1728
        return {
            "x": _w((lambda *s: torch.randn(*s, dtype=torch.bfloat16) * 0.05)(B, S, D)),
            "w1": _w((lambda *s: torch.randn(*s, dtype=torch.bfloat16) * 3.2)(D, F) * (D ** -0.5)),
            "b1": _w((lambda *s: torch.randn(*s, dtype=torch.bfloat16) * 3.2)(F) * 0.01),
            "w2": _w((lambda *s: torch.randn(*s, dtype=torch.bfloat16) * 0.4)(F, D) * (F ** -0.5)),
            "b2": _w((lambda *s: torch.randn(*s, dtype=torch.bfloat16) * 0.8)(D) * 0.01),
        }
    _B_in = _B_setup()

    return {
        "A_x": _A_in["x"],
        "A_wqkv": _A_in["wqkv"],
        "A_wo": _A_in["wo"],
        "B_x": _B_in["x"],
        "B_w1": _B_in["w1"],
        "B_b1": _B_in["b1"],
        "B_w2": _B_in["w2"],
        "B_b2": _B_in["b2"],
        "gate_w": _w((lambda *s: torch.randn(*s, dtype=torch.bfloat16) * 0.05)(640) * 16.0),
    }

def reference(A_x, A_wqkv, A_wo, B_x, B_w1, B_b1, B_w2, B_b2, gate_w):
    def _A_ref(x, wqkv, wo):
        B, S, D = x.shape
        H = 32; Dh = D // H
        qkv = (lambda x, *d: x.permute(*d))((x @ wqkv).reshape(B, S, 3, H, Dh), 2, 0, 3, 1, 4)
        q, k, v = qkv[0], qkv[1], qkv[2]
        phi = lambda t: torch.where(t > 0, t + 1, torch.exp(t)) + 1e-6
        pq, pk = phi(q), phi(k)
        kv = torch.einsum("bhsd,bhse->bhde", pk, v)
        z = torch.einsum("bhsd->bhd", pk)
        num = torch.einsum("bhqd,bhde->bhqe", pq, kv)
        den = torch.einsum("bhqd,bhd->bhq", pq, z)[..., None] + 1e-6
        o = num / den
        return (lambda x, *d: x.permute(*d))(o, 0, 2, 1, 3).reshape(B, S, D) @ wo

    def _B_ref(x, w1, b1, w2, b2):
        h = torch.einsum("bsd,df->bsf", x, w1) + b1
        h = _gelu(h)
        return torch.einsum("bsf,fd->bsd", h, w2) + b2

    x = A_x
    g = _sigmoid((x * gate_w).sum(-1, keepdims=True))
    a = _A_ref(x, A_wqkv, A_wo)
    b = _B_ref(x, B_w1, B_b1, B_w2, B_b2)
    return g * a + (1 - g) * b
```

```asm
; @launch kernel=k1_kernel grid=(256,1,1) block=(512,1,1) lds=163840
; @launch kernel=km_kernel grid=(256,1,1) block=(256,1,1) lds=163840
.amdgcn_target "amdgcn-amd-amdhsa--gfx950"
.text
.globl k1_kernel
.p2align 8
.type k1_kernel,@function
k1_kernel:
    s_cmp_ge_u32 s2, 256
    s_cbranch_scc1 K1_done
    s_load_dwordx2 s[4:5], s[0:1], 0
    s_load_dwordx2 s[6:7], s[0:1], 8
    s_load_dwordx2 s[8:9], s[0:1], 32
    s_load_dwordx2 s[36:37], s[0:1], 40
    s_load_dwordx2 s[10:11], s[0:1], 88
    s_load_dwordx2 s[90:91], s[0:1], 48
    s_load_dwordx2 s[92:93], s[0:1], 16
    s_load_dwordx2 s[60:61], s[0:1], 64
    s_and_b32 s33, s2, 7
    s_lshr_b32 s34, s2, 3
    s_lshr_b32 s29, s33, 1
    s_lshl_b32 s29, s29, 2
    s_and_b32 s35, s34, 3
    s_or_b32 s29, s29, s35
    s_and_b32 s28, s33, 1
    s_lshl_b32 s28, s28, 3
    s_lshr_b32 s35, s34, 2
    s_or_b32 s28, s28, s35
    v_lshrrev_b32 v2, 6, v0
    v_and_b32 v1, 63, v0
    s_nop 0
    v_readfirstlane_b32 s30, v2
    s_mov_b32 s38, 0x3fb8aa3b
    s_mov_b32 s39, 0x358637bd
    s_and_b32 s74, s30, 3
    s_lshr_b32 s75, s30, 2
    v_and_b32 v2, 15, v1
    v_lshrrev_b32 v3, 4, v1
    s_lshl_b32 s33, s28, 7
    s_lshl_b32 s34, s74, 5
    s_add_u32 s33, s33, s34
    v_lshrrev_b32 v24, 3, v1
    v_and_b32 v25, 7, v1
    v_lshrrev_b32 v26, 1, v24
    v_xor_b32 v27, v25, v26
    v_xor_b32 v26, 4, v27
    v_add_u32 v24, s33, v24
    v_mul_u32_u24 v24, 1280, v24
    v_lshlrev_b32 v27, 4, v27
    v_lshlrev_b32 v26, 4, v26
    v_add_u32 v30, v24, v27
    v_add_u32 v31, v24, v26
    s_lshl_b32 s35, s74, 14
    s_add_u32 s35, s35, 98304
    s_lshl_b32 s76, s75, 11
    s_add_u32 s76, s76, s35
    s_mul_i32 s77, s75, 20480
    s_lshl_b32 s78, s75, 13
    s_add_u32 s78, s78, s35
    v_lshrrev_b32 v24, 3, v2
    v_lshlrev_b32 v24, 10, v24
    v_and_b32 v25, 7, v2
    v_lshlrev_b32 v25, 7, v25
    v_add_u32 v24, v24, v25
    v_add_u32 v24, s35, v24
    v_lshrrev_b32 v25, 1, v2
    v_xor_b32 v25, v25, v3
    v_xor_b32 v26, 4, v25
    v_lshlrev_b32 v25, 4, v25
    v_lshlrev_b32 v26, 4, v26
    v_add_u32 v28, v24, v25
    v_add_u32 v29, v24, v26
    v_lshlrev_b32 v7, 3, v3
    v_lshrrev_b32 v24, 5, v1
    v_and_b32 v25, 31, v1
    v_lshrrev_b32 v5, 1, v25
    v_and_b32 v25, 1, v25
    s_and_b32 s33, s30, 1
    s_lshr_b32 s34, s30, 1
    s_and_b32 s34, s34, 1
    s_lshl_b32 s31, s33, 1
    s_lshl_b32 s3, s34, 2
    s_add_u32 s31, s31, s3
    v_add_u32 v27, s31, v24
    v_xor_b32 v5, v5, v27
    s_add_u32 s3, s33, s3
    s_lshl_b32 s33, s75, 3
    s_add_u32 s3, s3, s33
    s_lshl_b32 s32, s3, 10
    s_lshl_b32 s3, s3, 1
    v_lshrrev_b32 v4, 2, v2
    v_and_b32 v2, 3, v2
    v_and_b32 v26, 1, v3
    v_lshlrev_b32 v26, 2, v26
    v_or_b32 v26, v26, v4
    v_lshlrev_b32 v27, 3, v3
    v_add_u32 v27, v27, v4
    v_lshlrev_b32 v27, 9, v27
    v_lshlrev_b32 v2, 3, v2
    v_add_u32 v27, v27, v2
    s_waitcnt lgkmcnt(0)
    s_mov_b32 s12, s4
    s_mov_b32 s13, s5
    s_mov_b32 s14, 2621440
    s_mov_b32 s15, 0x00020000
    s_cmp_lt_u32 s29, 8
    s_cbranch_scc0 K1_ffn
    s_mov_b32 s16, s6
    s_mov_b32 s17, s7
    s_mov_b32 s18, 2457600
    s_mov_b32 s19, 0x00020000
    s_mov_b32 s20, s10
    s_mov_b32 s21, s11
    s_mov_b32 s22, 2621440
    s_mov_b32 s23, 0x00020000
    s_add_u32 s24, s10, 9699328
    s_addc_u32 s25, s11, 0
    s_mov_b32 s26, 2359296
    s_mov_b32 s27, 0x00020000
    s_mul_i32 s31, s3, 3840
    v_cmp_gt_u32 vcc, 15, v5
    s_nop 1
    v_cndmask_b32 v5, 0, v5, vcc
    v_mul_u32_u24 v4, 52, v5
    v_lshrrev_b32 v4, 8, v4
    v_mul_u32_u24 v6, 5, v4
    v_sub_u32 v5, v5, v6
    v_mul_u32_u24 v4, 1280, v4
    v_lshlrev_b32 v5, 5, v5
    v_add_u32 v6, v4, v5
    s_mul_i32 s33, s29, 160
    v_add_u32 v6, s33, v6
    v_mul_u32_u24 v4, 3840, v24
    v_add_u32 v6, v6, v4
    v_lshlrev_b32 v4, 4, v25
    v_add_u32 v6, v6, v4
    s_cmp_eq_u32 s75, 0
    s_cbranch_scc0 K1_q
    s_mov_b32 s79, 5
    v_mov_b32 v2, v26
    v_mov_b32 v3, v27
    s_add_u32 s33, s79, 0
    v_xor_b32 v4, s33, v2
    v_lshlrev_b32 v4, 5, v4
    v_add_u32 v8, v3, v4
    v_add_u32 v18, 0x10000, v8
    s_add_u32 s33, s79, 1
    v_xor_b32 v4, s33, v2
    v_lshlrev_b32 v4, 5, v4
    v_add_u32 v9, v3, v4
    v_add_u32 v19, 0x10000, v9
    s_add_u32 s33, s79, 2
    v_xor_b32 v4, s33, v2
    v_lshlrev_b32 v4, 5, v4
    v_add_u32 v10, v3, v4
    v_add_u32 v20, 0x10000, v10
    s_add_u32 s33, s79, 3
    v_xor_b32 v4, s33, v2
    v_lshlrev_b32 v4, 5, v4
    v_add_u32 v11, v3, v4
    v_add_u32 v21, 0x10000, v11
    s_add_u32 s33, s79, 4
    v_xor_b32 v4, s33, v2
    v_lshlrev_b32 v4, 5, v4
    v_add_u32 v12, v3, v4
    v_add_u32 v22, 0x10000, v12
    s_add_u32 s33, s79, 5
    v_xor_b32 v4, s33, v2
    v_lshlrev_b32 v4, 5, v4
    v_add_u32 v13, v3, v4
    v_add_u32 v23, 0x10000, v13
    s_add_u32 s33, s79, 6
    v_xor_b32 v4, s33, v2
    v_lshlrev_b32 v4, 5, v4
    v_add_u32 v14, v3, v4
    v_add_u32 v24, 0x10000, v14
    s_add_u32 s33, s79, 7
    v_xor_b32 v4, s33, v2
    v_lshlrev_b32 v4, 5, v4
    v_add_u32 v15, v3, v4
    v_add_u32 v25, 0x10000, v15
    s_add_u32 s33, s79, 8
    v_xor_b32 v4, s33, v2
    v_lshlrev_b32 v4, 5, v4
    v_add_u32 v16, v3, v4
    v_add_u32 v26, 0x10000, v16
    s_add_u32 s33, s79, 9
    v_xor_b32 v4, s33, v2
    v_lshlrev_b32 v4, 5, v4
    v_add_u32 v17, v3, v4
    v_add_u32 v27, 0x10000, v17
    s_add_u32 m0, s32, 0
    s_add_u32 s34, s31, 0
    buffer_load_dwordx4 v6, s[16:19], s34 offen lds
    s_add_u32 m0, s32, 2048
    s_add_u32 s34, s31, 15360
    buffer_load_dwordx4 v6, s[16:19], s34 offen lds
    s_add_u32 m0, s76, 0
    s_add_u32 s34, s77, 0
    buffer_load_dwordx4 v30, s[12:15], s34 offen lds
    s_add_u32 m0, s76, 1024
    s_add_u32 s34, s77, 10240
    buffer_load_dwordx4 v31, s[12:15], s34 offen lds
    s_add_u32 m0, s32, 16384
    s_add_u32 s34, s31, 122880
    buffer_load_dwordx4 v6, s[16:19], s34 offen lds
    s_add_u32 m0, s32, 18432
    s_add_u32 s34, s31, 138240
    buffer_load_dwordx4 v6, s[16:19], s34 offen lds
    s_add_u32 m0, s32, 32768
    s_add_u32 s34, s31, 245760
    buffer_load_dwordx4 v6, s[16:19], s34 offen lds
    s_add_u32 m0, s32, 34816
    s_add_u32 s34, s31, 261120
    buffer_load_dwordx4 v6, s[16:19], s34 offen lds
    s_add_u32 m0, s76, 4096
    s_add_u32 s34, s77, 128
    buffer_load_dwordx4 v30, s[12:15], s34 offen lds
    s_add_u32 m0, s76, 5120
    s_add_u32 s34, s77, 10368
    buffer_load_dwordx4 v31, s[12:15], s34 offen lds
    s_add_u32 m0, s32, 49152
    s_add_u32 s34, s31, 368640
    buffer_load_dwordx4 v6, s[16:19], s34 offen lds
    s_add_u32 m0, s32, 51200
    s_add_u32 s34, s31, 384000
    buffer_load_dwordx4 v6, s[16:19], s34 offen lds
    s_waitcnt vmcnt(10)
    s_waitcnt vmcnt(8)
    s_barrier
    s_add_u32 m0, s32, 65536
    s_add_u32 s34, s31, 491520
    buffer_load_dwordx4 v6, s[16:19], s34 offen lds
    s_add_u32 m0, s32, 67584
    s_add_u32 s34, s31, 506880
    buffer_load_dwordx4 v6, s[16:19], s34 offen lds
    s_add_u32 m0, s76, 8192
    s_add_u32 s34, s77, 256
    buffer_load_dwordx4 v30, s[12:15], s34 offen lds
    s_add_u32 m0, s76, 9216
    s_add_u32 s34, s77, 10496
    buffer_load_dwordx4 v31, s[12:15], s34 offen lds
    ds_read_b128 v[64:67], v28 offset:0
    ds_read_b128 v[68:71], v28 offset:2048
    ds_read_b128 v[72:75], v29 offset:0
    ds_read_b128 v[76:79], v29 offset:2048
    ds_read_b64_tr_b16 v[32:33], v8 offset:0
    ds_read_b64_tr_b16 v[34:35], v8 offset:2048
    ds_read_b64_tr_b16 v[36:37], v9 offset:0
    ds_read_b64_tr_b16 v[38:39], v9 offset:2048
    ds_read_b64_tr_b16 v[40:41], v10 offset:0
    ds_read_b64_tr_b16 v[42:43], v10 offset:2048
    ds_read_b64_tr_b16 v[44:45], v11 offset:0
    ds_read_b64_tr_b16 v[46:47], v11 offset:2048
    ds_read_b64_tr_b16 v[48:49], v12 offset:0
    ds_read_b64_tr_b16 v[50:51], v12 offset:2048
    s_waitcnt lgkmcnt(8)
    v_mfma_f32_16x16x32_bf16 v[128:131], v[64:67], v[32:35], 0
    v_mfma_f32_16x16x32_bf16 v[132:135], v[68:71], v[32:35], 0
    ds_read_b64_tr_b16 v[52:53], v13 offset:0
    ds_read_b64_tr_b16 v[54:55], v13 offset:2048
    s_waitcnt lgkmcnt(8)
    v_mfma_f32_16x16x32_bf16 v[136:139], v[64:67], v[36:39], 0
    v_mfma_f32_16x16x32_bf16 v[140:143], v[68:71], v[36:39], 0
    ds_read_b64_tr_b16 v[56:57], v14 offset:0
    ds_read_b64_tr_b16 v[58:59], v14 offset:2048
    s_waitcnt lgkmcnt(8)
    v_mfma_f32_16x16x32_bf16 v[144:147], v[64:67], v[40:43], 0
    v_mfma_f32_16x16x32_bf16 v[148:151], v[68:71], v[40:43], 0
    ds_read_b64_tr_b16 v[60:61], v15 offset:0
    ds_read_b64_tr_b16 v[62:63], v15 offset:2048
    s_waitcnt lgkmcnt(8)
    v_mfma_f32_16x16x32_bf16 v[152:155], v[64:67], v[44:47], 0
    v_mfma_f32_16x16x32_bf16 v[156:159], v[68:71], v[44:47], 0
    ds_read_b64_tr_b16 v[32:33], v16 offset:0
    ds_read_b64_tr_b16 v[34:35], v16 offset:2048
    s_waitcnt lgkmcnt(8)
    v_mfma_f32_16x16x32_bf16 v[160:163], v[64:67], v[48:51], 0
    v_mfma_f32_16x16x32_bf16 v[164:167], v[68:71], v[48:51], 0
    ds_read_b64_tr_b16 v[36:37], v17 offset:0
    ds_read_b64_tr_b16 v[38:39], v17 offset:2048
    s_waitcnt lgkmcnt(8)
    v_mfma_f32_16x16x32_bf16 v[168:171], v[64:67], v[52:55], 0
    v_mfma_f32_16x16x32_bf16 v[172:175], v[68:71], v[52:55], 0
    s_waitcnt vmcnt(10)
    s_barrier
    s_add_u32 m0, s32, 81920
    s_add_u32 s34, s31, 614400
    buffer_load_dwordx4 v6, s[16:19], s34 offen lds
    s_add_u32 m0, s32, 83968
    s_add_u32 s34, s31, 629760
    buffer_load_dwordx4 v6, s[16:19], s34 offen lds
    ds_read_b64_tr_b16 v[40:41], v8 offset:16384
    ds_read_b64_tr_b16 v[42:43], v8 offset:18432
    s_waitcnt lgkmcnt(8)
    v_mfma_f32_16x16x32_bf16 v[176:179], v[64:67], v[56:59], 0
    v_mfma_f32_16x16x32_bf16 v[180:183], v[68:71], v[56:59], 0
    ds_read_b64_tr_b16 v[44:45], v9 offset:16384
    ds_read_b64_tr_b16 v[46:47], v9 offset:18432
    s_waitcnt lgkmcnt(8)
    v_mfma_f32_16x16x32_bf16 v[184:187], v[64:67], v[60:63], 0
    v_mfma_f32_16x16x32_bf16 v[188:191], v[68:71], v[60:63], 0
    ds_read_b64_tr_b16 v[48:49], v10 offset:16384
    ds_read_b64_tr_b16 v[50:51], v10 offset:18432
    s_waitcnt lgkmcnt(8)
    v_mfma_f32_16x16x32_bf16 v[192:195], v[64:67], v[32:35], 0
    v_mfma_f32_16x16x32_bf16 v[196:199], v[68:71], v[32:35], 0
    ds_read_b64_tr_b16 v[52:53], v11 offset:16384
    ds_read_b64_tr_b16 v[54:55], v11 offset:18432
    s_waitcnt lgkmcnt(8)
    v_mfma_f32_16x16x32_bf16 v[200:203], v[64:67], v[36:39], 0
    v_mfma_f32_16x16x32_bf16 v[204:207], v[68:71], v[36:39], 0
    ds_read_b64_tr_b16 v[56:57], v12 offset:16384
    ds_read_b64_tr_b16 v[58:59], v12 offset:18432
    s_waitcnt lgkmcnt(8)
    v_mfma_f32_16x16x32_bf16 v[128:131], v[72:75], v[40:43], v[128:131]
    v_mfma_f32_16x16x32_bf16 v[132:135], v[76:79], v[40:43], v[132:135]
    ds_read_b64_tr_b16 v[60:61], v13 offset:16384
    ds_read_b64_tr_b16 v[62:63], v13 offset:18432
    s_waitcnt lgkmcnt(8)
    v_mfma_f32_16x16x32_bf16 v[136:139], v[72:75], v[44:47], v[136:139]
    v_mfma_f32_16x16x32_bf16 v[140:143], v[76:79], v[44:47], v[140:143]
    ds_read_b64_tr_b16 v[32:33], v14 offset:16384
    ds_read_b64_tr_b16 v[34:35], v14 offset:18432
    s_waitcnt lgkmcnt(8)
    v_mfma_f32_16x16x32_bf16 v[144:147], v[72:75], v[48:51], v[144:147]
    v_mfma_f32_16x16x32_bf16 v[148:151], v[76:79], v[48:51], v[148:151]
    ds_read_b64_tr_b16 v[36:37], v15 offset:16384
    ds_read_b64_tr_b16 v[38:39], v15 offset:18432
    s_waitcnt lgkmcnt(8)
    v_mfma_f32_16x16x32_bf16 v[152:155], v[72:75], v[52:55], v[152:155]
    v_mfma_f32_16x16x32_bf16 v[156:159], v[76:79], v[52:55], v[156:159]
    ds_read_b64_tr_b16 v[40:41], v16 offset:16384
    ds_read_b64_tr_b16 v[42:43], v16 offset:18432
    s_waitcnt lgkmcnt(8)
    v_mfma_f32_16x16x32_bf16 v[160:163], v[72:75], v[56:59], v[160:163]
    v_mfma_f32_16x16x32_bf16 v[164:167], v[76:79], v[56:59], v[164:167]
    ds_read_b64_tr_b16 v[44:45], v17 offset:16384
    ds_read_b64_tr_b16 v[46:47], v17 offset:18432
    s_waitcnt lgkmcnt(8)
    v_mfma_f32_16x16x32_bf16 v[168:171], v[72:75], v[60:63], v[168:171]
    v_mfma_f32_16x16x32_bf16 v[172:175], v[76:79], v[60:63], v[172:175]
    s_waitcnt vmcnt(10)
    s_waitcnt vmcnt(8)
    s_barrier
    s_add_u32 m0, s32, 0
    s_add_u32 s34, s31, 737280
    buffer_load_dwordx4 v6, s[16:19], s34 offen lds
    s_add_u32 m0, s32, 2048
    s_add_u32 s34, s31, 752640
    buffer_load_dwordx4 v6, s[16:19], s34 offen lds
    s_add_u32 m0, s76, 12288
    s_add_u32 s34, s77, 384
    buffer_load_dwordx4 v30, s[12:15], s34 offen lds
    s_add_u32 m0, s76, 13312
    s_add_u32 s34, s77, 10624
    buffer_load_dwordx4 v31, s[12:15], s34 offen lds
    ds_read_b64_tr_b16 v[48:49], v8 offset:32768
    ds_read_b64_tr_b16 v[50:51], v8 offset:34816
    ds_read_b128 v[80:83], v28 offset:4096
    s_waitcnt lgkmcnt(9)
    v_mfma_f32_16x16x32_bf16 v[176:179], v[72:75], v[32:35], v[176:179]
    v_mfma_f32_16x16x32_bf16 v[180:183], v[76:79], v[32:35], v[180:183]
    ds_read_b64_tr_b16 v[52:53], v9 offset:32768
    ds_read_b64_tr_b16 v[54:55], v9 offset:34816
    ds_read_b128 v[84:87], v28 offset:6144
    s_waitcnt lgkmcnt(10)
    v_mfma_f32_16x16x32_bf16 v[184:187], v[72:75], v[36:39], v[184:187]
    v_mfma_f32_16x16x32_bf16 v[188:191], v[76:79], v[36:39], v[188:191]
    ds_read_b64_tr_b16 v[56:57], v10 offset:32768
    ds_read_b64_tr_b16 v[58:59], v10 offset:34816
    ds_read_b128 v[88:91], v29 offset:4096
    s_waitcnt lgkmcnt(11)
    v_mfma_f32_16x16x32_bf16 v[192:195], v[72:75], v[40:43], v[192:195]
    v_mfma_f32_16x16x32_bf16 v[196:199], v[76:79], v[40:43], v[196:199]
    ds_read_b64_tr_b16 v[60:61], v11 offset:32768
    ds_read_b64_tr_b16 v[62:63], v11 offset:34816
    ds_read_b128 v[92:95], v29 offset:6144
    s_waitcnt lgkmcnt(12)
    v_mfma_f32_16x16x32_bf16 v[200:203], v[72:75], v[44:47], v[200:203]
    v_mfma_f32_16x16x32_bf16 v[204:207], v[76:79], v[44:47], v[204:207]
    ds_read_b64_tr_b16 v[32:33], v12 offset:32768
    ds_read_b64_tr_b16 v[34:35], v12 offset:34816
    s_waitcnt lgkmcnt(2)
    v_mfma_f32_16x16x32_bf16 v[128:131], v[80:83], v[48:51], v[128:131]
    v_mfma_f32_16x16x32_bf16 v[132:135], v[84:87], v[48:51], v[132:135]
    ds_read_b64_tr_b16 v[36:37], v13 offset:32768
    ds_read_b64_tr_b16 v[38:39], v13 offset:34816
    v_mfma_f32_16x16x32_bf16 v[136:139], v[80:83], v[52:55], v[136:139]
    v_mfma_f32_16x16x32_bf16 v[140:143], v[84:87], v[52:55], v[140:143]
    ds_read_b64_tr_b16 v[40:41], v14 offset:32768
    ds_read_b64_tr_b16 v[42:43], v14 offset:34816
    v_mfma_f32_16x16x32_bf16 v[144:147], v[80:83], v[56:59], v[144:147]
    v_mfma_f32_16x16x32_bf16 v[148:151], v[84:87], v[56:59], v[148:151]
    ds_read_b64_tr_b16 v[44:45], v15 offset:32768
    ds_read_b64_tr_b16 v[46:47], v15 offset:34816
    v_mfma_f32_16x16x32_bf16 v[152:155], v[80:83], v[60:63], v[152:155]
    v_mfma_f32_16x16x32_bf16 v[156:159], v[84:87], v[60:63], v[156:159]
    ds_read_b64_tr_b16 v[48:49], v16 offset:32768
    ds_read_b64_tr_b16 v[50:51], v16 offset:34816
    s_waitcnt lgkmcnt(8)
    v_mfma_f32_16x16x32_bf16 v[160:163], v[80:83], v[32:35], v[160:163]
    v_mfma_f32_16x16x32_bf16 v[164:167], v[84:87], v[32:35], v[164:167]
    ds_read_b64_tr_b16 v[52:53], v17 offset:32768
    ds_read_b64_tr_b16 v[54:55], v17 offset:34816
    s_waitcnt lgkmcnt(8)
    v_mfma_f32_16x16x32_bf16 v[168:171], v[80:83], v[36:39], v[168:171]
    v_mfma_f32_16x16x32_bf16 v[172:175], v[84:87], v[36:39], v[172:175]
    s_waitcnt vmcnt(10)
    s_barrier
    s_add_u32 m0, s32, 16384
    s_add_u32 s34, s31, 860160
    buffer_load_dwordx4 v6, s[16:19], s34 offen lds
    s_add_u32 m0, s32, 18432
    s_add_u32 s34, s31, 875520
    buffer_load_dwordx4 v6, s[16:19], s34 offen lds
    ds_read_b64_tr_b16 v[56:57], v8 offset:49152
    ds_read_b64_tr_b16 v[58:59], v8 offset:51200
    s_waitcnt lgkmcnt(8)
    v_mfma_f32_16x16x32_bf16 v[176:179], v[80:83], v[40:43], v[176:179]
    v_mfma_f32_16x16x32_bf16 v[180:183], v[84:87], v[40:43], v[180:183]
    ds_read_b64_tr_b16 v[60:61], v9 offset:49152
    ds_read_b64_tr_b16 v[62:63], v9 offset:51200
    s_waitcnt lgkmcnt(8)
    v_mfma_f32_16x16x32_bf16 v[184:187], v[80:83], v[44:47], v[184:187]
    v_mfma_f32_16x16x32_bf16 v[188:191], v[84:87], v[44:47], v[188:191]
    ds_read_b64_tr_b16 v[32:33], v10 offset:49152
    ds_read_b64_tr_b16 v[34:35], v10 offset:51200
    s_waitcnt lgkmcnt(8)
    v_mfma_f32_16x16x32_bf16 v[192:195], v[80:83], v[48:51], v[192:195]
    v_mfma_f32_16x16x32_bf16 v[196:199], v[84:87], v[48:51], v[196:199]
    ds_read_b64_tr_b16 v[36:37], v11 offset:49152
    ds_read_b64_tr_b16 v[38:39], v11 offset:51200
    s_waitcnt lgkmcnt(8)
    v_mfma_f32_16x16x32_bf16 v[200:203], v[80:83], v[52:55], v[200:203]
    v_mfma_f32_16x16x32_bf16 v[204:207], v[84:87], v[52:55], v[204:207]
    ds_read_b64_tr_b16 v[40:41], v12 offset:49152
    ds_read_b64_tr_b16 v[42:43], v12 offset:51200
    s_waitcnt lgkmcnt(8)
    v_mfma_f32_16x16x32_bf16 v[128:131], v[88:91], v[56:59], v[128:131]
    v_mfma_f32_16x16x32_bf16 v[132:135], v[92:95], v[56:59], v[132:135]
    ds_read_b64_tr_b16 v[44:45], v13 offset:49152
    ds_read_b64_tr_b16 v[46:47], v13 offset:51200
    s_waitcnt lgkmcnt(8)
    v_mfma_f32_16x16x32_bf16 v[136:139], v[88:91], v[60:63], v[136:139]
    v_mfma_f32_16x16x32_bf16 v[140:143], v[92:95], v[60:63], v[140:143]
    ds_read_b64_tr_b16 v[48:49], v14 offset:49152
    ds_read_b64_tr_b16 v[50:51], v14 offset:51200
    s_waitcnt lgkmcnt(8)
    v_mfma_f32_16x16x32_bf16 v[144:147], v[88:91], v[32:35], v[144:147]
    v_mfma_f32_16x16x32_bf16 v[148:151], v[92:95], v[32:35], v[148:151]
    ds_read_b64_tr_b16 v[52:53], v15 offset:49152
    ds_read_b64_tr_b16 v[54:55], v15 offset:51200
    s_waitcnt lgkmcnt(8)
    v_mfma_f32_16x16x32_bf16 v[152:155], v[88:91], v[36:39], v[152:155]
    v_mfma_f32_16x16x32_bf16 v[156:159], v[92:95], v[36:39], v[156:159]
    ds_read_b64_tr_b16 v[56:57], v16 offset:49152
    ds_read_b64_tr_b16 v[58:59], v16 offset:51200
    s_waitcnt lgkmcnt(8)
    v_mfma_f32_16x16x32_bf16 v[160:163], v[88:91], v[40:43], v[160:163]
    v_mfma_f32_16x16x32_bf16 v[164:167], v[92:95], v[40:43], v[164:167]
    ds_read_b64_tr_b16 v[60:61], v17 offset:49152
    ds_read_b64_tr_b16 v[62:63], v17 offset:51200
    s_waitcnt lgkmcnt(8)
    v_mfma_f32_16x16x32_bf16 v[168:171], v[88:91], v[44:47], v[168:171]
    v_mfma_f32_16x16x32_bf16 v[172:175], v[92:95], v[44:47], v[172:175]
    s_waitcnt vmcnt(10)
    s_waitcnt vmcnt(8)
    s_barrier
    s_add_u32 m0, s32, 32768
    s_add_u32 s34, s31, 983040
    buffer_load_dwordx4 v6, s[16:19], s34 offen lds
    s_add_u32 m0, s32, 34816
    s_add_u32 s34, s31, 998400
    buffer_load_dwordx4 v6, s[16:19], s34 offen lds
    s_add_u32 m0, s76, 0
    s_add_u32 s34, s77, 512
    buffer_load_dwordx4 v30, s[12:15], s34 offen lds
    s_add_u32 m0, s76, 1024
    s_add_u32 s34, s77, 10752
    buffer_load_dwordx4 v31, s[12:15], s34 offen lds
    ds_read_b64_tr_b16 v[32:33], v18 offset:0
    ds_read_b64_tr_b16 v[34:35], v18 offset:2048
    ds_read_b128 v[64:67], v28 offset:8192
    s_waitcnt lgkmcnt(9)
    v_mfma_f32_16x16x32_bf16 v[176:179], v[88:91], v[48:51], v[176:179]
    v_mfma_f32_16x16x32_bf16 v[180:183], v[92:95], v[48:51], v[180:183]
    ds_read_b64_tr_b16 v[36:37], v19 offset:0
    ds_read_b64_tr_b16 v[38:39], v19 offset:2048
    ds_read_b128 v[68:71], v28 offset:10240
    s_waitcnt lgkmcnt(10)
    v_mfma_f32_16x16x32_bf16 v[184:187], v[88:91], v[52:55], v[184:187]
    v_mfma_f32_16x16x32_bf16 v[188:191], v[92:95], v[52:55], v[188:191]
    ds_read_b64_tr_b16 v[40:41], v20 offset:0
    ds_read_b64_tr_b16 v[42:43], v20 offset:2048
    ds_read_b128 v[72:75], v29 offset:8192
    s_waitcnt lgkmcnt(11)
    v_mfma_f32_16x16x32_bf16 v[192:195], v[88:91], v[56:59], v[192:195]
    v_mfma_f32_16x16x32_bf16 v[196:199], v[92:95], v[56:59], v[196:199]
    ds_read_b64_tr_b16 v[44:45], v21 offset:0
    ds_read_b64_tr_b16 v[46:47], v21 offset:2048
    ds_read_b128 v[76:79], v29 offset:10240
    s_waitcnt lgkmcnt(12)
    v_mfma_f32_16x16x32_bf16 v[200:203], v[88:91], v[60:63], v[200:203]
    v_mfma_f32_16x16x32_bf16 v[204:207], v[92:95], v[60:63], v[204:207]
    ds_read_b64_tr_b16 v[48:49], v22 offset:0
    ds_read_b64_tr_b16 v[50:51], v22 offset:2048
    s_waitcnt lgkmcnt(2)
    v_mfma_f32_16x16x32_bf16 v[128:131], v[64:67], v[32:35], v[128:131]
    v_mfma_f32_16x16x32_bf16 v[132:135], v[68:71], v[32:35], v[132:135]
    ds_read_b64_tr_b16 v[52:53], v23 offset:0
    ds_read_b64_tr_b16 v[54:55], v23 offset:2048
    v_mfma_f32_16x16x32_bf16 v[136:139], v[64:67], v[36:39], v[136:139]
    v_mfma_f32_16x16x32_bf16 v[140:143], v[68:71], v[36:39], v[140:143]
    ds_read_b64_tr_b16 v[56:57], v24 offset:0
    ds_read_b64_tr_b16 v[58:59], v24 offset:2048
    v_mfma_f32_16x16x32_bf16 v[144:147], v[64:67], v[40:43], v[144:147]
    v_mfma_f32_16x16x32_bf16 v[148:151], v[68:71], v[40:43], v[148:151]
    ds_read_b64_tr_b16 v[60:61], v25 offset:0
    ds_read_b64_tr_b16 v[62:63], v25 offset:2048
    v_mfma_f32_16x16x32_bf16 v[152:155], v[64:67], v[44:47], v[152:155]
    v_mfma_f32_16x16x32_bf16 v[156:159], v[68:71], v[44:47], v[156:159]
    ds_read_b64_tr_b16 v[32:33], v26 offset:0
    ds_read_b64_tr_b16 v[34:35], v26 offset:2048
    s_waitcnt lgkmcnt(8)
    v_mfma_f32_16x16x32_bf16 v[160:163], v[64:67], v[48:51], v[160:163]
    v_mfma_f32_16x16x32_bf16 v[164:167], v[68:71], v[48:51], v[164:167]
    ds_read_b64_tr_b16 v[36:37], v27 offset:0
    ds_read_b64_tr_b16 v[38:39], v27 offset:2048
    s_waitcnt lgkmcnt(8)
    v_mfma_f32_16x16x32_bf16 v[168:171], v[64:67], v[52:55], v[168:171]
    v_mfma_f32_16x16x32_bf16 v[172:175], v[68:71], v[52:55], v[172:175]
    s_waitcnt vmcnt(10)
    s_barrier
    s_add_u32 m0, s32, 49152
    s_add_u32 s34, s31, 1105920
    buffer_load_dwordx4 v6, s[16:19], s34 offen lds
    s_add_u32 m0, s32, 51200
    s_add_u32 s34, s31, 1121280
    buffer_load_dwordx4 v6, s[16:19], s34 offen lds
    ds_read_b64_tr_b16 v[40:41], v18 offset:16384
    ds_read_b64_tr_b16 v[42:43], v18 offset:18432
    s_waitcnt lgkmcnt(8)
    v_mfma_f32_16x16x32_bf16 v[176:179], v[64:67], v[56:59], v[176:179]
    v_mfma_f32_16x16x32_bf16 v[180:183], v[68:71], v[56:59], v[180:183]
    ds_read_b64_tr_b16 v[44:45], v19 offset:16384
    ds_read_b64_tr_b16 v[46:47], v19 offset:18432
    s_waitcnt lgkmcnt(8)
    v_mfma_f32_16x16x32_bf16 v[184:187], v[64:67], v[60:63], v[184:187]
    v_mfma_f32_16x16x32_bf16 v[188:191], v[68:71], v[60:63], v[188:191]
    ds_read_b64_tr_b16 v[48:49], v20 offset:16384
    ds_read_b64_tr_b16 v[50:51], v20 offset:18432
    s_waitcnt lgkmcnt(8)
    v_mfma_f32_16x16x32_bf16 v[192:195], v[64:67], v[32:35], v[192:195]
    v_mfma_f32_16x16x32_bf16 v[196:199], v[68:71], v[32:35], v[196:199]
    ds_read_b64_tr_b16 v[52:53], v21 offset:16384
    ds_read_b64_tr_b16 v[54:55], v21 offset:18432
    s_waitcnt lgkmcnt(8)
    v_mfma_f32_16x16x32_bf16 v[200:203], v[64:67], v[36:39], v[200:203]
    v_mfma_f32_16x16x32_bf16 v[204:207], v[68:71], v[36:39], v[204:207]
    ds_read_b64_tr_b16 v[56:57], v22 offset:16384
    ds_read_b64_tr_b16 v[58:59], v22 offset:18432
    s_waitcnt lgkmcnt(8)
    v_mfma_f32_16x16x32_bf16 v[128:131], v[72:75], v[40:43], v[128:131]
    v_mfma_f32_16x16x32_bf16 v[132:135], v[76:79], v[40:43], v[132:135]
    ds_read_b64_tr_b16 v[60:61], v23 offset:16384
    ds_read_b64_tr_b16 v[62:63], v23 offset:18432
    s_waitcnt lgkmcnt(8)
    v_mfma_f32_16x16x32_bf16 v[136:139], v[72:75], v[44:47], v[136:139]
    v_mfma_f32_16x16x32_bf16 v[140:143], v[76:79], v[44:47], v[140:143]
    ds_read_b64_tr_b16 v[32:33], v24 offset:16384
    ds_read_b64_tr_b16 v[34:35], v24 offset:18432
    s_waitcnt lgkmcnt(8)
    v_mfma_f32_16x16x32_bf16 v[144:147], v[72:75], v[48:51], v[144:147]
    v_mfma_f32_16x16x32_bf16 v[148:151], v[76:79], v[48:51], v[148:151]
    ds_read_b64_tr_b16 v[36:37], v25 offset:16384
    ds_read_b64_tr_b16 v[38:39], v25 offset:18432
    s_waitcnt lgkmcnt(8)
    v_mfma_f32_16x16x32_bf16 v[152:155], v[72:75], v[52:55], v[152:155]
    v_mfma_f32_16x16x32_bf16 v[156:159], v[76:79], v[52:55], v[156:159]
    ds_read_b64_tr_b16 v[40:41], v26 offset:16384
    ds_read_b64_tr_b16 v[42:43], v26 offset:18432
    s_waitcnt lgkmcnt(8)
    v_mfma_f32_16x16x32_bf16 v[160:163], v[72:75], v[56:59], v[160:163]
    v_mfma_f32_16x16x32_bf16 v[164:167], v[76:79], v[56:59], v[164:167]
    ds_read_b64_tr_b16 v[44:45], v27 offset:16384
    ds_read_b64_tr_b16 v[46:47], v27 offset:18432
    s_waitcnt lgkmcnt(8)
    v_mfma_f32_16x16x32_bf16 v[168:171], v[72:75], v[60:63], v[168:171]
    v_mfma_f32_16x16x32_bf16 v[172:175], v[76:79], v[60:63], v[172:175]
    s_waitcnt vmcnt(10)
    s_waitcnt vmcnt(8)
    s_barrier
    s_add_u32 m0, s32, 65536
    s_add_u32 s34, s31, 1228800
    buffer_load_dwordx4 v6, s[16:19], s34 offen lds
    s_add_u32 m0, s32, 67584
    s_add_u32 s34, s31, 1244160
    buffer_load_dwordx4 v6, s[16:19], s34 offen lds
    s_add_u32 m0, s76, 4096
    s_add_u32 s34, s77, 640
    buffer_load_dwordx4 v30, s[12:15], s34 offen lds
    s_add_u32 m0, s76, 5120
    s_add_u32 s34, s77, 10880
    buffer_load_dwordx4 v31, s[12:15], s34 offen lds
    ds_read_b64_tr_b16 v[48:49], v8 offset:0
    ds_read_b64_tr_b16 v[50:51], v8 offset:2048
    ds_read_b128 v[80:83], v28 offset:12288
    s_waitcnt lgkmcnt(9)
    v_mfma_f32_16x16x32_bf16 v[176:179], v[72:75], v[32:35], v[176:179]
    v_mfma_f32_16x16x32_bf16 v[180:183], v[76:79], v[32:35], v[180:183]
    ds_read_b64_tr_b16 v[52:53], v9 offset:0
    ds_read_b64_tr_b16 v[54:55], v9 offset:2048
    ds_read_b128 v[84:87], v28 offset:14336
    s_waitcnt lgkmcnt(10)
    v_mfma_f32_16x16x32_bf16 v[184:187], v[72:75], v[36:39], v[184:187]
    v_mfma_f32_16x16x32_bf16 v[188:191], v[76:79], v[36:39], v[188:191]
    ds_read_b64_tr_b16 v[56:57], v10 offset:0
    ds_read_b64_tr_b16 v[58:59], v10 offset:2048
    ds_read_b128 v[88:91], v29 offset:12288
    s_waitcnt lgkmcnt(11)
    v_mfma_f32_16x16x32_bf16 v[192:195], v[72:75], v[40:43], v[192:195]
    v_mfma_f32_16x16x32_bf16 v[196:199], v[76:79], v[40:43], v[196:199]
    ds_read_b64_tr_b16 v[60:61], v11 offset:0
    ds_read_b64_tr_b16 v[62:63], v11 offset:2048
    ds_read_b128 v[92:95], v29 offset:14336
    s_waitcnt lgkmcnt(12)
    v_mfma_f32_16x16x32_bf16 v[200:203], v[72:75], v[44:47], v[200:203]
    v_mfma_f32_16x16x32_bf16 v[204:207], v[76:79], v[44:47], v[204:207]
    ds_read_b64_tr_b16 v[32:33], v12 offset:0
    ds_read_b64_tr_b16 v[34:35], v12 offset:2048
    s_waitcnt lgkmcnt(2)
    v_mfma_f32_16x16x32_bf16 v[128:131], v[80:83], v[48:51], v[128:131]
    v_mfma_f32_16x16x32_bf16 v[132:135], v[84:87], v[48:51], v[132:135]
    ds_read_b64_tr_b16 v[36:37], v13 offset:0
    ds_read_b64_tr_b16 v[38:39], v13 offset:2048
    v_mfma_f32_16x16x32_bf16 v[136:139], v[80:83], v[52:55], v[136:139]
    v_mfma_f32_16x16x32_bf16 v[140:143], v[84:87], v[52:55], v[140:143]
    ds_read_b64_tr_b16 v[40:41], v14 offset:0
    ds_read_b64_tr_b16 v[42:43], v14 offset:2048
    v_mfma_f32_16x16x32_bf16 v[144:147], v[80:83], v[56:59], v[144:147]
    v_mfma_f32_16x16x32_bf16 v[148:151], v[84:87], v[56:59], v[148:151]
    ds_read_b64_tr_b16 v[44:45], v15 offset:0
    ds_read_b64_tr_b16 v[46:47], v15 offset:2048
    v_mfma_f32_16x16x32_bf16 v[152:155], v[80:83], v[60:63], v[152:155]
    v_mfma_f32_16x16x32_bf16 v[156:159], v[84:87], v[60:63], v[156:159]
    ds_read_b64_tr_b16 v[48:49], v16 offset:0
    ds_read_b64_tr_b16 v[50:51], v16 offset:2048
    s_waitcnt lgkmcnt(8)
    v_mfma_f32_16x16x32_bf16 v[160:163], v[80:83], v[32:35], v[160:163]
    v_mfma_f32_16x16x32_bf16 v[164:167], v[84:87], v[32:35], v[164:167]
    ds_read_b64_tr_b16 v[52:53], v17 offset:0
    ds_read_b64_tr_b16 v[54:55], v17 offset:2048
    s_waitcnt lgkmcnt(8)
    v_mfma_f32_16x16x32_bf16 v[168:171], v[80:83], v[36:39], v[168:171]
    v_mfma_f32_16x16x32_bf16 v[172:175], v[84:87], v[36:39], v[172:175]
    s_waitcnt vmcnt(10)
    s_barrier
    s_add_u32 m0, s32, 81920
    s_add_u32 s34, s31, 1351680
    buffer_load_dwordx4 v6, s[16:19], s34 offen lds
    s_add_u32 m0, s32, 83968
    s_add_u32 s34, s31, 1367040
    buffer_load_dwordx4 v6, s[16:19], s34 offen lds
    ds_read_b64_tr_b16 v[56:57], v8 offset:16384
    ds_read_b64_tr_b16 v[58:59], v8 offset:18432
    s_waitcnt lgkmcnt(8)
    v_mfma_f32_16x16x32_bf16 v[176:179], v[80:83], v[40:43], v[176:179]
    v_mfma_f32_16x16x32_bf16 v[180:183], v[84:87], v[40:43], v[180:183]
    ds_read_b64_tr_b16 v[60:61], v9 offset:16384
    ds_read_b64_tr_b16 v[62:63], v9 offset:18432
    s_waitcnt lgkmcnt(8)
    v_mfma_f32_16x16x32_bf16 v[184:187], v[80:83], v[44:47], v[184:187]
    v_mfma_f32_16x16x32_bf16 v[188:191], v[84:87], v[44:47], v[188:191]
    ds_read_b64_tr_b16 v[32:33], v10 offset:16384
    ds_read_b64_tr_b16 v[34:35], v10 offset:18432
    s_waitcnt lgkmcnt(8)
    v_mfma_f32_16x16x32_bf16 v[192:195], v[80:83], v[48:51], v[192:195]
    v_mfma_f32_16x16x32_bf16 v[196:199], v[84:87], v[48:51], v[196:199]
    ds_read_b64_tr_b16 v[36:37], v11 offset:16384
    ds_read_b64_tr_b16 v[38:39], v11 offset:18432
    s_waitcnt lgkmcnt(8)
    v_mfma_f32_16x16x32_bf16 v[200:203], v[80:83], v[52:55], v[200:203]
    v_mfma_f32_16x16x32_bf16 v[204:207], v[84:87], v[52:55], v[204:207]
    ds_read_b64_tr_b16 v[40:41], v12 offset:16384
    ds_read_b64_tr_b16 v[42:43], v12 offset:18432
    s_waitcnt lgkmcnt(8)
    v_mfma_f32_16x16x32_bf16 v[128:131], v[88:91], v[56:59], v[128:131]
    v_mfma_f32_16x16x32_bf16 v[132:135], v[92:95], v[56:59], v[132:135]
    ds_read_b64_tr_b16 v[44:45], v13 offset:16384
    ds_read_b64_tr_b16 v[46:47], v13 offset:18432
    s_waitcnt lgkmcnt(8)
    v_mfma_f32_16x16x32_bf16 v[136:139], v[88:91], v[60:63], v[136:139]
    v_mfma_f32_16x16x32_bf16 v[140:143], v[92:95], v[60:63], v[140:143]
    ds_read_b64_tr_b16 v[48:49], v14 offset:16384
    ds_read_b64_tr_b16 v[50:51], v14 offset:18432
    s_waitcnt lgkmcnt(8)
    v_mfma_f32_16x16x32_bf16 v[144:147], v[88:91], v[32:35], v[144:147]
    v_mfma_f32_16x16x32_bf16 v[148:151], v[92:95], v[32:35], v[148:151]
    ds_read_b64_tr_b16 v[52:53], v15 offset:16384
    ds_read_b64_tr_b16 v[54:55], v15 offset:18432
    s_waitcnt lgkmcnt(8)
    v_mfma_f32_16x16x32_bf16 v[152:155], v[88:91], v[36:39], v[152:155]
    v_mfma_f32_16x16x32_bf16 v[156:159], v[92:95], v[36:39], v[156:159]
    ds_read_b64_tr_b16 v[56:57], v16 offset:16384
    ds_read_b64_tr_b16 v[58:59], v16 offset:18432
    s_waitcnt lgkmcnt(8)
    v_mfma_f32_16x16x32_bf16 v[160:163], v[88:91], v[40:43], v[160:163]
    v_mfma_f32_16x16x32_bf16 v[164:167], v[92:95], v[40:43], v[164:167]
    ds_read_b64_tr_b16 v[60:61], v17 offset:16384
    ds_read_b64_tr_b16 v[62:63], v17 offset:18432
    s_waitcnt lgkmcnt(8)
    v_mfma_f32_16x16x32_bf16 v[168:171], v[88:91], v[44:47], v[168:171]
    v_mfma_f32_16x16x32_bf16 v[172:175], v[92:95], v[44:47], v[172:175]
    s_waitcnt vmcnt(10)
    s_waitcnt vmcnt(8)
    s_barrier
    s_add_u32 m0, s32, 0
    s_add_u32 s34, s31, 1474560
    buffer_load_dwordx4 v6, s[16:19], s34 offen lds
    s_add_u32 m0, s32, 2048
    s_add_u32 s34, s31, 1489920
    buffer_load_dwordx4 v6, s[16:19], s34 offen lds
    s_add_u32 m0, s76, 8192
    s_add_u32 s34, s77, 768
    buffer_load_dwordx4 v30, s[12:15], s34 offen lds
    s_add_u32 m0, s76, 9216
    s_add_u32 s34, s77, 11008
    buffer_load_dwordx4 v31, s[12:15], s34 offen lds
    ds_read_b64_tr_b16 v[32:33], v8 offset:32768
    ds_read_b64_tr_b16 v[34:35], v8 offset:34816
    ds_read_b128 v[64:67], v28 offset:0
    s_waitcnt lgkmcnt(9)
    v_mfma_f32_16x16x32_bf16 v[176:179], v[88:91], v[48:51], v[176:179]
    v_mfma_f32_16x16x32_bf16 v[180:183], v[92:95], v[48:51], v[180:183]
    ds_read_b64_tr_b16 v[36:37], v9 offset:32768
    ds_read_b64_tr_b16 v[38:39], v9 offset:34816
    ds_read_b128 v[68:71], v28 offset:2048
    s_waitcnt lgkmcnt(10)
    v_mfma_f32_16x16x32_bf16 v[184:187], v[88:91], v[52:55], v[184:187]
    v_mfma_f32_16x16x32_bf16 v[188:191], v[92:95], v[52:55], v[188:191]
    ds_read_b64_tr_b16 v[40:41], v10 offset:32768
    ds_read_b64_tr_b16 v[42:43], v10 offset:34816
    ds_read_b128 v[72:75], v29 offset:0
    s_waitcnt lgkmcnt(11)
    v_mfma_f32_16x16x32_bf16 v[192:195], v[88:91], v[56:59], v[192:195]
    v_mfma_f32_16x16x32_bf16 v[196:199], v[92:95], v[56:59], v[196:199]
    ds_read_b64_tr_b16 v[44:45], v11 offset:32768
    ds_read_b64_tr_b16 v[46:47], v11 offset:34816
    ds_read_b128 v[76:79], v29 offset:2048
    s_waitcnt lgkmcnt(12)
    v_mfma_f32_16x16x32_bf16 v[200:203], v[88:91], v[60:63], v[200:203]
    v_mfma_f32_16x16x32_bf16 v[204:207], v[92:95], v[60:63], v[204:207]
    ds_read_b64_tr_b16 v[48:49], v12 offset:32768
    ds_read_b64_tr_b16 v[50:51], v12 offset:34816
    s_waitcnt lgkmcnt(2)
    v_mfma_f32_16x16x32_bf16 v[128:131], v[64:67], v[32:35], v[128:131]
    v_mfma_f32_16x16x32_bf16 v[132:135], v[68:71], v[32:35], v[132:135]
    ds_read_b64_tr_b16 v[52:53], v13 offset:32768
    ds_read_b64_tr_b16 v[54:55], v13 offset:34816
    v_mfma_f32_16x16x32_bf16 v[136:139], v[64:67], v[36:39], v[136:139]
    v_mfma_f32_16x16x32_bf16 v[140:143], v[68:71], v[36:39], v[140:143]
    ds_read_b64_tr_b16 v[56:57], v14 offset:32768
    ds_read_b64_tr_b16 v[58:59], v14 offset:34816
    v_mfma_f32_16x16x32_bf16 v[144:147], v[64:67], v[40:43], v[144:147]
    v_mfma_f32_16x16x32_bf16 v[148:151], v[68:71], v[40:43], v[148:151]
    ds_read_b64_tr_b16 v[60:61], v15 offset:32768
    ds_read_b64_tr_b16 v[62:63], v15 offset:34816
    v_mfma_f32_16x16x32_bf16 v[152:155], v[64:67], v[44:47], v[152:155]
    v_mfma_f32_16x16x32_bf16 v[156:159], v[68:71], v[44:47], v[156:159]
    ds_read_b64_tr_b16 v[32:33], v16 offset:32768
    ds_read_b64_tr_b16 v[34:35], v16 offset:34816
    s_waitcnt lgkmcnt(8)
    v_mfma_f32_16x16x32_bf16 v[160:163], v[64:67], v[48:51], v[160:163]
    v_mfma_f32_16x16x32_bf16 v[164:167], v[68:71], v[48:51], v[164:167]
    ds_read_b64_tr_b16 v[36:37], v17 offset:32768
    ds_read_b64_tr_b16 v[38:39], v17 offset:34816
    s_waitcnt lgkmcnt(8)
    v_mfma_f32_16x16x32_bf16 v[168:171], v[64:67], v[52:55], v[168:171]
    v_mfma_f32_16x16x32_bf16 v[172:175], v[68:71], v[52:55], v[172:175]
    s_waitcnt vmcnt(10)
    s_barrier
    s_add_u32 m0, s32, 16384
    s_add_u32 s34, s31, 1597440
    buffer_load_dwordx4 v6, s[16:19], s34 offen lds
    s_add_u32 m0, s32, 18432
    s_add_u32 s34, s31, 1612800
    buffer_load_dwordx4 v6, s[16:19], s34 offen lds
    ds_read_b64_tr_b16 v[40:41], v8 offset:49152
    ds_read_b64_tr_b16 v[42:43], v8 offset:51200
    s_waitcnt lgkmcnt(8)
    v_mfma_f32_16x16x32_bf16 v[176:179], v[64:67], v[56:59], v[176:179]
    v_mfma_f32_16x16x32_bf16 v[180:183], v[68:71], v[56:59], v[180:183]
    ds_read_b64_tr_b16 v[44:45], v9 offset:49152
    ds_read_b64_tr_b16 v[46:47], v9 offset:51200
    s_waitcnt lgkmcnt(8)
    v_mfma_f32_16x16x32_bf16 v[184:187], v[64:67], v[60:63], v[184:187]
    v_mfma_f32_16x16x32_bf16 v[188:191], v[68:71], v[60:63], v[188:191]
    ds_read_b64_tr_b16 v[48:49], v10 offset:49152
    ds_read_b64_tr_b16 v[50:51], v10 offset:51200
    s_waitcnt lgkmcnt(8)
    v_mfma_f32_16x16x32_bf16 v[192:195], v[64:67], v[32:35], v[192:195]
    v_mfma_f32_16x16x32_bf16 v[196:199], v[68:71], v[32:35], v[196:199]
    ds_read_b64_tr_b16 v[52:53], v11 offset:49152
    ds_read_b64_tr_b16 v[54:55], v11 offset:51200
    s_waitcnt lgkmcnt(8)
    v_mfma_f32_16x16x32_bf16 v[200:203], v[64:67], v[36:39], v[200:203]
    v_mfma_f32_16x16x32_bf16 v[204:207], v[68:71], v[36:39], v[204:207]
    ds_read_b64_tr_b16 v[56:57], v12 offset:49152
    ds_read_b64_tr_b16 v[58:59], v12 offset:51200
    s_waitcnt lgkmcnt(8)
    v_mfma_f32_16x16x32_bf16 v[128:131], v[72:75], v[40:43], v[128:131]
    v_mfma_f32_16x16x32_bf16 v[132:135], v[76:79], v[40:43], v[132:135]
    ds_read_b64_tr_b16 v[60:61], v13 offset:49152
    ds_read_b64_tr_b16 v[62:63], v13 offset:51200
    s_waitcnt lgkmcnt(8)
    v_mfma_f32_16x16x32_bf16 v[136:139], v[72:75], v[44:47], v[136:139]
    v_mfma_f32_16x16x32_bf16 v[140:143], v[76:79], v[44:47], v[140:143]
    ds_read_b64_tr_b16 v[32:33], v14 offset:49152
    ds_read_b64_tr_b16 v[34:35], v14 offset:51200
    s_waitcnt lgkmcnt(8)
    v_mfma_f32_16x16x32_bf16 v[144:147], v[72:75], v[48:51], v[144:147]
    v_mfma_f32_16x16x32_bf16 v[148:151], v[76:79], v[48:51], v[148:151]
    ds_read_b64_tr_b16 v[36:37], v15 offset:49152
    ds_read_b64_tr_b16 v[38:39], v15 offset:51200
    s_waitcnt lgkmcnt(8)
    v_mfma_f32_16x16x32_bf16 v[152:155], v[72:75], v[52:55], v[152:155]
    v_mfma_f32_16x16x32_bf16 v[156:159], v[76:79], v[52:55], v[156:159]
    ds_read_b64_tr_b16 v[40:41], v16 offset:49152
    ds_read_b64_tr_b16 v[42:43], v16 offset:51200
    s_waitcnt lgkmcnt(8)
    v_mfma_f32_16x16x32_bf16 v[160:163], v[72:75], v[56:59], v[160:163]
    v_mfma_f32_16x16x32_bf16 v[164:167], v[76:79], v[56:59], v[164:167]
    ds_read_b64_tr_b16 v[44:45], v17 offset:49152
    ds_read_b64_tr_b16 v[46:47], v17 offset:51200
    s_waitcnt lgkmcnt(8)
    v_mfma_f32_16x16x32_bf16 v[168:171], v[72:75], v[60:63], v[168:171]
    v_mfma_f32_16x16x32_bf16 v[172:175], v[76:79], v[60:63], v[172:175]
    s_waitcnt vmcnt(10)
    s_waitcnt vmcnt(8)
    s_barrier
    s_add_u32 m0, s32, 32768
    s_add_u32 s34, s31, 1720320
    buffer_load_dwordx4 v6, s[16:19], s34 offen lds
    s_add_u32 m0, s32, 34816
    s_add_u32 s34, s31, 1735680
    buffer_load_dwordx4 v6, s[16:19], s34 offen lds
    s_add_u32 m0, s76, 12288
    s_add_u32 s34, s77, 896
    buffer_load_dwordx4 v30, s[12:15], s34 offen lds
    s_add_u32 m0, s76, 13312
    s_add_u32 s34, s77, 11136
    buffer_load_dwordx4 v31, s[12:15], s34 offen lds
    ds_read_b64_tr_b16 v[48:49], v18 offset:0
    ds_read_b64_tr_b16 v[50:51], v18 offset:2048
    ds_read_b128 v[80:83], v28 offset:4096
    s_waitcnt lgkmcnt(9)
    v_mfma_f32_16x16x32_bf16 v[176:179], v[72:75], v[32:35], v[176:179]
    v_mfma_f32_16x16x32_bf16 v[180:183], v[76:79], v[32:35], v[180:183]
    ds_read_b64_tr_b16 v[52:53], v19 offset:0
    ds_read_b64_tr_b16 v[54:55], v19 offset:2048
    ds_read_b128 v[84:87], v28 offset:6144
    s_waitcnt lgkmcnt(10)
    v_mfma_f32_16x16x32_bf16 v[184:187], v[72:75], v[36:39], v[184:187]
    v_mfma_f32_16x16x32_bf16 v[188:191], v[76:79], v[36:39], v[188:191]
    ds_read_b64_tr_b16 v[56:57], v20 offset:0
    ds_read_b64_tr_b16 v[58:59], v20 offset:2048
    ds_read_b128 v[88:91], v29 offset:4096
    s_waitcnt lgkmcnt(11)
    v_mfma_f32_16x16x32_bf16 v[192:195], v[72:75], v[40:43], v[192:195]
    v_mfma_f32_16x16x32_bf16 v[196:199], v[76:79], v[40:43], v[196:199]
    ds_read_b64_tr_b16 v[60:61], v21 offset:0
    ds_read_b64_tr_b16 v[62:63], v21 offset:2048
    ds_read_b128 v[92:95], v29 offset:6144
    s_waitcnt lgkmcnt(12)
    v_mfma_f32_16x16x32_bf16 v[200:203], v[72:75], v[44:47], v[200:203]
    v_mfma_f32_16x16x32_bf16 v[204:207], v[76:79], v[44:47], v[204:207]
    ds_read_b64_tr_b16 v[32:33], v22 offset:0
    ds_read_b64_tr_b16 v[34:35], v22 offset:2048
    s_waitcnt lgkmcnt(2)
    v_mfma_f32_16x16x32_bf16 v[128:131], v[80:83], v[48:51], v[128:131]
    v_mfma_f32_16x16x32_bf16 v[132:135], v[84:87], v[48:51], v[132:135]
    ds_read_b64_tr_b16 v[36:37], v23 offset:0
    ds_read_b64_tr_b16 v[38:39], v23 offset:2048
    v_mfma_f32_16x16x32_bf16 v[136:139], v[80:83], v[52:55], v[136:139]
    v_mfma_f32_16x16x32_bf16 v[140:143], v[84:87], v[52:55], v[140:143]
    ds_read_b64_tr_b16 v[40:41], v24 offset:0
    ds_read_b64_tr_b16 v[42:43], v24 offset:2048
    v_mfma_f32_16x16x32_bf16 v[144:147], v[80:83], v[56:59], v[144:147]
    v_mfma_f32_16x16x32_bf16 v[148:151], v[84:87], v[56:59], v[148:151]
    ds_read_b64_tr_b16 v[44:45], v25 offset:0
    ds_read_b64_tr_b16 v[46:47], v25 offset:2048
    v_mfma_f32_16x16x32_bf16 v[152:155], v[80:83], v[60:63], v[152:155]
    v_mfma_f32_16x16x32_bf16 v[156:159], v[84:87], v[60:63], v[156:159]
    ds_read_b64_tr_b16 v[48:49], v26 offset:0
    ds_read_b64_tr_b16 v[50:51], v26 offset:2048
    s_waitcnt lgkmcnt(8)
    v_mfma_f32_16x16x32_bf16 v[160:163], v[80:83], v[32:35], v[160:163]
    v_mfma_f32_16x16x32_bf16 v[164:167], v[84:87], v[32:35], v[164:167]
    ds_read_b64_tr_b16 v[52:53], v27 offset:0
    ds_read_b64_tr_b16 v[54:55], v27 offset:2048
    s_waitcnt lgkmcnt(8)
    v_mfma_f32_16x16x32_bf16 v[168:171], v[80:83], v[36:39], v[168:171]
    v_mfma_f32_16x16x32_bf16 v[172:175], v[84:87], v[36:39], v[172:175]
    s_waitcnt vmcnt(10)
    s_barrier
    s_add_u32 m0, s32, 49152
    s_add_u32 s34, s31, 1843200
    buffer_load_dwordx4 v6, s[16:19], s34 offen lds
    s_add_u32 m0, s32, 51200
    s_add_u32 s34, s31, 1858560
    buffer_load_dwordx4 v6, s[16:19], s34 offen lds
    ds_read_b64_tr_b16 v[56:57], v18 offset:16384
    ds_read_b64_tr_b16 v[58:59], v18 offset:18432
    s_waitcnt lgkmcnt(8)
    v_mfma_f32_16x16x32_bf16 v[176:179], v[80:83], v[40:43], v[176:179]
    v_mfma_f32_16x16x32_bf16 v[180:183], v[84:87], v[40:43], v[180:183]
    ds_read_b64_tr_b16 v[60:61], v19 offset:16384
    ds_read_b64_tr_b16 v[62:63], v19 offset:18432
    s_waitcnt lgkmcnt(8)
    v_mfma_f32_16x16x32_bf16 v[184:187], v[80:83], v[44:47], v[184:187]
    v_mfma_f32_16x16x32_bf16 v[188:191], v[84:87], v[44:47], v[188:191]
    ds_read_b64_tr_b16 v[32:33], v20 offset:16384
    ds_read_b64_tr_b16 v[34:35], v20 offset:18432
    s_waitcnt lgkmcnt(8)
    v_mfma_f32_16x16x32_bf16 v[192:195], v[80:83], v[48:51], v[192:195]
    v_mfma_f32_16x16x32_bf16 v[196:199], v[84:87], v[48:51], v[196:199]
    ds_read_b64_tr_b16 v[36:37], v21 offset:16384
    ds_read_b64_tr_b16 v[38:39], v21 offset:18432
    s_waitcnt lgkmcnt(8)
    v_mfma_f32_16x16x32_bf16 v[200:203], v[80:83], v[52:55], v[200:203]
    v_mfma_f32_16x16x32_bf16 v[204:207], v[84:87], v[52:55], v[204:207]
    ds_read_b64_tr_b16 v[40:41], v22 offset:16384
    ds_read_b64_tr_b16 v[42:43], v22 offset:18432
    s_waitcnt lgkmcnt(8)
    v_mfma_f32_16x16x32_bf16 v[128:131], v[88:91], v[56:59], v[128:131]
    v_mfma_f32_16x16x32_bf16 v[132:135], v[92:95], v[56:59], v[132:135]
    ds_read_b64_tr_b16 v[44:45], v23 offset:16384
    ds_read_b64_tr_b16 v[46:47], v23 offset:18432
    s_waitcnt lgkmcnt(8)
    v_mfma_f32_16x16x32_bf16 v[136:139], v[88:91], v[60:63], v[136:139]
    v_mfma_f32_16x16x32_bf16 v[140:143], v[92:95], v[60:63], v[140:143]
    ds_read_b64_tr_b16 v[48:49], v24 offset:16384
    ds_read_b64_tr_b16 v[50:51], v24 offset:18432
    s_waitcnt lgkmcnt(8)
    v_mfma_f32_16x16x32_bf16 v[144:147], v[88:91], v[32:35], v[144:147]
    v_mfma_f32_16x16x32_bf16 v[148:151], v[92:95], v[32:35], v[148:151]
    ds_read_b64_tr_b16 v[52:53], v25 offset:16384
    ds_read_b64_tr_b16 v[54:55], v25 offset:18432
    s_waitcnt lgkmcnt(8)
    v_mfma_f32_16x16x32_bf16 v[152:155], v[88:91], v[36:39], v[152:155]
    v_mfma_f32_16x16x32_bf16 v[156:159], v[92:95], v[36:39], v[156:159]
    ds_read_b64_tr_b16 v[56:57], v26 offset:16384
    ds_read_b64_tr_b16 v[58:59], v26 offset:18432
    s_waitcnt lgkmcnt(8)
    v_mfma_f32_16x16x32_bf16 v[160:163], v[88:91], v[40:43], v[160:163]
    v_mfma_f32_16x16x32_bf16 v[164:167], v[92:95], v[40:43], v[164:167]
    ds_read_b64_tr_b16 v[60:61], v27 offset:16384
    ds_read_b64_tr_b16 v[62:63], v27 offset:18432
    s_waitcnt lgkmcnt(8)
    v_mfma_f32_16x16x32_bf16 v[168:171], v[88:91], v[44:47], v[168:171]
    v_mfma_f32_16x16x32_bf16 v[172:175], v[92:95], v[44:47], v[172:175]
    s_waitcnt vmcnt(10)
    s_waitcnt vmcnt(8)
    s_barrier
    s_add_u32 m0, s32, 65536
    s_add_u32 s34, s31, 1966080
    buffer_load_dwordx4 v6, s[16:19], s34 offen lds
    s_add_u32 m0, s32, 67584
    s_add_u32 s34, s31, 1981440
    buffer_load_dwordx4 v6, s[16:19], s34 offen lds
    s_add_u32 m0, s76, 0
    s_add_u32 s34, s77, 1024
    buffer_load_dwordx4 v30, s[12:15], s34 offen lds
    s_add_u32 m0, s76, 1024
    s_add_u32 s34, s77, 11264
    buffer_load_dwordx4 v31, s[12:15], s34 offen lds
    ds_read_b64_tr_b16 v[32:33], v8 offset:0
    ds_read_b64_tr_b16 v[34:35], v8 offset:2048
    ds_read_b128 v[64:67], v28 offset:8192
    s_waitcnt lgkmcnt(9)
    v_mfma_f32_16x16x32_bf16 v[176:179], v[88:91], v[48:51], v[176:179]
    v_mfma_f32_16x16x32_bf16 v[180:183], v[92:95], v[48:51], v[180:183]
    ds_read_b64_tr_b16 v[36:37], v9 offset:0
    ds_read_b64_tr_b16 v[38:39], v9 offset:2048
    ds_read_b128 v[68:71], v28 offset:10240
    s_waitcnt lgkmcnt(10)
    v_mfma_f32_16x16x32_bf16 v[184:187], v[88:91], v[52:55], v[184:187]
    v_mfma_f32_16x16x32_bf16 v[188:191], v[92:95], v[52:55], v[188:191]
    ds_read_b64_tr_b16 v[40:41], v10 offset:0
    ds_read_b64_tr_b16 v[42:43], v10 offset:2048
    ds_read_b128 v[72:75], v29 offset:8192
    s_waitcnt lgkmcnt(11)
    v_mfma_f32_16x16x32_bf16 v[192:195], v[88:91], v[56:59], v[192:195]
    v_mfma_f32_16x16x32_bf16 v[196:199], v[92:95], v[56:59], v[196:199]
    ds_read_b64_tr_b16 v[44:45], v11 offset:0
    ds_read_b64_tr_b16 v[46:47], v11 offset:2048
    ds_read_b128 v[76:79], v29 offset:10240
    s_waitcnt lgkmcnt(12)
    v_mfma_f32_16x16x32_bf16 v[200:203], v[88:91], v[60:63], v[200:203]
    v_mfma_f32_16x16x32_bf16 v[204:207], v[92:95], v[60:63], v[204:207]
    ds_read_b64_tr_b16 v[48:49], v12 offset:0
    ds_read_b64_tr_b16 v[50:51], v12 offset:2048
    s_waitcnt lgkmcnt(2)
    v_mfma_f32_16x16x32_bf16 v[128:131], v[64:67], v[32:35], v[128:131]
    v_mfma_f32_16x16x32_bf16 v[132:135], v[68:71], v[32:35], v[132:135]
    ds_read_b64_tr_b16 v[52:53], v13 offset:0
    ds_read_b64_tr_b16 v[54:55], v13 offset:2048
    v_mfma_f32_16x16x32_bf16 v[136:139], v[64:67], v[36:39], v[136:139]
    v_mfma_f32_16x16x32_bf16 v[140:143], v[68:71], v[36:39], v[140:143]
    ds_read_b64_tr_b16 v[56:57], v14 offset:0
    ds_read_b64_tr_b16 v[58:59], v14 offset:2048
    v_mfma_f32_16x16x32_bf16 v[144:147], v[64:67], v[40:43], v[144:147]
    v_mfma_f32_16x16x32_bf16 v[148:151], v[68:71], v[40:43], v[148:151]
    ds_read_b64_tr_b16 v[60:61], v15 offset:0
    ds_read_b64_tr_b16 v[62:63], v15 offset:2048
    v_mfma_f32_16x16x32_bf16 v[152:155], v[64:67], v[44:47], v[152:155]
    v_mfma_f32_16x16x32_bf16 v[156:159], v[68:71], v[44:47], v[156:159]
    ds_read_b64_tr_b16 v[32:33], v16 offset:0
    ds_read_b64_tr_b16 v[34:35], v16 offset:2048
    s_waitcnt lgkmcnt(8)
    v_mfma_f32_16x16x32_bf16 v[160:163], v[64:67], v[48:51], v[160:163]
    v_mfma_f32_16x16x32_bf16 v[164:167], v[68:71], v[48:51], v[164:167]
    ds_read_b64_tr_b16 v[36:37], v17 offset:0
    ds_read_b64_tr_b16 v[38:39], v17 offset:2048
    s_waitcnt lgkmcnt(8)
    v_mfma_f32_16x16x32_bf16 v[168:171], v[64:67], v[52:55], v[168:171]
    v_mfma_f32_16x16x32_bf16 v[172:175], v[68:71], v[52:55], v[172:175]
    s_waitcnt vmcnt(10)
    s_barrier
    s_add_u32 m0, s32, 81920
    s_add_u32 s34, s31, 2088960
    buffer_load_dwordx4 v6, s[16:19], s34 offen lds
    s_add_u32 m0, s32, 83968
    s_add_u32 s34, s31, 2104320
    buffer_load_dwordx4 v6, s[16:19], s34 offen lds
    ds_read_b64_tr_b16 v[40:41], v8 offset:16384
    ds_read_b64_tr_b16 v[42:43], v8 offset:18432
    s_waitcnt lgkmcnt(8)
    v_mfma_f32_16x16x32_bf16 v[176:179], v[64:67], v[56:59], v[176:179]
    v_mfma_f32_16x16x32_bf16 v[180:183], v[68:71], v[56:59], v[180:183]
    ds_read_b64_tr_b16 v[44:45], v9 offset:16384
    ds_read_b64_tr_b16 v[46:47], v9 offset:18432
    s_waitcnt lgkmcnt(8)
    v_mfma_f32_16x16x32_bf16 v[184:187], v[64:67], v[60:63], v[184:187]
    v_mfma_f32_16x16x32_bf16 v[188:191], v[68:71], v[60:63], v[188:191]
    ds_read_b64_tr_b16 v[48:49], v10 offset:16384
    ds_read_b64_tr_b16 v[50:51], v10 offset:18432
    s_waitcnt lgkmcnt(8)
    v_mfma_f32_16x16x32_bf16 v[192:195], v[64:67], v[32:35], v[192:195]
    v_mfma_f32_16x16x32_bf16 v[196:199], v[68:71], v[32:35], v[196:199]
    ds_read_b64_tr_b16 v[52:53], v11 offset:16384
    ds_read_b64_tr_b16 v[54:55], v11 offset:18432
    s_waitcnt lgkmcnt(8)
    v_mfma_f32_16x16x32_bf16 v[200:203], v[64:67], v[36:39], v[200:203]
    v_mfma_f32_16x16x32_bf16 v[204:207], v[68:71], v[36:39], v[204:207]
    ds_read_b64_tr_b16 v[56:57], v12 offset:16384
    ds_read_b64_tr_b16 v[58:59], v12 offset:18432
    s_waitcnt lgkmcnt(8)
    v_mfma_f32_16x16x32_bf16 v[128:131], v[72:75], v[40:43], v[128:131]
    v_mfma_f32_16x16x32_bf16 v[132:135], v[76:79], v[40:43], v[132:135]
    ds_read_b64_tr_b16 v[60:61], v13 offset:16384
    ds_read_b64_tr_b16 v[62:63], v13 offset:18432
    s_waitcnt lgkmcnt(8)
    v_mfma_f32_16x16x32_bf16 v[136:139], v[72:75], v[44:47], v[136:139]
    v_mfma_f32_16x16x32_bf16 v[140:143], v[76:79], v[44:47], v[140:143]
    ds_read_b64_tr_b16 v[32:33], v14 offset:16384
    ds_read_b64_tr_b16 v[34:35], v14 offset:18432
    s_waitcnt lgkmcnt(8)
    v_mfma_f32_16x16x32_bf16 v[144:147], v[72:75], v[48:51], v[144:147]
    v_mfma_f32_16x16x32_bf16 v[148:151], v[76:79], v[48:51], v[148:151]
    ds_read_b64_tr_b16 v[36:37], v15 offset:16384
    ds_read_b64_tr_b16 v[38:39], v15 offset:18432
    s_waitcnt lgkmcnt(8)
    v_mfma_f32_16x16x32_bf16 v[152:155], v[72:75], v[52:55], v[152:155]
    v_mfma_f32_16x16x32_bf16 v[156:159], v[76:79], v[52:55], v[156:159]
    ds_read_b64_tr_b16 v[40:41], v16 offset:16384
    ds_read_b64_tr_b16 v[42:43], v16 offset:18432
    s_waitcnt lgkmcnt(8)
    v_mfma_f32_16x16x32_bf16 v[160:163], v[72:75], v[56:59], v[160:163]
    v_mfma_f32_16x16x32_bf16 v[164:167], v[76:79], v[56:59], v[164:167]
    ds_read_b64_tr_b16 v[44:45], v17 offset:16384
    ds_read_b64_tr_b16 v[46:47], v17 offset:18432
    s_waitcnt lgkmcnt(8)
    v_mfma_f32_16x16x32_bf16 v[168:171], v[72:75], v[60:63], v[168:171]
    v_mfma_f32_16x16x32_bf16 v[172:175], v[76:79], v[60:63], v[172:175]
    s_waitcnt vmcnt(10)
    s_waitcnt vmcnt(8)
    s_barrier
    s_add_u32 m0, s32, 0
    s_add_u32 s34, s31, 2211840
    buffer_load_dwordx4 v6, s[16:19], s34 offen lds
    s_add_u32 m0, s32, 2048
    s_add_u32 s34, s31, 2227200
    buffer_load_dwordx4 v6, s[16:19], s34 offen lds
    s_add_u32 m0, s76, 4096
    s_add_u32 s34, s77, 1152
    buffer_load_dwordx4 v30, s[12:15], s34 offen lds
    s_add_u32 m0, s76, 5120
    s_add_u32 s34, s77, 11392
    buffer_load_dwordx4 v31, s[12:15], s34 offen lds
    ds_read_b64_tr_b16 v[48:49], v8 offset:32768
    ds_read_b64_tr_b16 v[50:51], v8 offset:34816
    ds_read_b128 v[80:83], v28 offset:12288
    s_waitcnt lgkmcnt(9)
    v_mfma_f32_16x16x32_bf16 v[176:179], v[72:75], v[32:35], v[176:179]
    v_mfma_f32_16x16x32_bf16 v[180:183], v[76:79], v[32:35], v[180:183]
    ds_read_b64_tr_b16 v[52:53], v9 offset:32768
    ds_read_b64_tr_b16 v[54:55], v9 offset:34816
    ds_read_b128 v[84:87], v28 offset:14336
    s_waitcnt lgkmcnt(10)
    v_mfma_f32_16x16x32_bf16 v[184:187], v[72:75], v[36:39], v[184:187]
    v_mfma_f32_16x16x32_bf16 v[188:191], v[76:79], v[36:39], v[188:191]
    ds_read_b64_tr_b16 v[56:57], v10 offset:32768
    ds_read_b64_tr_b16 v[58:59], v10 offset:34816
    ds_read_b128 v[88:91], v29 offset:12288
    s_waitcnt lgkmcnt(11)
    v_mfma_f32_16x16x32_bf16 v[192:195], v[72:75], v[40:43], v[192:195]
    v_mfma_f32_16x16x32_bf16 v[196:199], v[76:79], v[40:43], v[196:199]
    ds_read_b64_tr_b16 v[60:61], v11 offset:32768
    ds_read_b64_tr_b16 v[62:63], v11 offset:34816
    ds_read_b128 v[92:95], v29 offset:14336
    s_waitcnt lgkmcnt(12)
    v_mfma_f32_16x16x32_bf16 v[200:203], v[72:75], v[44:47], v[200:203]
    v_mfma_f32_16x16x32_bf16 v[204:207], v[76:79], v[44:47], v[204:207]
    ds_read_b64_tr_b16 v[32:33], v12 offset:32768
    ds_read_b64_tr_b16 v[34:35], v12 offset:34816
    s_waitcnt lgkmcnt(2)
    v_mfma_f32_16x16x32_bf16 v[128:131], v[80:83], v[48:51], v[128:131]
    v_mfma_f32_16x16x32_bf16 v[132:135], v[84:87], v[48:51], v[132:135]
    ds_read_b64_tr_b16 v[36:37], v13 offset:32768
    ds_read_b64_tr_b16 v[38:39], v13 offset:34816
    v_mfma_f32_16x16x32_bf16 v[136:139], v[80:83], v[52:55], v[136:139]
    v_mfma_f32_16x16x32_bf16 v[140:143], v[84:87], v[52:55], v[140:143]
    ds_read_b64_tr_b16 v[40:41], v14 offset:32768
    ds_read_b64_tr_b16 v[42:43], v14 offset:34816
    v_mfma_f32_16x16x32_bf16 v[144:147], v[80:83], v[56:59], v[144:147]
    v_mfma_f32_16x16x32_bf16 v[148:151], v[84:87], v[56:59], v[148:151]
    ds_read_b64_tr_b16 v[44:45], v15 offset:32768
    ds_read_b64_tr_b16 v[46:47], v15 offset:34816
    v_mfma_f32_16x16x32_bf16 v[152:155], v[80:83], v[60:63], v[152:155]
    v_mfma_f32_16x16x32_bf16 v[156:159], v[84:87], v[60:63], v[156:159]
    ds_read_b64_tr_b16 v[48:49], v16 offset:32768
    ds_read_b64_tr_b16 v[50:51], v16 offset:34816
    s_waitcnt lgkmcnt(8)
    v_mfma_f32_16x16x32_bf16 v[160:163], v[80:83], v[32:35], v[160:163]
    v_mfma_f32_16x16x32_bf16 v[164:167], v[84:87], v[32:35], v[164:167]
    ds_read_b64_tr_b16 v[52:53], v17 offset:32768
    ds_read_b64_tr_b16 v[54:55], v17 offset:34816
    s_waitcnt lgkmcnt(8)
    v_mfma_f32_16x16x32_bf16 v[168:171], v[80:83], v[36:39], v[168:171]
    v_mfma_f32_16x16x32_bf16 v[172:175], v[84:87], v[36:39], v[172:175]
    s_waitcnt vmcnt(10)
    s_barrier
    s_add_u32 m0, s32, 16384
    s_add_u32 s34, s31, 2334720
    buffer_load_dwordx4 v6, s[16:19], s34 offen lds
    s_add_u32 m0, s32, 18432
    s_add_u32 s34, s31, 2350080
    buffer_load_dwordx4 v6, s[16:19], s34 offen lds
    ds_read_b64_tr_b16 v[56:57], v8 offset:49152
    ds_read_b64_tr_b16 v[58:59], v8 offset:51200
    s_waitcnt lgkmcnt(8)
    v_mfma_f32_16x16x32_bf16 v[176:179], v[80:83], v[40:43], v[176:179]
    v_mfma_f32_16x16x32_bf16 v[180:183], v[84:87], v[40:43], v[180:183]
    ds_read_b64_tr_b16 v[60:61], v9 offset:49152
    ds_read_b64_tr_b16 v[62:63], v9 offset:51200
    s_waitcnt lgkmcnt(8)
    v_mfma_f32_16x16x32_bf16 v[184:187], v[80:83], v[44:47], v[184:187]
    v_mfma_f32_16x16x32_bf16 v[188:191], v[84:87], v[44:47], v[188:191]
    ds_read_b64_tr_b16 v[32:33], v10 offset:49152
    ds_read_b64_tr_b16 v[34:35], v10 offset:51200
    s_waitcnt lgkmcnt(8)
    v_mfma_f32_16x16x32_bf16 v[192:195], v[80:83], v[48:51], v[192:195]
    v_mfma_f32_16x16x32_bf16 v[196:199], v[84:87], v[48:51], v[196:199]
    ds_read_b64_tr_b16 v[36:37], v11 offset:49152
    ds_read_b64_tr_b16 v[38:39], v11 offset:51200
    s_waitcnt lgkmcnt(8)
    v_mfma_f32_16x16x32_bf16 v[200:203], v[80:83], v[52:55], v[200:203]
    v_mfma_f32_16x16x32_bf16 v[204:207], v[84:87], v[52:55], v[204:207]
    ds_read_b64_tr_b16 v[40:41], v12 offset:49152
    ds_read_b64_tr_b16 v[42:43], v12 offset:51200
    s_waitcnt lgkmcnt(8)
    v_mfma_f32_16x16x32_bf16 v[128:131], v[88:91], v[56:59], v[128:131]
    v_mfma_f32_16x16x32_bf16 v[132:135], v[92:95], v[56:59], v[132:135]
    ds_read_b64_tr_b16 v[44:45], v13 offset:49152
    ds_read_b64_tr_b16 v[46:47], v13 offset:51200
    s_waitcnt lgkmcnt(8)
    v_mfma_f32_16x16x32_bf16 v[136:139], v[88:91], v[60:63], v[136:139]
    v_mfma_f32_16x16x32_bf16 v[140:143], v[92:95], v[60:63], v[140:143]
    ds_read_b64_tr_b16 v[48:49], v14 offset:49152
    ds_read_b64_tr_b16 v[50:51], v14 offset:51200
    s_waitcnt lgkmcnt(8)
    v_mfma_f32_16x16x32_bf16 v[144:147], v[88:91], v[32:35], v[144:147]
    v_mfma_f32_16x16x32_bf16 v[148:151], v[92:95], v[32:35], v[148:151]
    ds_read_b64_tr_b16 v[52:53], v15 offset:49152
    ds_read_b64_tr_b16 v[54:55], v15 offset:51200
    s_waitcnt lgkmcnt(8)
    v_mfma_f32_16x16x32_bf16 v[152:155], v[88:91], v[36:39], v[152:155]
    v_mfma_f32_16x16x32_bf16 v[156:159], v[92:95], v[36:39], v[156:159]
    ds_read_b64_tr_b16 v[56:57], v16 offset:49152
    ds_read_b64_tr_b16 v[58:59], v16 offset:51200
    s_waitcnt lgkmcnt(8)
    v_mfma_f32_16x16x32_bf16 v[160:163], v[88:91], v[40:43], v[160:163]
    v_mfma_f32_16x16x32_bf16 v[164:167], v[92:95], v[40:43], v[164:167]
    ds_read_b64_tr_b16 v[60:61], v17 offset:49152
    ds_read_b64_tr_b16 v[62:63], v17 offset:51200
    s_waitcnt lgkmcnt(8)
    v_mfma_f32_16x16x32_bf16 v[168:171], v[88:91], v[44:47], v[168:171]
    v_mfma_f32_16x16x32_bf16 v[172:175], v[92:95], v[44:47], v[172:175]
    s_waitcnt vmcnt(10)
    s_waitcnt vmcnt(8)
    s_barrier
    ds_read_b64_tr_b16 v[32:33], v18 offset:0
    ds_read_b64_tr_b16 v[34:35], v18 offset:2048
    ds_read_b128 v[64:67], v28 offset:0
    s_waitcnt lgkmcnt(9)
    v_mfma_f32_16x16x32_bf16 v[176:179], v[88:91], v[48:51], v[176:179]
    v_mfma_f32_16x16x32_bf16 v[180:183], v[92:95], v[48:51], v[180:183]
    ds_read_b64_tr_b16 v[36:37], v19 offset:0
    ds_read_b64_tr_b16 v[38:39], v19 offset:2048
    ds_read_b128 v[68:71], v28 offset:2048
    s_waitcnt lgkmcnt(10)
    v_mfma_f32_16x16x32_bf16 v[184:187], v[88:91], v[52:55], v[184:187]
    v_mfma_f32_16x16x32_bf16 v[188:191], v[92:95], v[52:55], v[188:191]
    ds_read_b64_tr_b16 v[40:41], v20 offset:0
    ds_read_b64_tr_b16 v[42:43], v20 offset:2048
    ds_read_b128 v[72:75], v29 offset:0
    s_waitcnt lgkmcnt(11)
    v_mfma_f32_16x16x32_bf16 v[192:195], v[88:91], v[56:59], v[192:195]
    v_mfma_f32_16x16x32_bf16 v[196:199], v[92:95], v[56:59], v[196:199]
    ds_read_b64_tr_b16 v[44:45], v21 offset:0
    ds_read_b64_tr_b16 v[46:47], v21 offset:2048
    ds_read_b128 v[76:79], v29 offset:2048
    s_waitcnt lgkmcnt(12)
    v_mfma_f32_16x16x32_bf16 v[200:203], v[88:91], v[60:63], v[200:203]
    v_mfma_f32_16x16x32_bf16 v[204:207], v[92:95], v[60:63], v[204:207]
    ds_read_b64_tr_b16 v[48:49], v22 offset:0
    ds_read_b64_tr_b16 v[50:51], v22 offset:2048
    s_waitcnt lgkmcnt(2)
    v_mfma_f32_16x16x32_bf16 v[128:131], v[64:67], v[32:35], v[128:131]
    v_mfma_f32_16x16x32_bf16 v[132:135], v[68:71], v[32:35], v[132:135]
    ds_read_b64_tr_b16 v[52:53], v23 offset:0
    ds_read_b64_tr_b16 v[54:55], v23 offset:2048
    v_mfma_f32_16x16x32_bf16 v[136:139], v[64:67], v[36:39], v[136:139]
    v_mfma_f32_16x16x32_bf16 v[140:143], v[68:71], v[36:39], v[140:143]
    ds_read_b64_tr_b16 v[56:57], v24 offset:0
    ds_read_b64_tr_b16 v[58:59], v24 offset:2048
    v_mfma_f32_16x16x32_bf16 v[144:147], v[64:67], v[40:43], v[144:147]
    v_mfma_f32_16x16x32_bf16 v[148:151], v[68:71], v[40:43], v[148:151]
    ds_read_b64_tr_b16 v[60:61], v25 offset:0
    ds_read_b64_tr_b16 v[62:63], v25 offset:2048
    v_mfma_f32_16x16x32_bf16 v[152:155], v[64:67], v[44:47], v[152:155]
    v_mfma_f32_16x16x32_bf16 v[156:159], v[68:71], v[44:47], v[156:159]
    ds_read_b64_tr_b16 v[32:33], v26 offset:0
    ds_read_b64_tr_b16 v[34:35], v26 offset:2048
    s_waitcnt lgkmcnt(8)
    v_mfma_f32_16x16x32_bf16 v[160:163], v[64:67], v[48:51], v[160:163]
    v_mfma_f32_16x16x32_bf16 v[164:167], v[68:71], v[48:51], v[164:167]
    ds_read_b64_tr_b16 v[36:37], v27 offset:0
    ds_read_b64_tr_b16 v[38:39], v27 offset:2048
    s_waitcnt lgkmcnt(8)
    v_mfma_f32_16x16x32_bf16 v[168:171], v[64:67], v[52:55], v[168:171]
    v_mfma_f32_16x16x32_bf16 v[172:175], v[68:71], v[52:55], v[172:175]
    s_waitcnt vmcnt(6)
    s_barrier
    ds_read_b64_tr_b16 v[40:41], v18 offset:16384
    ds_read_b64_tr_b16 v[42:43], v18 offset:18432
    s_waitcnt lgkmcnt(8)
    v_mfma_f32_16x16x32_bf16 v[176:179], v[64:67], v[56:59], v[176:179]
    v_mfma_f32_16x16x32_bf16 v[180:183], v[68:71], v[56:59], v[180:183]
    ds_read_b64_tr_b16 v[44:45], v19 offset:16384
    ds_read_b64_tr_b16 v[46:47], v19 offset:18432
    s_waitcnt lgkmcnt(8)
    v_mfma_f32_16x16x32_bf16 v[184:187], v[64:67], v[60:63], v[184:187]
    v_mfma_f32_16x16x32_bf16 v[188:191], v[68:71], v[60:63], v[188:191]
    ds_read_b64_tr_b16 v[48:49], v20 offset:16384
    ds_read_b64_tr_b16 v[50:51], v20 offset:18432
    s_waitcnt lgkmcnt(8)
    v_mfma_f32_16x16x32_bf16 v[192:195], v[64:67], v[32:35], v[192:195]
    v_mfma_f32_16x16x32_bf16 v[196:199], v[68:71], v[32:35], v[196:199]
    ds_read_b64_tr_b16 v[52:53], v21 offset:16384
    ds_read_b64_tr_b16 v[54:55], v21 offset:18432
    s_waitcnt lgkmcnt(8)
    v_mfma_f32_16x16x32_bf16 v[200:203], v[64:67], v[36:39], v[200:203]
    v_mfma_f32_16x16x32_bf16 v[204:207], v[68:71], v[36:39], v[204:207]
    ds_read_b64_tr_b16 v[56:57], v22 offset:16384
    ds_read_b64_tr_b16 v[58:59], v22 offset:18432
    s_waitcnt lgkmcnt(8)
    v_mfma_f32_16x16x32_bf16 v[128:131], v[72:75], v[40:43], v[128:131]
    v_mfma_f32_16x16x32_bf16 v[132:135], v[76:79], v[40:43], v[132:135]
    ds_read_b64_tr_b16 v[60:61], v23 offset:16384
    ds_read_b64_tr_b16 v[62:63], v23 offset:18432
    s_waitcnt lgkmcnt(8)
    v_mfma_f32_16x16x32_bf16 v[136:139], v[72:75], v[44:47], v[136:139]
    v_mfma_f32_16x16x32_bf16 v[140:143], v[76:79], v[44:47], v[140:143]
    ds_read_b64_tr_b16 v[32:33], v24 offset:16384
    ds_read_b64_tr_b16 v[34:35], v24 offset:18432
    s_waitcnt lgkmcnt(8)
    v_mfma_f32_16x16x32_bf16 v[144:147], v[72:75], v[48:51], v[144:147]
    v_mfma_f32_16x16x32_bf16 v[148:151], v[76:79], v[48:51], v[148:151]
    ds_read_b64_tr_b16 v[36:37], v25 offset:16384
    ds_read_b64_tr_b16 v[38:39], v25 offset:18432
    s_waitcnt lgkmcnt(8)
    v_mfma_f32_16x16x32_bf16 v[152:155], v[72:75], v[52:55], v[152:155]
    v_mfma_f32_16x16x32_bf16 v[156:159], v[76:79], v[52:55], v[156:159]
    ds_read_b64_tr_b16 v[40:41], v26 offset:16384
    ds_read_b64_tr_b16 v[42:43], v26 offset:18432
    s_waitcnt lgkmcnt(8)
    v_mfma_f32_16x16x32_bf16 v[160:163], v[72:75], v[56:59], v[160:163]
    v_mfma_f32_16x16x32_bf16 v[164:167], v[76:79], v[56:59], v[164:167]
    ds_read_b64_tr_b16 v[44:45], v27 offset:16384
    ds_read_b64_tr_b16 v[46:47], v27 offset:18432
    s_waitcnt lgkmcnt(8)
    v_mfma_f32_16x16x32_bf16 v[168:171], v[72:75], v[60:63], v[168:171]
    v_mfma_f32_16x16x32_bf16 v[172:175], v[76:79], v[60:63], v[172:175]
    s_waitcnt vmcnt(4)
    s_waitcnt vmcnt(2)
    s_barrier
    ds_read_b64_tr_b16 v[48:49], v8 offset:0
    ds_read_b64_tr_b16 v[50:51], v8 offset:2048
    ds_read_b128 v[80:83], v28 offset:4096
    s_waitcnt lgkmcnt(9)
    v_mfma_f32_16x16x32_bf16 v[176:179], v[72:75], v[32:35], v[176:179]
    v_mfma_f32_16x16x32_bf16 v[180:183], v[76:79], v[32:35], v[180:183]
    ds_read_b64_tr_b16 v[52:53], v9 offset:0
    ds_read_b64_tr_b16 v[54:55], v9 offset:2048
    ds_read_b128 v[84:87], v28 offset:6144
    s_waitcnt lgkmcnt(10)
    v_mfma_f32_16x16x32_bf16 v[184:187], v[72:75], v[36:39], v[184:187]
    v_mfma_f32_16x16x32_bf16 v[188:191], v[76:79], v[36:39], v[188:191]
    ds_read_b64_tr_b16 v[56:57], v10 offset:0
    ds_read_b64_tr_b16 v[58:59], v10 offset:2048
    ds_read_b128 v[88:91], v29 offset:4096
    s_waitcnt lgkmcnt(11)
    v_mfma_f32_16x16x32_bf16 v[192:195], v[72:75], v[40:43], v[192:195]
    v_mfma_f32_16x16x32_bf16 v[196:199], v[76:79], v[40:43], v[196:199]
    ds_read_b64_tr_b16 v[60:61], v11 offset:0
    ds_read_b64_tr_b16 v[62:63], v11 offset:2048
    ds_read_b128 v[92:95], v29 offset:6144
    s_waitcnt lgkmcnt(12)
    v_mfma_f32_16x16x32_bf16 v[200:203], v[72:75], v[44:47], v[200:203]
    v_mfma_f32_16x16x32_bf16 v[204:207], v[76:79], v[44:47], v[204:207]
    ds_read_b64_tr_b16 v[32:33], v12 offset:0
    ds_read_b64_tr_b16 v[34:35], v12 offset:2048
    s_waitcnt lgkmcnt(2)
    v_mfma_f32_16x16x32_bf16 v[128:131], v[80:83], v[48:51], v[128:131]
    v_mfma_f32_16x16x32_bf16 v[132:135], v[84:87], v[48:51], v[132:135]
    ds_read_b64_tr_b16 v[36:37], v13 offset:0
    ds_read_b64_tr_b16 v[38:39], v13 offset:2048
    v_mfma_f32_16x16x32_bf16 v[136:139], v[80:83], v[52:55], v[136:139]
    v_mfma_f32_16x16x32_bf16 v[140:143], v[84:87], v[52:55], v[140:143]
    ds_read_b64_tr_b16 v[40:41], v14 offset:0
    ds_read_b64_tr_b16 v[42:43], v14 offset:2048
    v_mfma_f32_16x16x32_bf16 v[144:147], v[80:83], v[56:59], v[144:147]
    v_mfma_f32_16x16x32_bf16 v[148:151], v[84:87], v[56:59], v[148:151]
    ds_read_b64_tr_b16 v[44:45], v15 offset:0
    ds_read_b64_tr_b16 v[46:47], v15 offset:2048
    v_mfma_f32_16x16x32_bf16 v[152:155], v[80:83], v[60:63], v[152:155]
    v_mfma_f32_16x16x32_bf16 v[156:159], v[84:87], v[60:63], v[156:159]
    ds_read_b64_tr_b16 v[48:49], v16 offset:0
    ds_read_b64_tr_b16 v[50:51], v16 offset:2048
    s_waitcnt lgkmcnt(8)
    v_mfma_f32_16x16x32_bf16 v[160:163], v[80:83], v[32:35], v[160:163]
    v_mfma_f32_16x16x32_bf16 v[164:167], v[84:87], v[32:35], v[164:167]
    ds_read_b64_tr_b16 v[52:53], v17 offset:0
    ds_read_b64_tr_b16 v[54:55], v17 offset:2048
    s_waitcnt lgkmcnt(8)
    v_mfma_f32_16x16x32_bf16 v[168:171], v[80:83], v[36:39], v[168:171]
    v_mfma_f32_16x16x32_bf16 v[172:175], v[84:87], v[36:39], v[172:175]
    s_waitcnt vmcnt(0)
    s_barrier
    s_lshl_b32 s88, s28, 3
    s_add_u32 s88, s88, s29
    s_sub_u32 s88, s88, 8
    s_lshl_b32 s88, s88, 3
    s_add_u32 s88, s88, s30
    s_cmp_lt_u32 s29, 8
    s_cselect_b32 s88, 0xffff, s88
    s_cmp_ge_u32 s88, 592
    s_cbranch_scc1 K1_nopp_kv
    s_cmp_lt_u32 s88, 432
    s_cselect_b32 s80, s90, s92
    s_cselect_b32 s81, s91, s93
    s_mov_b32 s82, 819200
    s_cselect_b32 s82, 2211840, s82
    s_mov_b32 s83, 0x00020000
    s_mov_b32 s84, 19398656
    s_cselect_b32 s84, 16777216, s84
    s_mov_b32 s86, 819200
    s_cselect_b32 s86, 2211840, s86
    s_cselect_b32 s89, 0, 432
    s_cselect_b32 s33, 54, 20
    s_add_u32 s84, s84, s10
    s_addc_u32 s85, s11, 0
    s_mov_b32 s87, 0x00020000
    s_sub_u32 s89, s88, s89
    s_lshr_b32 s34, s89, 3
    s_and_b32 s89, s89, 7
    s_mul_i32 s33, s33, s89
    s_add_u32 s33, s33, s34
    s_mul_i32 s34, s34, 40960
    s_mul_i32 s89, s89, 160
    s_add_u32 s34, s34, s89
    s_mul_i32 s89, s33, 5120
    v_add_u32 v125, 0, v1
    v_mul_u32_u24 v126, 6554, v125
    v_lshrrev_b32 v126, 16, v126
    v_mul_u32_u24 v127, 10, v126
    v_sub_u32 v127, v125, v127
    v_mul_u32_u24 v126, 1280, v126
    v_lshlrev_b32 v127, 4, v127
    v_add_u32 v120, v126, v127
    v_add_u32 v125, 64, v1
    v_mul_u32_u24 v126, 6554, v125
    v_lshrrev_b32 v126, 16, v126
    v_mul_u32_u24 v127, 10, v126
    v_sub_u32 v127, v125, v127
    v_mul_u32_u24 v126, 1280, v126
    v_lshlrev_b32 v127, 4, v127
    v_add_u32 v121, v126, v127
    v_add_u32 v125, 128, v1
    v_mul_u32_u24 v126, 6554, v125
    v_lshrrev_b32 v126, 16, v126
    v_mul_u32_u24 v127, 10, v126
    v_sub_u32 v127, v125, v127
    v_mul_u32_u24 v126, 1280, v126
    v_lshlrev_b32 v127, 4, v127
    v_add_u32 v122, v126, v127
    v_add_u32 v125, 192, v1
    v_mul_u32_u24 v126, 6554, v125
    v_lshrrev_b32 v126, 16, v126
    v_mul_u32_u24 v127, 10, v126
    v_sub_u32 v127, v125, v127
    v_mul_u32_u24 v126, 1280, v126
    v_lshlrev_b32 v127, 4, v127
    v_add_u32 v123, v126, v127
    v_add_u32 v125, 256, v1
    v_mul_u32_u24 v126, 6554, v125
    v_lshrrev_b32 v126, 16, v126
    v_mul_u32_u24 v127, 10, v126
    v_sub_u32 v127, v125, v127
    v_mul_u32_u24 v126, 1280, v126
    v_lshlrev_b32 v127, 4, v127
    v_add_u32 v124, v126, v127
    s_add_u32 m0, s78, 0
    s_nop 0
    buffer_load_dwordx4 v120, s[80:83], s34 offen lds
    s_add_u32 m0, s78, 1024
    s_nop 0
    buffer_load_dwordx4 v121, s[80:83], s34 offen lds
    s_add_u32 m0, s78, 2048
    s_nop 0
    buffer_load_dwordx4 v122, s[80:83], s34 offen lds
    s_add_u32 m0, s78, 3072
    s_nop 0
    buffer_load_dwordx4 v123, s[80:83], s34 offen lds
    s_add_u32 m0, s78, 4096
    s_nop 0
    buffer_load_dwordx4 v124, s[80:83], s34 offen lds
K1_nopp_kv:
    ds_read_b64_tr_b16 v[56:57], v8 offset:16384
    ds_read_b64_tr_b16 v[58:59], v8 offset:18432
    s_waitcnt lgkmcnt(8)
    v_mfma_f32_16x16x32_bf16 v[176:179], v[80:83], v[40:43], v[176:179]
    v_mfma_f32_16x16x32_bf16 v[180:183], v[84:87], v[40:43], v[180:183]
    ds_read_b64_tr_b16 v[60:61], v9 offset:16384
    ds_read_b64_tr_b16 v[62:63], v9 offset:18432
    s_waitcnt lgkmcnt(8)
    v_mfma_f32_16x16x32_bf16 v[184:187], v[80:83], v[44:47], v[184:187]
    v_mfma_f32_16x16x32_bf16 v[188:191], v[84:87], v[44:47], v[188:191]
    ds_read_b64_tr_b16 v[32:33], v10 offset:16384
    ds_read_b64_tr_b16 v[34:35], v10 offset:18432
    s_waitcnt lgkmcnt(8)
    v_mfma_f32_16x16x32_bf16 v[192:195], v[80:83], v[48:51], v[192:195]
    v_mfma_f32_16x16x32_bf16 v[196:199], v[84:87], v[48:51], v[196:199]
    ds_read_b64_tr_b16 v[36:37], v11 offset:16384
    ds_read_b64_tr_b16 v[38:39], v11 offset:18432
    s_waitcnt lgkmcnt(8)
    v_mfma_f32_16x16x32_bf16 v[200:203], v[80:83], v[52:55], v[200:203]
    v_mfma_f32_16x16x32_bf16 v[204:207], v[84:87], v[52:55], v[204:207]
    ds_read_b64_tr_b16 v[40:41], v12 offset:16384
    ds_read_b64_tr_b16 v[42:43], v12 offset:18432
    s_waitcnt lgkmcnt(8)
    v_mfma_f32_16x16x32_bf16 v[128:131], v[88:91], v[56:59], v[128:131]
    v_mfma_f32_16x16x32_bf16 v[132:135], v[92:95], v[56:59], v[132:135]
    ds_read_b64_tr_b16 v[44:45], v13 offset:16384
    ds_read_b64_tr_b16 v[46:47], v13 offset:18432
    s_waitcnt lgkmcnt(8)
    v_mfma_f32_16x16x32_bf16 v[136:139], v[88:91], v[60:63], v[136:139]
    v_mfma_f32_16x16x32_bf16 v[140:143], v[92:95], v[60:63], v[140:143]
    ds_read_b64_tr_b16 v[48:49], v14 offset:16384
    ds_read_b64_tr_b16 v[50:51], v14 offset:18432
    s_waitcnt lgkmcnt(8)
    v_mfma_f32_16x16x32_bf16 v[144:147], v[88:91], v[32:35], v[144:147]
    v_mfma_f32_16x16x32_bf16 v[148:151], v[92:95], v[32:35], v[148:151]
    ds_read_b64_tr_b16 v[52:53], v15 offset:16384
    ds_read_b64_tr_b16 v[54:55], v15 offset:18432
    s_waitcnt lgkmcnt(8)
    v_mfma_f32_16x16x32_bf16 v[152:155], v[88:91], v[36:39], v[152:155]
    v_mfma_f32_16x16x32_bf16 v[156:159], v[92:95], v[36:39], v[156:159]
    ds_read_b64_tr_b16 v[56:57], v16 offset:16384
    ds_read_b64_tr_b16 v[58:59], v16 offset:18432
    s_waitcnt lgkmcnt(8)
    v_mfma_f32_16x16x32_bf16 v[160:163], v[88:91], v[40:43], v[160:163]
    v_mfma_f32_16x16x32_bf16 v[164:167], v[92:95], v[40:43], v[164:167]
    ds_read_b64_tr_b16 v[60:61], v17 offset:16384
    ds_read_b64_tr_b16 v[62:63], v17 offset:18432
    s_waitcnt lgkmcnt(8)
    v_mfma_f32_16x16x32_bf16 v[168:171], v[88:91], v[44:47], v[168:171]
    v_mfma_f32_16x16x32_bf16 v[172:175], v[92:95], v[44:47], v[172:175]
    s_waitcnt lgkmcnt(6)
    v_mfma_f32_16x16x32_bf16 v[176:179], v[88:91], v[48:51], v[176:179]
    v_mfma_f32_16x16x32_bf16 v[180:183], v[92:95], v[48:51], v[180:183]
    s_waitcnt lgkmcnt(4)
    v_mfma_f32_16x16x32_bf16 v[184:187], v[88:91], v[52:55], v[184:187]
    v_mfma_f32_16x16x32_bf16 v[188:191], v[92:95], v[52:55], v[188:191]
    s_waitcnt lgkmcnt(2)
    v_mfma_f32_16x16x32_bf16 v[192:195], v[88:91], v[56:59], v[192:195]
    v_mfma_f32_16x16x32_bf16 v[196:199], v[92:95], v[56:59], v[196:199]
    s_waitcnt lgkmcnt(0)
    v_mfma_f32_16x16x32_bf16 v[200:203], v[88:91], v[60:63], v[200:203]
    v_mfma_f32_16x16x32_bf16 v[204:207], v[92:95], v[60:63], v[204:207]
    s_nop 7
    s_nop 1
    v_cvt_pk_bf16_f32 v80, v128, v129
    v_cvt_pk_bf16_f32 v81, v130, v131
    v_cvt_pk_bf16_f32 v84, v136, v137
    v_cvt_pk_bf16_f32 v85, v138, v139
    v_cvt_pk_bf16_f32 v88, v144, v145
    v_cvt_pk_bf16_f32 v89, v146, v147
    v_cvt_pk_bf16_f32 v92, v152, v153
    v_cvt_pk_bf16_f32 v93, v154, v155
    v_cvt_pk_bf16_f32 v96, v160, v161
    v_cvt_pk_bf16_f32 v97, v162, v163
    v_lshlrev_b32 v8, 16, v80
    v_and_b32 v9, 0xffff0000, v80
    v_lshlrev_b32 v10, 16, v81
    v_and_b32 v11, 0xffff0000, v81
    v_lshlrev_b32 v12, 16, v84
    v_and_b32 v13, 0xffff0000, v84
    v_lshlrev_b32 v14, 16, v85
    v_and_b32 v15, 0xffff0000, v85
    v_lshlrev_b32 v16, 16, v88
    v_and_b32 v17, 0xffff0000, v88
    v_lshlrev_b32 v18, 16, v89
    v_and_b32 v19, 0xffff0000, v89
    v_lshlrev_b32 v20, 16, v92
    v_and_b32 v21, 0xffff0000, v92
    v_lshlrev_b32 v22, 16, v93
    v_and_b32 v23, 0xffff0000, v93
    v_lshlrev_b32 v24, 16, v96
    v_and_b32 v25, 0xffff0000, v96
    v_lshlrev_b32 v26, 16, v97
    v_and_b32 v27, 0xffff0000, v97
    v_mul_f32 v28, s38, v8
    v_mul_f32 v29, s38, v9
    v_mul_f32 v30, s38, v10
    v_mul_f32 v31, s38, v11
    v_mul_f32 v32, s38, v12
    v_mul_f32 v33, s38, v13
    v_mul_f32 v34, s38, v14
    v_mul_f32 v35, s38, v15
    v_mul_f32 v36, s38, v16
    v_mul_f32 v37, s38, v17
    v_mul_f32 v38, s38, v18
    v_mul_f32 v39, s38, v19
    v_mul_f32 v40, s38, v20
    v_mul_f32 v41, s38, v21
    v_mul_f32 v42, s38, v22
    v_mul_f32 v43, s38, v23
    v_mul_f32 v44, s38, v24
    v_mul_f32 v45, s38, v25
    v_mul_f32 v46, s38, v26
    v_mul_f32 v47, s38, v27
    v_exp_f32 v28, v28
    v_exp_f32 v29, v29
    v_exp_f32 v30, v30
    v_exp_f32 v31, v31
    v_exp_f32 v32, v32
    v_exp_f32 v33, v33
    v_exp_f32 v34, v34
    v_exp_f32 v35, v35
    v_exp_f32 v36, v36
    v_exp_f32 v37, v37
    v_exp_f32 v38, v38
    v_exp_f32 v39, v39
    v_exp_f32 v40, v40
    v_exp_f32 v41, v41
    v_exp_f32 v42, v42
    v_exp_f32 v43, v43
    v_exp_f32 v44, v44
    v_exp_f32 v45, v45
    v_exp_f32 v46, v46
    v_exp_f32 v47, v47
    v_add_f32 v48, 1.0, v8
    v_add_f32 v49, 1.0, v9
    v_add_f32 v50, 1.0, v10
    v_add_f32 v51, 1.0, v11
    v_add_f32 v52, 1.0, v12
    v_add_f32 v53, 1.0, v13
    v_add_f32 v54, 1.0, v14
    v_add_f32 v55, 1.0, v15
    v_add_f32 v56, 1.0, v16
    v_add_f32 v57, 1.0, v17
    v_add_f32 v58, 1.0, v18
    v_add_f32 v59, 1.0, v19
    v_add_f32 v60, 1.0, v20
    v_add_f32 v61, 1.0, v21
    v_add_f32 v62, 1.0, v22
    v_add_f32 v63, 1.0, v23
    v_add_f32 v64, 1.0, v24
    v_add_f32 v65, 1.0, v25
    v_add_f32 v66, 1.0, v26
    v_add_f32 v67, 1.0, v27
    v_cmp_gt_f32 s[40:41], v8, 0
    v_cmp_gt_f32 s[42:43], v9, 0
    v_cmp_gt_f32 s[44:45], v10, 0
    v_cmp_gt_f32 s[46:47], v11, 0
    v_cmp_gt_f32 s[48:49], v12, 0
    v_cmp_gt_f32 s[50:51], v13, 0
    v_cmp_gt_f32 s[52:53], v14, 0
    v_cmp_gt_f32 s[54:55], v15, 0
    s_nop 1
    v_cndmask_b32 v28, v28, v48, s[40:41]
    v_cndmask_b32 v29, v29, v49, s[42:43]
    v_cndmask_b32 v30, v30, v50, s[44:45]
    v_cndmask_b32 v31, v31, v51, s[46:47]
    v_cndmask_b32 v32, v32, v52, s[48:49]
    v_cndmask_b32 v33, v33, v53, s[50:51]
    v_cndmask_b32 v34, v34, v54, s[52:53]
    v_cndmask_b32 v35, v35, v55, s[54:55]
    v_cmp_gt_f32 s[40:41], v16, 0
    v_cmp_gt_f32 s[42:43], v17, 0
    v_cmp_gt_f32 s[44:45], v18, 0
    v_cmp_gt_f32 s[46:47], v19, 0
    v_cmp_gt_f32 s[48:49], v20, 0
    v_cmp_gt_f32 s[50:51], v21, 0
    v_cmp_gt_f32 s[52:53], v22, 0
    v_cmp_gt_f32 s[54:55], v23, 0
    s_nop 1
    v_cndmask_b32 v36, v36, v56, s[40:41]
    v_cndmask_b32 v37, v37, v57, s[42:43]
    v_cndmask_b32 v38, v38, v58, s[44:45]
    v_cndmask_b32 v39, v39, v59, s[46:47]
    v_cndmask_b32 v40, v40, v60, s[48:49]
    v_cndmask_b32 v41, v41, v61, s[50:51]
    v_cndmask_b32 v42, v42, v62, s[52:53]
    v_cndmask_b32 v43, v43, v63, s[54:55]
    v_cmp_gt_f32 s[40:41], v24, 0
    v_cmp_gt_f32 s[42:43], v25, 0
    v_cmp_gt_f32 s[44:45], v26, 0
    v_cmp_gt_f32 s[46:47], v27, 0
    s_nop 1
    v_cndmask_b32 v44, v44, v64, s[40:41]
    v_cndmask_b32 v45, v45, v65, s[42:43]
    v_cndmask_b32 v46, v46, v66, s[44:45]
    v_cndmask_b32 v47, v47, v67, s[46:47]
    v_cvt_pk_bf16_f32 v80, v28, v29
    v_cvt_pk_bf16_f32 v81, v30, v31
    v_cvt_pk_bf16_f32 v84, v32, v33
    v_cvt_pk_bf16_f32 v85, v34, v35
    v_cvt_pk_bf16_f32 v88, v36, v37
    v_cvt_pk_bf16_f32 v89, v38, v39
    v_cvt_pk_bf16_f32 v92, v40, v41
    v_cvt_pk_bf16_f32 v93, v42, v43
    v_cvt_pk_bf16_f32 v96, v44, v45
    v_cvt_pk_bf16_f32 v97, v46, v47
    v_lshlrev_b32 v8, 16, v80
    v_and_b32 v9, 0xffff0000, v80
    v_lshlrev_b32 v10, 16, v81
    v_and_b32 v11, 0xffff0000, v81
    v_lshlrev_b32 v12, 16, v84
    v_and_b32 v13, 0xffff0000, v84
    v_lshlrev_b32 v14, 16, v85
    v_and_b32 v15, 0xffff0000, v85
    v_lshlrev_b32 v16, 16, v88
    v_and_b32 v17, 0xffff0000, v88
    v_lshlrev_b32 v18, 16, v89
    v_and_b32 v19, 0xffff0000, v89
    v_lshlrev_b32 v20, 16, v92
    v_and_b32 v21, 0xffff0000, v92
    v_lshlrev_b32 v22, 16, v93
    v_and_b32 v23, 0xffff0000, v93
    v_lshlrev_b32 v24, 16, v96
    v_and_b32 v25, 0xffff0000, v96
    v_lshlrev_b32 v26, 16, v97
    v_and_b32 v27, 0xffff0000, v97
    v_add_f32 v8, s39, v8
    v_add_f32 v9, s39, v9
    v_add_f32 v10, s39, v10
    v_add_f32 v11, s39, v11
    v_add_f32 v12, s39, v12
    v_add_f32 v13, s39, v13
    v_add_f32 v14, s39, v14
    v_add_f32 v15, s39, v15
    v_add_f32 v16, s39, v16
    v_add_f32 v17, s39, v17
    v_add_f32 v18, s39, v18
    v_add_f32 v19, s39, v19
    v_add_f32 v20, s39, v20
    v_add_f32 v21, s39, v21
    v_add_f32 v22, s39, v22
    v_add_f32 v23, s39, v23
    v_add_f32 v24, s39, v24
    v_add_f32 v25, s39, v25
    v_add_f32 v26, s39, v26
    v_add_f32 v27, s39, v27
    v_cvt_pk_bf16_f32 v80, v8, v9
    v_cvt_pk_bf16_f32 v81, v10, v11
    v_cvt_pk_bf16_f32 v84, v12, v13
    v_cvt_pk_bf16_f32 v85, v14, v15
    v_cvt_pk_bf16_f32 v88, v16, v17
    v_cvt_pk_bf16_f32 v89, v18, v19
    v_cvt_pk_bf16_f32 v92, v20, v21
    v_cvt_pk_bf16_f32 v93, v22, v23
    v_cvt_pk_bf16_f32 v96, v24, v25
    v_cvt_pk_bf16_f32 v97, v26, v27
    v_cvt_pk_bf16_f32 v82, v132, v133
    v_cvt_pk_bf16_f32 v83, v134, v135
    v_cvt_pk_bf16_f32 v86, v140, v141
    v_cvt_pk_bf16_f32 v87, v142, v143
    v_cvt_pk_bf16_f32 v90, v148, v149
    v_cvt_pk_bf16_f32 v91, v150, v151
    v_cvt_pk_bf16_f32 v94, v156, v157
    v_cvt_pk_bf16_f32 v95, v158, v159
    v_cvt_pk_bf16_f32 v98, v164, v165
    v_cvt_pk_bf16_f32 v99, v166, v167
    v_lshlrev_b32 v8, 16, v82
    v_and_b32 v9, 0xffff0000, v82
    v_lshlrev_b32 v10, 16, v83
    v_and_b32 v11, 0xffff0000, v83
    v_lshlrev_b32 v12, 16, v86
    v_and_b32 v13, 0xffff0000, v86
    v_lshlrev_b32 v14, 16, v87
    v_and_b32 v15, 0xffff0000, v87
    v_lshlrev_b32 v16, 16, v90
    v_and_b32 v17, 0xffff0000, v90
    v_lshlrev_b32 v18, 16, v91
    v_and_b32 v19, 0xffff0000, v91
    v_lshlrev_b32 v20, 16, v94
    v_and_b32 v21, 0xffff0000, v94
    v_lshlrev_b32 v22, 16, v95
    v_and_b32 v23, 0xffff0000, v95
    v_lshlrev_b32 v24, 16, v98
    v_and_b32 v25, 0xffff0000, v98
    v_lshlrev_b32 v26, 16, v99
    v_and_b32 v27, 0xffff0000, v99
    v_mul_f32 v28, s38, v8
    v_mul_f32 v29, s38, v9
    v_mul_f32 v30, s38, v10
    v_mul_f32 v31, s38, v11
    v_mul_f32 v32, s38, v12
    v_mul_f32 v33, s38, v13
    v_mul_f32 v34, s38, v14
    v_mul_f32 v35, s38, v15
    v_mul_f32 v36, s38, v16
    v_mul_f32 v37, s38, v17
    v_mul_f32 v38, s38, v18
    v_mul_f32 v39, s38, v19
    v_mul_f32 v40, s38, v20
    v_mul_f32 v41, s38, v21
    v_mul_f32 v42, s38, v22
    v_mul_f32 v43, s38, v23
    v_mul_f32 v44, s38, v24
    v_mul_f32 v45, s38, v25
    v_mul_f32 v46, s38, v26
    v_mul_f32 v47, s38, v27
    v_exp_f32 v28, v28
    v_exp_f32 v29, v29
    v_exp_f32 v30, v30
    v_exp_f32 v31, v31
    v_exp_f32 v32, v32
    v_exp_f32 v33, v33
    v_exp_f32 v34, v34
    v_exp_f32 v35, v35
    v_exp_f32 v36, v36
    v_exp_f32 v37, v37
    v_exp_f32 v38, v38
    v_exp_f32 v39, v39
    v_exp_f32 v40, v40
    v_exp_f32 v41, v41
    v_exp_f32 v42, v42
    v_exp_f32 v43, v43
    v_exp_f32 v44, v44
    v_exp_f32 v45, v45
    v_exp_f32 v46, v46
    v_exp_f32 v47, v47
    v_add_f32 v48, 1.0, v8
    v_add_f32 v49, 1.0, v9
    v_add_f32 v50, 1.0, v10
    v_add_f32 v51, 1.0, v11
    v_add_f32 v52, 1.0, v12
    v_add_f32 v53, 1.0, v13
    v_add_f32 v54, 1.0, v14
    v_add_f32 v55, 1.0, v15
    v_add_f32 v56, 1.0, v16
    v_add_f32 v57, 1.0, v17
    v_add_f32 v58, 1.0, v18
    v_add_f32 v59, 1.0, v19
    v_add_f32 v60, 1.0, v20
    v_add_f32 v61, 1.0, v21
    v_add_f32 v62, 1.0, v22
    v_add_f32 v63, 1.0, v23
    v_add_f32 v64, 1.0, v24
    v_add_f32 v65, 1.0, v25
    v_add_f32 v66, 1.0, v26
    v_add_f32 v67, 1.0, v27
    v_cmp_gt_f32 s[40:41], v8, 0
    v_cmp_gt_f32 s[42:43], v9, 0
    v_cmp_gt_f32 s[44:45], v10, 0
    v_cmp_gt_f32 s[46:47], v11, 0
    v_cmp_gt_f32 s[48:49], v12, 0
    v_cmp_gt_f32 s[50:51], v13, 0
    v_cmp_gt_f32 s[52:53], v14, 0
    v_cmp_gt_f32 s[54:55], v15, 0
    s_nop 1
    v_cndmask_b32 v28, v28, v48, s[40:41]
    v_cndmask_b32 v29, v29, v49, s[42:43]
    v_cndmask_b32 v30, v30, v50, s[44:45]
    v_cndmask_b32 v31, v31, v51, s[46:47]
    v_cndmask_b32 v32, v32, v52, s[48:49]
    v_cndmask_b32 v33, v33, v53, s[50:51]
    v_cndmask_b32 v34, v34, v54, s[52:53]
    v_cndmask_b32 v35, v35, v55, s[54:55]
    v_cmp_gt_f32 s[40:41], v16, 0
    v_cmp_gt_f32 s[42:43], v17, 0
    v_cmp_gt_f32 s[44:45], v18, 0
    v_cmp_gt_f32 s[46:47], v19, 0
    v_cmp_gt_f32 s[48:49], v20, 0
    v_cmp_gt_f32 s[50:51], v21, 0
    v_cmp_gt_f32 s[52:53], v22, 0
    v_cmp_gt_f32 s[54:55], v23, 0
    s_nop 1
    v_cndmask_b32 v36, v36, v56, s[40:41]
    v_cndmask_b32 v37, v37, v57, s[42:43]
    v_cndmask_b32 v38, v38, v58, s[44:45]
    v_cndmask_b32 v39, v39, v59, s[46:47]
    v_cndmask_b32 v40, v40, v60, s[48:49]
    v_cndmask_b32 v41, v41, v61, s[50:51]
    v_cndmask_b32 v42, v42, v62, s[52:53]
    v_cndmask_b32 v43, v43, v63, s[54:55]
    v_cmp_gt_f32 s[40:41], v24, 0
    v_cmp_gt_f32 s[42:43], v25, 0
    v_cmp_gt_f32 s[44:45], v26, 0
    v_cmp_gt_f32 s[46:47], v27, 0
    s_nop 1
    v_cndmask_b32 v44, v44, v64, s[40:41]
    v_cndmask_b32 v45, v45, v65, s[42:43]
    v_cndmask_b32 v46, v46, v66, s[44:45]
    v_cndmask_b32 v47, v47, v67, s[46:47]
    v_cvt_pk_bf16_f32 v82, v28, v29
    v_cvt_pk_bf16_f32 v83, v30, v31
    v_cvt_pk_bf16_f32 v86, v32, v33
    v_cvt_pk_bf16_f32 v87, v34, v35
    v_cvt_pk_bf16_f32 v90, v36, v37
    v_cvt_pk_bf16_f32 v91, v38, v39
    v_cvt_pk_bf16_f32 v94, v40, v41
    v_cvt_pk_bf16_f32 v95, v42, v43
    v_cvt_pk_bf16_f32 v98, v44, v45
    v_cvt_pk_bf16_f32 v99, v46, v47
    v_lshlrev_b32 v8, 16, v82
    v_and_b32 v9, 0xffff0000, v82
    v_lshlrev_b32 v10, 16, v83
    v_and_b32 v11, 0xffff0000, v83
    v_lshlrev_b32 v12, 16, v86
    v_and_b32 v13, 0xffff0000, v86
    v_lshlrev_b32 v14, 16, v87
    v_and_b32 v15, 0xffff0000, v87
    v_lshlrev_b32 v16, 16, v90
    v_and_b32 v17, 0xffff0000, v90
    v_lshlrev_b32 v18, 16, v91
    v_and_b32 v19, 0xffff0000, v91
    v_lshlrev_b32 v20, 16, v94
    v_and_b32 v21, 0xffff0000, v94
    v_lshlrev_b32 v22, 16, v95
    v_and_b32 v23, 0xffff0000, v95
    v_lshlrev_b32 v24, 16, v98
    v_and_b32 v25, 0xffff0000, v98
    v_lshlrev_b32 v26, 16, v99
    v_and_b32 v27, 0xffff0000, v99
    v_add_f32 v8, s39, v8
    v_add_f32 v9, s39, v9
    v_add_f32 v10, s39, v10
    v_add_f32 v11, s39, v11
    v_add_f32 v12, s39, v12
    v_add_f32 v13, s39, v13
    v_add_f32 v14, s39, v14
    v_add_f32 v15, s39, v15
    v_add_f32 v16, s39, v16
    v_add_f32 v17, s39, v17
    v_add_f32 v18, s39, v18
    v_add_f32 v19, s39, v19
    v_add_f32 v20, s39, v20
    v_add_f32 v21, s39, v21
    v_add_f32 v22, s39, v22
    v_add_f32 v23, s39, v23
    v_add_f32 v24, s39, v24
    v_add_f32 v25, s39, v25
    v_add_f32 v26, s39, v26
    v_add_f32 v27, s39, v27
    v_cvt_pk_bf16_f32 v82, v8, v9
    v_cvt_pk_bf16_f32 v83, v10, v11
    v_cvt_pk_bf16_f32 v86, v12, v13
    v_cvt_pk_bf16_f32 v87, v14, v15
    v_cvt_pk_bf16_f32 v90, v16, v17
    v_cvt_pk_bf16_f32 v91, v18, v19
    v_cvt_pk_bf16_f32 v94, v20, v21
    v_cvt_pk_bf16_f32 v95, v22, v23
    v_cvt_pk_bf16_f32 v98, v24, v25
    v_cvt_pk_bf16_f32 v99, v26, v27
    v_cvt_pk_bf16_f32 v100, v168, v169
    v_cvt_pk_bf16_f32 v101, v170, v171
    v_cvt_pk_bf16_f32 v102, v172, v173
    v_cvt_pk_bf16_f32 v103, v174, v175
    v_cvt_pk_bf16_f32 v104, v176, v177
    v_cvt_pk_bf16_f32 v105, v178, v179
    v_cvt_pk_bf16_f32 v106, v180, v181
    v_cvt_pk_bf16_f32 v107, v182, v183
    v_cvt_pk_bf16_f32 v108, v184, v185
    v_cvt_pk_bf16_f32 v109, v186, v187
    v_cvt_pk_bf16_f32 v110, v188, v189
    v_cvt_pk_bf16_f32 v111, v190, v191
    v_cvt_pk_bf16_f32 v112, v192, v193
    v_cvt_pk_bf16_f32 v113, v194, v195
    v_cvt_pk_bf16_f32 v114, v196, v197
    v_cvt_pk_bf16_f32 v115, v198, v199
    v_cvt_pk_bf16_f32 v116, v200, v201
    v_cvt_pk_bf16_f32 v117, v202, v203
    v_cvt_pk_bf16_f32 v118, v204, v205
    v_cvt_pk_bf16_f32 v119, v206, v207
    v_mov_b32 v120, 0x3f803f80
    v_mov_b32 v121, 0x3f803f80
    v_mov_b32 v122, 0x3f803f80
    v_mov_b32 v123, 0x3f803f80
    s_nop 1
    v_mfma_f32_16x16x32_bf16 v[128:131], v[80:83], v[100:103], 0
    v_mfma_f32_16x16x32_bf16 v[132:135], v[80:83], v[104:107], 0
    v_mfma_f32_16x16x32_bf16 v[136:139], v[84:87], v[100:103], 0
    v_mfma_f32_16x16x32_bf16 v[140:143], v[84:87], v[104:107], 0
    v_mfma_f32_16x16x32_bf16 v[144:147], v[84:87], v[108:111], 0
    v_mfma_f32_16x16x32_bf16 v[148:151], v[88:91], v[104:107], 0
    v_mfma_f32_16x16x32_bf16 v[152:155], v[88:91], v[108:111], 0
    v_mfma_f32_16x16x32_bf16 v[156:159], v[88:91], v[112:115], 0
    v_mfma_f32_16x16x32_bf16 v[160:163], v[92:95], v[108:111], 0
    v_mfma_f32_16x16x32_bf16 v[164:167], v[92:95], v[112:115], 0
    v_mfma_f32_16x16x32_bf16 v[168:171], v[92:95], v[116:119], 0
    v_mfma_f32_16x16x32_bf16 v[172:175], v[96:99], v[112:115], 0
    v_mfma_f32_16x16x32_bf16 v[176:179], v[96:99], v[116:119], 0
    v_mfma_f32_16x16x32_bf16 v[180:183], v[80:83], v[120:123], 0
    v_mfma_f32_16x16x32_bf16 v[184:187], v[84:87], v[120:123], 0
    v_mfma_f32_16x16x32_bf16 v[188:191], v[88:91], v[120:123], 0
    v_mfma_f32_16x16x32_bf16 v[192:195], v[92:95], v[120:123], 0
    v_mfma_f32_16x16x32_bf16 v[196:199], v[96:99], v[120:123], 0
    s_nop 7
    s_nop 1
    s_barrier
    s_mul_i32 s33, s74, 18432
    v_lshlrev_b32 v2, 4, v1
    v_add_u32 v3, s33, v2
    ds_write_b128 v3, v[128:131] offset:0
    ds_write_b128 v3, v[132:135] offset:1024
    ds_write_b128 v3, v[136:139] offset:2048
    ds_write_b128 v3, v[140:143] offset:3072
    ds_write_b128 v3, v[144:147] offset:4096
    ds_write_b128 v3, v[148:151] offset:5120
    ds_write_b128 v3, v[152:155] offset:6144
    ds_write_b128 v3, v[156:159] offset:7168
    ds_write_b128 v3, v[160:163] offset:8192
    ds_write_b128 v3, v[164:167] offset:9216
    ds_write_b128 v3, v[168:171] offset:10240
    ds_write_b128 v3, v[172:175] offset:11264
    ds_write_b128 v3, v[176:179] offset:12288
    ds_write_b128 v3, v[180:183] offset:13312
    ds_write_b128 v3, v[184:187] offset:14336
    ds_write_b128 v3, v[188:191] offset:15360
    ds_write_b128 v3, v[192:195] offset:16384
    ds_write_b128 v3, v[196:199] offset:17408
    s_waitcnt lgkmcnt(0)
    s_branch K1_kvsum
K1_q:
    s_mov_b32 s79, 0
    v_mov_b32 v2, v26
    v_mov_b32 v3, v27
    s_add_u32 s33, s79, 0
    v_xor_b32 v4, s33, v2
    v_lshlrev_b32 v4, 5, v4
    v_add_u32 v8, v3, v4
    v_add_u32 v18, 0x10000, v8
    s_add_u32 s33, s79, 1
    v_xor_b32 v4, s33, v2
    v_lshlrev_b32 v4, 5, v4
    v_add_u32 v9, v3, v4
    v_add_u32 v19, 0x10000, v9
    s_add_u32 s33, s79, 2
    v_xor_b32 v4, s33, v2
    v_lshlrev_b32 v4, 5, v4
    v_add_u32 v10, v3, v4
    v_add_u32 v20, 0x10000, v10
    s_add_u32 s33, s79, 3
    v_xor_b32 v4, s33, v2
    v_lshlrev_b32 v4, 5, v4
    v_add_u32 v11, v3, v4
    v_add_u32 v21, 0x10000, v11
    s_add_u32 s33, s79, 4
    v_xor_b32 v4, s33, v2
    v_lshlrev_b32 v4, 5, v4
    v_add_u32 v12, v3, v4
    v_add_u32 v22, 0x10000, v12
    v_mov_b32 v108, 0
    v_mov_b32 v109, 0
    v_mov_b32 v110, 0
    v_mov_b32 v111, 0
    s_mov_b32 s56, s60
    s_mov_b32 s57, s61
    s_mov_b32 s58, 1280
    s_mov_b32 s59, 0x00020000
    s_add_u32 s64, s10, 15204352
    s_addc_u32 s65, s11, 0
    s_mov_b32 s66, 65536
    s_mov_b32 s67, 0x00020000
    v_lshlrev_b32 v104, 1, v7
    s_lshl_b32 s33, s29, 6
    buffer_load_dwordx4 v[168:171], v104, s[56:59], s33 offen offset:0
    buffer_load_dwordx4 v[172:175], v104, s[56:59], s33 offen offset:512
    buffer_load_dwordx4 v[176:179], v104, s[56:59], s33 offen offset:1024
    s_add_u32 m0, s32, 0
    s_add_u32 s34, s31, 0
    buffer_load_dwordx4 v6, s[16:19], s34 offen lds
    s_add_u32 m0, s32, 2048
    s_add_u32 s34, s31, 15360
    buffer_load_dwordx4 v6, s[16:19], s34 offen lds
    s_add_u32 m0, s76, 0
    s_add_u32 s34, s77, 0
    buffer_load_dwordx4 v30, s[12:15], s34 offen lds
    s_add_u32 m0, s76, 1024
    s_add_u32 s34, s77, 10240
    buffer_load_dwordx4 v31, s[12:15], s34 offen lds
    s_add_u32 m0, s32, 16384
    s_add_u32 s34, s31, 122880
    buffer_load_dwordx4 v6, s[16:19], s34 offen lds
    s_add_u32 m0, s32, 18432
    s_add_u32 s34, s31, 138240
    buffer_load_dwordx4 v6, s[16:19], s34 offen lds
    s_add_u32 m0, s32, 32768
    s_add_u32 s34, s31, 245760
    buffer_load_dwordx4 v6, s[16:19], s34 offen lds
    s_add_u32 m0, s32, 34816
    s_add_u32 s34, s31, 261120
    buffer_load_dwordx4 v6, s[16:19], s34 offen lds
    s_add_u32 m0, s76, 4096
    s_add_u32 s34, s77, 128
    buffer_load_dwordx4 v30, s[12:15], s34 offen lds
    s_add_u32 m0, s76, 5120
    s_add_u32 s34, s77, 10368
    buffer_load_dwordx4 v31, s[12:15], s34 offen lds
    s_add_u32 m0, s32, 49152
    s_add_u32 s34, s31, 368640
    buffer_load_dwordx4 v6, s[16:19], s34 offen lds
    s_add_u32 m0, s32, 51200
    s_add_u32 s34, s31, 384000
    buffer_load_dwordx4 v6, s[16:19], s34 offen lds
    s_waitcnt vmcnt(10)
    s_waitcnt vmcnt(8)
    s_barrier
    s_add_u32 m0, s32, 65536
    s_add_u32 s34, s31, 491520
    buffer_load_dwordx4 v6, s[16:19], s34 offen lds
    s_add_u32 m0, s32, 67584
    s_add_u32 s34, s31, 506880
    buffer_load_dwordx4 v6, s[16:19], s34 offen lds
    s_add_u32 m0, s76, 8192
    s_add_u32 s34, s77, 256
    buffer_load_dwordx4 v30, s[12:15], s34 offen lds
    s_add_u32 m0, s76, 9216
    s_add_u32 s34, s77, 10496
    buffer_load_dwordx4 v31, s[12:15], s34 offen lds
    ds_read_b128 v[64:67], v28 offset:0
    ds_read_b128 v[68:71], v28 offset:2048
    ds_read_b128 v[72:75], v29 offset:0
    ds_read_b128 v[76:79], v29 offset:2048
    ds_read_b64_tr_b16 v[32:33], v8 offset:0
    ds_read_b64_tr_b16 v[34:35], v8 offset:2048
    ds_read_b64_tr_b16 v[36:37], v9 offset:0
    ds_read_b64_tr_b16 v[38:39], v9 offset:2048
    ds_read_b64_tr_b16 v[40:41], v10 offset:0
    ds_read_b64_tr_b16 v[42:43], v10 offset:2048
    ds_read_b64_tr_b16 v[44:45], v11 offset:0
    ds_read_b64_tr_b16 v[46:47], v11 offset:2048
    ds_read_b64_tr_b16 v[48:49], v12 offset:0
    ds_read_b64_tr_b16 v[50:51], v12 offset:2048
    s_waitcnt lgkmcnt(8)
    v_mfma_f32_16x16x32_bf16 v[128:131], v[32:35], v[64:67], 0
    v_mfma_f32_16x16x32_bf16 v[132:135], v[32:35], v[68:71], 0
    s_waitcnt vmcnt(10)
    s_barrier
    s_add_u32 m0, s32, 81920
    s_add_u32 s34, s31, 614400
    buffer_load_dwordx4 v6, s[16:19], s34 offen lds
    s_add_u32 m0, s32, 83968
    s_add_u32 s34, s31, 629760
    buffer_load_dwordx4 v6, s[16:19], s34 offen lds
    ds_read_b64_tr_b16 v[52:53], v8 offset:16384
    ds_read_b64_tr_b16 v[54:55], v8 offset:18432
    s_waitcnt lgkmcnt(8)
    v_mfma_f32_16x16x32_bf16 v[136:139], v[36:39], v[64:67], 0
    v_mfma_f32_16x16x32_bf16 v[140:143], v[36:39], v[68:71], 0
    ds_read_b64_tr_b16 v[56:57], v9 offset:16384
    ds_read_b64_tr_b16 v[58:59], v9 offset:18432
    s_waitcnt lgkmcnt(8)
    v_mfma_f32_16x16x32_bf16 v[144:147], v[40:43], v[64:67], 0
    v_mfma_f32_16x16x32_bf16 v[148:151], v[40:43], v[68:71], 0
    ds_read_b64_tr_b16 v[60:61], v10 offset:16384
    ds_read_b64_tr_b16 v[62:63], v10 offset:18432
    s_waitcnt lgkmcnt(8)
    v_mfma_f32_16x16x32_bf16 v[152:155], v[44:47], v[64:67], 0
    v_mfma_f32_16x16x32_bf16 v[156:159], v[44:47], v[68:71], 0
    ds_read_b64_tr_b16 v[32:33], v11 offset:16384
    ds_read_b64_tr_b16 v[34:35], v11 offset:18432
    s_waitcnt lgkmcnt(8)
    v_mfma_f32_16x16x32_bf16 v[160:163], v[48:51], v[64:67], 0
    v_mfma_f32_16x16x32_bf16 v[164:167], v[48:51], v[68:71], 0
    s_cmp_eq_u32 s29, 0
    s_cbranch_scc0 K1_g0
    v_lshlrev_b32 v112, 16, v168
    v_and_b32 v113, 0xffff0000, v168
    v_lshlrev_b32 v114, 16, v169
    v_and_b32 v115, 0xffff0000, v169
    v_lshlrev_b32 v116, 16, v170
    v_and_b32 v117, 0xffff0000, v170
    v_lshlrev_b32 v118, 16, v171
    v_and_b32 v119, 0xffff0000, v171
    v_lshlrev_b32 v120, 16, v64
    v_and_b32 v121, 0xffff0000, v64
    v_lshlrev_b32 v122, 16, v65
    v_and_b32 v123, 0xffff0000, v65
    v_lshlrev_b32 v124, 16, v66
    v_and_b32 v125, 0xffff0000, v66
    v_lshlrev_b32 v126, 16, v67
    v_and_b32 v127, 0xffff0000, v67
    v_pk_mul_f32 v[120:121], v[120:121], v[112:113]
    v_pk_mul_f32 v[122:123], v[122:123], v[114:115]
    v_pk_mul_f32 v[124:125], v[124:125], v[116:117]
    v_pk_mul_f32 v[126:127], v[126:127], v[118:119]
    v_cvt_pk_bf16_f32 v120, v120, v121
    v_cvt_pk_bf16_f32 v122, v122, v123
    v_cvt_pk_bf16_f32 v124, v124, v125
    v_cvt_pk_bf16_f32 v126, v126, v127
    v_and_b32 v121, 0xffff0000, v120
    v_lshlrev_b32 v120, 16, v120
    v_and_b32 v123, 0xffff0000, v122
    v_lshlrev_b32 v122, 16, v122
    v_and_b32 v125, 0xffff0000, v124
    v_lshlrev_b32 v124, 16, v124
    v_and_b32 v127, 0xffff0000, v126
    v_lshlrev_b32 v126, 16, v126
    v_pk_add_f32 v[108:109], v[108:109], v[120:121]
    v_pk_add_f32 v[108:109], v[108:109], v[122:123]
    v_pk_add_f32 v[108:109], v[108:109], v[124:125]
    v_pk_add_f32 v[108:109], v[108:109], v[126:127]
    v_lshlrev_b32 v120, 16, v68
    v_and_b32 v121, 0xffff0000, v68
    v_lshlrev_b32 v122, 16, v69
    v_and_b32 v123, 0xffff0000, v69
    v_lshlrev_b32 v124, 16, v70
    v_and_b32 v125, 0xffff0000, v70
    v_lshlrev_b32 v126, 16, v71
    v_and_b32 v127, 0xffff0000, v71
    v_pk_mul_f32 v[120:121], v[120:121], v[112:113]
    v_pk_mul_f32 v[122:123], v[122:123], v[114:115]
    v_pk_mul_f32 v[124:125], v[124:125], v[116:117]
    v_pk_mul_f32 v[126:127], v[126:127], v[118:119]
    v_cvt_pk_bf16_f32 v120, v120, v121
    v_cvt_pk_bf16_f32 v122, v122, v123
    v_cvt_pk_bf16_f32 v124, v124, v125
    v_cvt_pk_bf16_f32 v126, v126, v127
    v_and_b32 v121, 0xffff0000, v120
    v_lshlrev_b32 v120, 16, v120
    v_and_b32 v123, 0xffff0000, v122
    v_lshlrev_b32 v122, 16, v122
    v_and_b32 v125, 0xffff0000, v124
    v_lshlrev_b32 v124, 16, v124
    v_and_b32 v127, 0xffff0000, v126
    v_lshlrev_b32 v126, 16, v126
    v_pk_add_f32 v[110:111], v[110:111], v[120:121]
    v_pk_add_f32 v[110:111], v[110:111], v[122:123]
    v_pk_add_f32 v[110:111], v[110:111], v[124:125]
    v_pk_add_f32 v[110:111], v[110:111], v[126:127]
K1_g0:
    ds_read_b64_tr_b16 v[36:37], v12 offset:16384
    ds_read_b64_tr_b16 v[38:39], v12 offset:18432
    s_waitcnt lgkmcnt(8)
    v_mfma_f32_16x16x32_bf16 v[128:131], v[52:55], v[72:75], v[128:131]
    v_mfma_f32_16x16x32_bf16 v[132:135], v[52:55], v[76:79], v[132:135]
    s_waitcnt vmcnt(10)
    s_waitcnt vmcnt(8)
    s_barrier
    s_add_u32 m0, s32, 0
    s_add_u32 s34, s31, 737280
    buffer_load_dwordx4 v6, s[16:19], s34 offen lds
    s_add_u32 m0, s32, 2048
    s_add_u32 s34, s31, 752640
    buffer_load_dwordx4 v6, s[16:19], s34 offen lds
    s_add_u32 m0, s76, 12288
    s_add_u32 s34, s77, 384
    buffer_load_dwordx4 v30, s[12:15], s34 offen lds
    s_add_u32 m0, s76, 13312
    s_add_u32 s34, s77, 10624
    buffer_load_dwordx4 v31, s[12:15], s34 offen lds
    ds_read_b64_tr_b16 v[40:41], v8 offset:32768
    ds_read_b64_tr_b16 v[42:43], v8 offset:34816
    ds_read_b128 v[80:83], v28 offset:4096
    s_waitcnt lgkmcnt(9)
    v_mfma_f32_16x16x32_bf16 v[136:139], v[56:59], v[72:75], v[136:139]
    v_mfma_f32_16x16x32_bf16 v[140:143], v[56:59], v[76:79], v[140:143]
    ds_read_b64_tr_b16 v[44:45], v9 offset:32768
    ds_read_b64_tr_b16 v[46:47], v9 offset:34816
    ds_read_b128 v[84:87], v28 offset:6144
    s_waitcnt lgkmcnt(10)
    v_mfma_f32_16x16x32_bf16 v[144:147], v[60:63], v[72:75], v[144:147]
    v_mfma_f32_16x16x32_bf16 v[148:151], v[60:63], v[76:79], v[148:151]
    ds_read_b64_tr_b16 v[48:49], v10 offset:32768
    ds_read_b64_tr_b16 v[50:51], v10 offset:34816
    ds_read_b128 v[88:91], v29 offset:4096
    s_waitcnt lgkmcnt(11)
    v_mfma_f32_16x16x32_bf16 v[152:155], v[32:35], v[72:75], v[152:155]
    v_mfma_f32_16x16x32_bf16 v[156:159], v[32:35], v[76:79], v[156:159]
    ds_read_b64_tr_b16 v[52:53], v11 offset:32768
    ds_read_b64_tr_b16 v[54:55], v11 offset:34816
    ds_read_b128 v[92:95], v29 offset:6144
    s_waitcnt lgkmcnt(12)
    v_mfma_f32_16x16x32_bf16 v[160:163], v[36:39], v[72:75], v[160:163]
    v_mfma_f32_16x16x32_bf16 v[164:167], v[36:39], v[76:79], v[164:167]
    s_cmp_eq_u32 s29, 1
    s_cbranch_scc0 K1_g1
    v_lshlrev_b32 v112, 16, v168
    v_and_b32 v113, 0xffff0000, v168
    v_lshlrev_b32 v114, 16, v169
    v_and_b32 v115, 0xffff0000, v169
    v_lshlrev_b32 v116, 16, v170
    v_and_b32 v117, 0xffff0000, v170
    v_lshlrev_b32 v118, 16, v171
    v_and_b32 v119, 0xffff0000, v171
    v_lshlrev_b32 v120, 16, v72
    v_and_b32 v121, 0xffff0000, v72
    v_lshlrev_b32 v122, 16, v73
    v_and_b32 v123, 0xffff0000, v73
    v_lshlrev_b32 v124, 16, v74
    v_and_b32 v125, 0xffff0000, v74
    v_lshlrev_b32 v126, 16, v75
    v_and_b32 v127, 0xffff0000, v75
    v_pk_mul_f32 v[120:121], v[120:121], v[112:113]
    v_pk_mul_f32 v[122:123], v[122:123], v[114:115]
    v_pk_mul_f32 v[124:125], v[124:125], v[116:117]
    v_pk_mul_f32 v[126:127], v[126:127], v[118:119]
    v_cvt_pk_bf16_f32 v120, v120, v121
    v_cvt_pk_bf16_f32 v122, v122, v123
    v_cvt_pk_bf16_f32 v124, v124, v125
    v_cvt_pk_bf16_f32 v126, v126, v127
    v_and_b32 v121, 0xffff0000, v120
    v_lshlrev_b32 v120, 16, v120
    v_and_b32 v123, 0xffff0000, v122
    v_lshlrev_b32 v122, 16, v122
    v_and_b32 v125, 0xffff0000, v124
    v_lshlrev_b32 v124, 16, v124
    v_and_b32 v127, 0xffff0000, v126
    v_lshlrev_b32 v126, 16, v126
    v_pk_add_f32 v[108:109], v[108:109], v[120:121]
    v_pk_add_f32 v[108:109], v[108:109], v[122:123]
    v_pk_add_f32 v[108:109], v[108:109], v[124:125]
    v_pk_add_f32 v[108:109], v[108:109], v[126:127]
    v_lshlrev_b32 v120, 16, v76
    v_and_b32 v121, 0xffff0000, v76
    v_lshlrev_b32 v122, 16, v77
    v_and_b32 v123, 0xffff0000, v77
    v_lshlrev_b32 v124, 16, v78
    v_and_b32 v125, 0xffff0000, v78
    v_lshlrev_b32 v126, 16, v79
    v_and_b32 v127, 0xffff0000, v79
    v_pk_mul_f32 v[120:121], v[120:121], v[112:113]
    v_pk_mul_f32 v[122:123], v[122:123], v[114:115]
    v_pk_mul_f32 v[124:125], v[124:125], v[116:117]
    v_pk_mul_f32 v[126:127], v[126:127], v[118:119]
    v_cvt_pk_bf16_f32 v120, v120, v121
    v_cvt_pk_bf16_f32 v122, v122, v123
    v_cvt_pk_bf16_f32 v124, v124, v125
    v_cvt_pk_bf16_f32 v126, v126, v127
    v_and_b32 v121, 0xffff0000, v120
    v_lshlrev_b32 v120, 16, v120
    v_and_b32 v123, 0xffff0000, v122
    v_lshlrev_b32 v122, 16, v122
    v_and_b32 v125, 0xffff0000, v124
    v_lshlrev_b32 v124, 16, v124
    v_and_b32 v127, 0xffff0000, v126
    v_lshlrev_b32 v126, 16, v126
    v_pk_add_f32 v[110:111], v[110:111], v[120:121]
    v_pk_add_f32 v[110:111], v[110:111], v[122:123]
    v_pk_add_f32 v[110:111], v[110:111], v[124:125]
    v_pk_add_f32 v[110:111], v[110:111], v[126:127]
K1_g1:
    ds_read_b64_tr_b16 v[56:57], v12 offset:32768
    ds_read_b64_tr_b16 v[58:59], v12 offset:34816
    s_waitcnt lgkmcnt(2)
    v_mfma_f32_16x16x32_bf16 v[128:131], v[40:43], v[80:83], v[128:131]
    v_mfma_f32_16x16x32_bf16 v[132:135], v[40:43], v[84:87], v[132:135]
    s_waitcnt vmcnt(10)
    s_barrier
    s_add_u32 m0, s32, 16384
    s_add_u32 s34, s31, 860160
    buffer_load_dwordx4 v6, s[16:19], s34 offen lds
    s_add_u32 m0, s32, 18432
    s_add_u32 s34, s31, 875520
    buffer_load_dwordx4 v6, s[16:19], s34 offen lds
    ds_read_b64_tr_b16 v[60:61], v8 offset:49152
    ds_read_b64_tr_b16 v[62:63], v8 offset:51200
    v_mfma_f32_16x16x32_bf16 v[136:139], v[44:47], v[80:83], v[136:139]
    v_mfma_f32_16x16x32_bf16 v[140:143], v[44:47], v[84:87], v[140:143]
    ds_read_b64_tr_b16 v[32:33], v9 offset:49152
    ds_read_b64_tr_b16 v[34:35], v9 offset:51200
    v_mfma_f32_16x16x32_bf16 v[144:147], v[48:51], v[80:83], v[144:147]
    v_mfma_f32_16x16x32_bf16 v[148:151], v[48:51], v[84:87], v[148:151]
    ds_read_b64_tr_b16 v[36:37], v10 offset:49152
    ds_read_b64_tr_b16 v[38:39], v10 offset:51200
    v_mfma_f32_16x16x32_bf16 v[152:155], v[52:55], v[80:83], v[152:155]
    v_mfma_f32_16x16x32_bf16 v[156:159], v[52:55], v[84:87], v[156:159]
    ds_read_b64_tr_b16 v[40:41], v11 offset:49152
    ds_read_b64_tr_b16 v[42:43], v11 offset:51200
    s_waitcnt lgkmcnt(8)
    v_mfma_f32_16x16x32_bf16 v[160:163], v[56:59], v[80:83], v[160:163]
    v_mfma_f32_16x16x32_bf16 v[164:167], v[56:59], v[84:87], v[164:167]
    s_cmp_eq_u32 s29, 2
    s_cbranch_scc0 K1_g2
    v_lshlrev_b32 v112, 16, v168
    v_and_b32 v113, 0xffff0000, v168
    v_lshlrev_b32 v114, 16, v169
    v_and_b32 v115, 0xffff0000, v169
    v_lshlrev_b32 v116, 16, v170
    v_and_b32 v117, 0xffff0000, v170
    v_lshlrev_b32 v118, 16, v171
    v_and_b32 v119, 0xffff0000, v171
    v_lshlrev_b32 v120, 16, v80
    v_and_b32 v121, 0xffff0000, v80
    v_lshlrev_b32 v122, 16, v81
    v_and_b32 v123, 0xffff0000, v81
    v_lshlrev_b32 v124, 16, v82
    v_and_b32 v125, 0xffff0000, v82
    v_lshlrev_b32 v126, 16, v83
    v_and_b32 v127, 0xffff0000, v83
    v_pk_mul_f32 v[120:121], v[120:121], v[112:113]
    v_pk_mul_f32 v[122:123], v[122:123], v[114:115]
    v_pk_mul_f32 v[124:125], v[124:125], v[116:117]
    v_pk_mul_f32 v[126:127], v[126:127], v[118:119]
    v_cvt_pk_bf16_f32 v120, v120, v121
    v_cvt_pk_bf16_f32 v122, v122, v123
    v_cvt_pk_bf16_f32 v124, v124, v125
    v_cvt_pk_bf16_f32 v126, v126, v127
    v_and_b32 v121, 0xffff0000, v120
    v_lshlrev_b32 v120, 16, v120
    v_and_b32 v123, 0xffff0000, v122
    v_lshlrev_b32 v122, 16, v122
    v_and_b32 v125, 0xffff0000, v124
    v_lshlrev_b32 v124, 16, v124
    v_and_b32 v127, 0xffff0000, v126
    v_lshlrev_b32 v126, 16, v126
    v_pk_add_f32 v[108:109], v[108:109], v[120:121]
    v_pk_add_f32 v[108:109], v[108:109], v[122:123]
    v_pk_add_f32 v[108:109], v[108:109], v[124:125]
    v_pk_add_f32 v[108:109], v[108:109], v[126:127]
    v_lshlrev_b32 v120, 16, v84
    v_and_b32 v121, 0xffff0000, v84
    v_lshlrev_b32 v122, 16, v85
    v_and_b32 v123, 0xffff0000, v85
    v_lshlrev_b32 v124, 16, v86
    v_and_b32 v125, 0xffff0000, v86
    v_lshlrev_b32 v126, 16, v87
    v_and_b32 v127, 0xffff0000, v87
    v_pk_mul_f32 v[120:121], v[120:121], v[112:113]
    v_pk_mul_f32 v[122:123], v[122:123], v[114:115]
    v_pk_mul_f32 v[124:125], v[124:125], v[116:117]
    v_pk_mul_f32 v[126:127], v[126:127], v[118:119]
    v_cvt_pk_bf16_f32 v120, v120, v121
    v_cvt_pk_bf16_f32 v122, v122, v123
    v_cvt_pk_bf16_f32 v124, v124, v125
    v_cvt_pk_bf16_f32 v126, v126, v127
    v_and_b32 v121, 0xffff0000, v120
    v_lshlrev_b32 v120, 16, v120
    v_and_b32 v123, 0xffff0000, v122
    v_lshlrev_b32 v122, 16, v122
    v_and_b32 v125, 0xffff0000, v124
    v_lshlrev_b32 v124, 16, v124
    v_and_b32 v127, 0xffff0000, v126
    v_lshlrev_b32 v126, 16, v126
    v_pk_add_f32 v[110:111], v[110:111], v[120:121]
    v_pk_add_f32 v[110:111], v[110:111], v[122:123]
    v_pk_add_f32 v[110:111], v[110:111], v[124:125]
    v_pk_add_f32 v[110:111], v[110:111], v[126:127]
K1_g2:
    ds_read_b64_tr_b16 v[44:45], v12 offset:49152
    ds_read_b64_tr_b16 v[46:47], v12 offset:51200
    s_waitcnt lgkmcnt(8)
    v_mfma_f32_16x16x32_bf16 v[128:131], v[60:63], v[88:91], v[128:131]
    v_mfma_f32_16x16x32_bf16 v[132:135], v[60:63], v[92:95], v[132:135]
    s_waitcnt vmcnt(10)
    s_waitcnt vmcnt(8)
    s_barrier
    s_add_u32 m0, s32, 32768
    s_add_u32 s34, s31, 983040
    buffer_load_dwordx4 v6, s[16:19], s34 offen lds
    s_add_u32 m0, s32, 34816
    s_add_u32 s34, s31, 998400
    buffer_load_dwordx4 v6, s[16:19], s34 offen lds
    s_add_u32 m0, s76, 0
    s_add_u32 s34, s77, 512
    buffer_load_dwordx4 v30, s[12:15], s34 offen lds
    s_add_u32 m0, s76, 1024
    s_add_u32 s34, s77, 10752
    buffer_load_dwordx4 v31, s[12:15], s34 offen lds
    ds_read_b64_tr_b16 v[48:49], v18 offset:0
    ds_read_b64_tr_b16 v[50:51], v18 offset:2048
    ds_read_b128 v[64:67], v28 offset:8192
    s_waitcnt lgkmcnt(9)
    v_mfma_f32_16x16x32_bf16 v[136:139], v[32:35], v[88:91], v[136:139]
    v_mfma_f32_16x16x32_bf16 v[140:143], v[32:35], v[92:95], v[140:143]
    ds_read_b64_tr_b16 v[52:53], v19 offset:0
    ds_read_b64_tr_b16 v[54:55], v19 offset:2048
    ds_read_b128 v[68:71], v28 offset:10240
    s_waitcnt lgkmcnt(10)
    v_mfma_f32_16x16x32_bf16 v[144:147], v[36:39], v[88:91], v[144:147]
    v_mfma_f32_16x16x32_bf16 v[148:151], v[36:39], v[92:95], v[148:151]
    ds_read_b64_tr_b16 v[56:57], v20 offset:0
    ds_read_b64_tr_b16 v[58:59], v20 offset:2048
    ds_read_b128 v[72:75], v29 offset:8192
    s_waitcnt lgkmcnt(11)
    v_mfma_f32_16x16x32_bf16 v[152:155], v[40:43], v[88:91], v[152:155]
    v_mfma_f32_16x16x32_bf16 v[156:159], v[40:43], v[92:95], v[156:159]
    ds_read_b64_tr_b16 v[60:61], v21 offset:0
    ds_read_b64_tr_b16 v[62:63], v21 offset:2048
    ds_read_b128 v[76:79], v29 offset:10240
    s_waitcnt lgkmcnt(12)
    v_mfma_f32_16x16x32_bf16 v[160:163], v[44:47], v[88:91], v[160:163]
    v_mfma_f32_16x16x32_bf16 v[164:167], v[44:47], v[92:95], v[164:167]
    s_cmp_eq_u32 s29, 3
    s_cbranch_scc0 K1_g3
    v_lshlrev_b32 v112, 16, v168
    v_and_b32 v113, 0xffff0000, v168
    v_lshlrev_b32 v114, 16, v169
    v_and_b32 v115, 0xffff0000, v169
    v_lshlrev_b32 v116, 16, v170
    v_and_b32 v117, 0xffff0000, v170
    v_lshlrev_b32 v118, 16, v171
    v_and_b32 v119, 0xffff0000, v171
    v_lshlrev_b32 v120, 16, v88
    v_and_b32 v121, 0xffff0000, v88
    v_lshlrev_b32 v122, 16, v89
    v_and_b32 v123, 0xffff0000, v89
    v_lshlrev_b32 v124, 16, v90
    v_and_b32 v125, 0xffff0000, v90
    v_lshlrev_b32 v126, 16, v91
    v_and_b32 v127, 0xffff0000, v91
    v_pk_mul_f32 v[120:121], v[120:121], v[112:113]
    v_pk_mul_f32 v[122:123], v[122:123], v[114:115]
    v_pk_mul_f32 v[124:125], v[124:125], v[116:117]
    v_pk_mul_f32 v[126:127], v[126:127], v[118:119]
    v_cvt_pk_bf16_f32 v120, v120, v121
    v_cvt_pk_bf16_f32 v122, v122, v123
    v_cvt_pk_bf16_f32 v124, v124, v125
    v_cvt_pk_bf16_f32 v126, v126, v127
    v_and_b32 v121, 0xffff0000, v120
    v_lshlrev_b32 v120, 16, v120
    v_and_b32 v123, 0xffff0000, v122
    v_lshlrev_b32 v122, 16, v122
    v_and_b32 v125, 0xffff0000, v124
    v_lshlrev_b32 v124, 16, v124
    v_and_b32 v127, 0xffff0000, v126
    v_lshlrev_b32 v126, 16, v126
    v_pk_add_f32 v[108:109], v[108:109], v[120:121]
    v_pk_add_f32 v[108:109], v[108:109], v[122:123]
    v_pk_add_f32 v[108:109], v[108:109], v[124:125]
    v_pk_add_f32 v[108:109], v[108:109], v[126:127]
    v_lshlrev_b32 v120, 16, v92
    v_and_b32 v121, 0xffff0000, v92
    v_lshlrev_b32 v122, 16, v93
    v_and_b32 v123, 0xffff0000, v93
    v_lshlrev_b32 v124, 16, v94
    v_and_b32 v125, 0xffff0000, v94
    v_lshlrev_b32 v126, 16, v95
    v_and_b32 v127, 0xffff0000, v95
    v_pk_mul_f32 v[120:121], v[120:121], v[112:113]
    v_pk_mul_f32 v[122:123], v[122:123], v[114:115]
    v_pk_mul_f32 v[124:125], v[124:125], v[116:117]
    v_pk_mul_f32 v[126:127], v[126:127], v[118:119]
    v_cvt_pk_bf16_f32 v120, v120, v121
    v_cvt_pk_bf16_f32 v122, v122, v123
    v_cvt_pk_bf16_f32 v124, v124, v125
    v_cvt_pk_bf16_f32 v126, v126, v127
    v_and_b32 v121, 0xffff0000, v120
    v_lshlrev_b32 v120, 16, v120
    v_and_b32 v123, 0xffff0000, v122
    v_lshlrev_b32 v122, 16, v122
    v_and_b32 v125, 0xffff0000, v124
    v_lshlrev_b32 v124, 16, v124
    v_and_b32 v127, 0xffff0000, v126
    v_lshlrev_b32 v126, 16, v126
    v_pk_add_f32 v[110:111], v[110:111], v[120:121]
    v_pk_add_f32 v[110:111], v[110:111], v[122:123]
    v_pk_add_f32 v[110:111], v[110:111], v[124:125]
    v_pk_add_f32 v[110:111], v[110:111], v[126:127]
K1_g3:
    ds_read_b64_tr_b16 v[32:33], v22 offset:0
    ds_read_b64_tr_b16 v[34:35], v22 offset:2048
    s_waitcnt lgkmcnt(2)
    v_mfma_f32_16x16x32_bf16 v[128:131], v[48:51], v[64:67], v[128:131]
    v_mfma_f32_16x16x32_bf16 v[132:135], v[48:51], v[68:71], v[132:135]
    s_waitcnt vmcnt(10)
    s_barrier
    s_add_u32 m0, s32, 49152
    s_add_u32 s34, s31, 1105920
    buffer_load_dwordx4 v6, s[16:19], s34 offen lds
    s_add_u32 m0, s32, 51200
    s_add_u32 s34, s31, 1121280
    buffer_load_dwordx4 v6, s[16:19], s34 offen lds
    ds_read_b64_tr_b16 v[36:37], v18 offset:16384
    ds_read_b64_tr_b16 v[38:39], v18 offset:18432
    v_mfma_f32_16x16x32_bf16 v[136:139], v[52:55], v[64:67], v[136:139]
    v_mfma_f32_16x16x32_bf16 v[140:143], v[52:55], v[68:71], v[140:143]
    ds_read_b64_tr_b16 v[40:41], v19 offset:16384
    ds_read_b64_tr_b16 v[42:43], v19 offset:18432
    v_mfma_f32_16x16x32_bf16 v[144:147], v[56:59], v[64:67], v[144:147]
    v_mfma_f32_16x16x32_bf16 v[148:151], v[56:59], v[68:71], v[148:151]
    ds_read_b64_tr_b16 v[44:45], v20 offset:16384
    ds_read_b64_tr_b16 v[46:47], v20 offset:18432
    v_mfma_f32_16x16x32_bf16 v[152:155], v[60:63], v[64:67], v[152:155]
    v_mfma_f32_16x16x32_bf16 v[156:159], v[60:63], v[68:71], v[156:159]
    ds_read_b64_tr_b16 v[48:49], v21 offset:16384
    ds_read_b64_tr_b16 v[50:51], v21 offset:18432
    s_waitcnt lgkmcnt(8)
    v_mfma_f32_16x16x32_bf16 v[160:163], v[32:35], v[64:67], v[160:163]
    v_mfma_f32_16x16x32_bf16 v[164:167], v[32:35], v[68:71], v[164:167]
    s_cmp_eq_u32 s29, 4
    s_cbranch_scc0 K1_g4
    v_lshlrev_b32 v112, 16, v168
    v_and_b32 v113, 0xffff0000, v168
    v_lshlrev_b32 v114, 16, v169
    v_and_b32 v115, 0xffff0000, v169
    v_lshlrev_b32 v116, 16, v170
    v_and_b32 v117, 0xffff0000, v170
    v_lshlrev_b32 v118, 16, v171
    v_and_b32 v119, 0xffff0000, v171
    v_lshlrev_b32 v120, 16, v64
    v_and_b32 v121, 0xffff0000, v64
    v_lshlrev_b32 v122, 16, v65
    v_and_b32 v123, 0xffff0000, v65
    v_lshlrev_b32 v124, 16, v66
    v_and_b32 v125, 0xffff0000, v66
    v_lshlrev_b32 v126, 16, v67
    v_and_b32 v127, 0xffff0000, v67
    v_pk_mul_f32 v[120:121], v[120:121], v[112:113]
    v_pk_mul_f32 v[122:123], v[122:123], v[114:115]
    v_pk_mul_f32 v[124:125], v[124:125], v[116:117]
    v_pk_mul_f32 v[126:127], v[126:127], v[118:119]
    v_cvt_pk_bf16_f32 v120, v120, v121
    v_cvt_pk_bf16_f32 v122, v122, v123
    v_cvt_pk_bf16_f32 v124, v124, v125
    v_cvt_pk_bf16_f32 v126, v126, v127
    v_and_b32 v121, 0xffff0000, v120
    v_lshlrev_b32 v120, 16, v120
    v_and_b32 v123, 0xffff0000, v122
    v_lshlrev_b32 v122, 16, v122
    v_and_b32 v125, 0xffff0000, v124
    v_lshlrev_b32 v124, 16, v124
    v_and_b32 v127, 0xffff0000, v126
    v_lshlrev_b32 v126, 16, v126
    v_pk_add_f32 v[108:109], v[108:109], v[120:121]
    v_pk_add_f32 v[108:109], v[108:109], v[122:123]
    v_pk_add_f32 v[108:109], v[108:109], v[124:125]
    v_pk_add_f32 v[108:109], v[108:109], v[126:127]
    v_lshlrev_b32 v120, 16, v68
    v_and_b32 v121, 0xffff0000, v68
    v_lshlrev_b32 v122, 16, v69
    v_and_b32 v123, 0xffff0000, v69
    v_lshlrev_b32 v124, 16, v70
    v_and_b32 v125, 0xffff0000, v70
    v_lshlrev_b32 v126, 16, v71
    v_and_b32 v127, 0xffff0000, v71
    v_pk_mul_f32 v[120:121], v[120:121], v[112:113]
    v_pk_mul_f32 v[122:123], v[122:123], v[114:115]
    v_pk_mul_f32 v[124:125], v[124:125], v[116:117]
    v_pk_mul_f32 v[126:127], v[126:127], v[118:119]
    v_cvt_pk_bf16_f32 v120, v120, v121
    v_cvt_pk_bf16_f32 v122, v122, v123
    v_cvt_pk_bf16_f32 v124, v124, v125
    v_cvt_pk_bf16_f32 v126, v126, v127
    v_and_b32 v121, 0xffff0000, v120
    v_lshlrev_b32 v120, 16, v120
    v_and_b32 v123, 0xffff0000, v122
    v_lshlrev_b32 v122, 16, v122
    v_and_b32 v125, 0xffff0000, v124
    v_lshlrev_b32 v124, 16, v124
    v_and_b32 v127, 0xffff0000, v126
    v_lshlrev_b32 v126, 16, v126
    v_pk_add_f32 v[110:111], v[110:111], v[120:121]
    v_pk_add_f32 v[110:111], v[110:111], v[122:123]
    v_pk_add_f32 v[110:111], v[110:111], v[124:125]
    v_pk_add_f32 v[110:111], v[110:111], v[126:127]
K1_g4:
    ds_read_b64_tr_b16 v[52:53], v22 offset:16384
    ds_read_b64_tr_b16 v[54:55], v22 offset:18432
    s_waitcnt lgkmcnt(8)
    v_mfma_f32_16x16x32_bf16 v[128:131], v[36:39], v[72:75], v[128:131]
    v_mfma_f32_16x16x32_bf16 v[132:135], v[36:39], v[76:79], v[132:135]
    s_waitcnt vmcnt(10)
    s_waitcnt vmcnt(8)
    s_barrier
    s_add_u32 m0, s32, 65536
    s_add_u32 s34, s31, 1228800
    buffer_load_dwordx4 v6, s[16:19], s34 offen lds
    s_add_u32 m0, s32, 67584
    s_add_u32 s34, s31, 1244160
    buffer_load_dwordx4 v6, s[16:19], s34 offen lds
    s_add_u32 m0, s76, 4096
    s_add_u32 s34, s77, 640
    buffer_load_dwordx4 v30, s[12:15], s34 offen lds
    s_add_u32 m0, s76, 5120
    s_add_u32 s34, s77, 10880
    buffer_load_dwordx4 v31, s[12:15], s34 offen lds
    ds_read_b64_tr_b16 v[56:57], v8 offset:0
    ds_read_b64_tr_b16 v[58:59], v8 offset:2048
    ds_read_b128 v[80:83], v28 offset:12288
    s_waitcnt lgkmcnt(9)
    v_mfma_f32_16x16x32_bf16 v[136:139], v[40:43], v[72:75], v[136:139]
    v_mfma_f32_16x16x32_bf16 v[140:143], v[40:43], v[76:79], v[140:143]
    ds_read_b64_tr_b16 v[60:61], v9 offset:0
    ds_read_b64_tr_b16 v[62:63], v9 offset:2048
    ds_read_b128 v[84:87], v28 offset:14336
    s_waitcnt lgkmcnt(10)
    v_mfma_f32_16x16x32_bf16 v[144:147], v[44:47], v[72:75], v[144:147]
    v_mfma_f32_16x16x32_bf16 v[148:151], v[44:47], v[76:79], v[148:151]
    ds_read_b64_tr_b16 v[32:33], v10 offset:0
    ds_read_b64_tr_b16 v[34:35], v10 offset:2048
    ds_read_b128 v[88:91], v29 offset:12288
    s_waitcnt lgkmcnt(11)
    v_mfma_f32_16x16x32_bf16 v[152:155], v[48:51], v[72:75], v[152:155]
    v_mfma_f32_16x16x32_bf16 v[156:159], v[48:51], v[76:79], v[156:159]
    ds_read_b64_tr_b16 v[36:37], v11 offset:0
    ds_read_b64_tr_b16 v[38:39], v11 offset:2048
    ds_read_b128 v[92:95], v29 offset:14336
    s_waitcnt lgkmcnt(12)
    v_mfma_f32_16x16x32_bf16 v[160:163], v[52:55], v[72:75], v[160:163]
    v_mfma_f32_16x16x32_bf16 v[164:167], v[52:55], v[76:79], v[164:167]
    s_cmp_eq_u32 s29, 5
    s_cbranch_scc0 K1_g5
    v_lshlrev_b32 v112, 16, v168
    v_and_b32 v113, 0xffff0000, v168
    v_lshlrev_b32 v114, 16, v169
    v_and_b32 v115, 0xffff0000, v169
    v_lshlrev_b32 v116, 16, v170
    v_and_b32 v117, 0xffff0000, v170
    v_lshlrev_b32 v118, 16, v171
    v_and_b32 v119, 0xffff0000, v171
    v_lshlrev_b32 v120, 16, v72
    v_and_b32 v121, 0xffff0000, v72
    v_lshlrev_b32 v122, 16, v73
    v_and_b32 v123, 0xffff0000, v73
    v_lshlrev_b32 v124, 16, v74
    v_and_b32 v125, 0xffff0000, v74
    v_lshlrev_b32 v126, 16, v75
    v_and_b32 v127, 0xffff0000, v75
    v_pk_mul_f32 v[120:121], v[120:121], v[112:113]
    v_pk_mul_f32 v[122:123], v[122:123], v[114:115]
    v_pk_mul_f32 v[124:125], v[124:125], v[116:117]
    v_pk_mul_f32 v[126:127], v[126:127], v[118:119]
    v_cvt_pk_bf16_f32 v120, v120, v121
    v_cvt_pk_bf16_f32 v122, v122, v123
    v_cvt_pk_bf16_f32 v124, v124, v125
    v_cvt_pk_bf16_f32 v126, v126, v127
    v_and_b32 v121, 0xffff0000, v120
    v_lshlrev_b32 v120, 16, v120
    v_and_b32 v123, 0xffff0000, v122
    v_lshlrev_b32 v122, 16, v122
    v_and_b32 v125, 0xffff0000, v124
    v_lshlrev_b32 v124, 16, v124
    v_and_b32 v127, 0xffff0000, v126
    v_lshlrev_b32 v126, 16, v126
    v_pk_add_f32 v[108:109], v[108:109], v[120:121]
    v_pk_add_f32 v[108:109], v[108:109], v[122:123]
    v_pk_add_f32 v[108:109], v[108:109], v[124:125]
    v_pk_add_f32 v[108:109], v[108:109], v[126:127]
    v_lshlrev_b32 v120, 16, v76
    v_and_b32 v121, 0xffff0000, v76
    v_lshlrev_b32 v122, 16, v77
    v_and_b32 v123, 0xffff0000, v77
    v_lshlrev_b32 v124, 16, v78
    v_and_b32 v125, 0xffff0000, v78
    v_lshlrev_b32 v126, 16, v79
    v_and_b32 v127, 0xffff0000, v79
    v_pk_mul_f32 v[120:121], v[120:121], v[112:113]
    v_pk_mul_f32 v[122:123], v[122:123], v[114:115]
    v_pk_mul_f32 v[124:125], v[124:125], v[116:117]
    v_pk_mul_f32 v[126:127], v[126:127], v[118:119]
    v_cvt_pk_bf16_f32 v120, v120, v121
    v_cvt_pk_bf16_f32 v122, v122, v123
    v_cvt_pk_bf16_f32 v124, v124, v125
    v_cvt_pk_bf16_f32 v126, v126, v127
    v_and_b32 v121, 0xffff0000, v120
    v_lshlrev_b32 v120, 16, v120
    v_and_b32 v123, 0xffff0000, v122
    v_lshlrev_b32 v122, 16, v122
    v_and_b32 v125, 0xffff0000, v124
    v_lshlrev_b32 v124, 16, v124
    v_and_b32 v127, 0xffff0000, v126
    v_lshlrev_b32 v126, 16, v126
    v_pk_add_f32 v[110:111], v[110:111], v[120:121]
    v_pk_add_f32 v[110:111], v[110:111], v[122:123]
    v_pk_add_f32 v[110:111], v[110:111], v[124:125]
    v_pk_add_f32 v[110:111], v[110:111], v[126:127]
K1_g5:
    ds_read_b64_tr_b16 v[40:41], v12 offset:0
    ds_read_b64_tr_b16 v[42:43], v12 offset:2048
    s_waitcnt lgkmcnt(2)
    v_mfma_f32_16x16x32_bf16 v[128:131], v[56:59], v[80:83], v[128:131]
    v_mfma_f32_16x16x32_bf16 v[132:135], v[56:59], v[84:87], v[132:135]
    s_waitcnt vmcnt(10)
    s_barrier
    s_add_u32 m0, s32, 81920
    s_add_u32 s34, s31, 1351680
    buffer_load_dwordx4 v6, s[16:19], s34 offen lds
    s_add_u32 m0, s32, 83968
    s_add_u32 s34, s31, 1367040
    buffer_load_dwordx4 v6, s[16:19], s34 offen lds
    ds_read_b64_tr_b16 v[44:45], v8 offset:16384
    ds_read_b64_tr_b16 v[46:47], v8 offset:18432
    v_mfma_f32_16x16x32_bf16 v[136:139], v[60:63], v[80:83], v[136:139]
    v_mfma_f32_16x16x32_bf16 v[140:143], v[60:63], v[84:87], v[140:143]
    ds_read_b64_tr_b16 v[48:49], v9 offset:16384
    ds_read_b64_tr_b16 v[50:51], v9 offset:18432
    v_mfma_f32_16x16x32_bf16 v[144:147], v[32:35], v[80:83], v[144:147]
    v_mfma_f32_16x16x32_bf16 v[148:151], v[32:35], v[84:87], v[148:151]
    ds_read_b64_tr_b16 v[52:53], v10 offset:16384
    ds_read_b64_tr_b16 v[54:55], v10 offset:18432
    v_mfma_f32_16x16x32_bf16 v[152:155], v[36:39], v[80:83], v[152:155]
    v_mfma_f32_16x16x32_bf16 v[156:159], v[36:39], v[84:87], v[156:159]
    ds_read_b64_tr_b16 v[56:57], v11 offset:16384
    ds_read_b64_tr_b16 v[58:59], v11 offset:18432
    s_waitcnt lgkmcnt(8)
    v_mfma_f32_16x16x32_bf16 v[160:163], v[40:43], v[80:83], v[160:163]
    v_mfma_f32_16x16x32_bf16 v[164:167], v[40:43], v[84:87], v[164:167]
    s_cmp_eq_u32 s29, 6
    s_cbranch_scc0 K1_g6
    v_lshlrev_b32 v112, 16, v168
    v_and_b32 v113, 0xffff0000, v168
    v_lshlrev_b32 v114, 16, v169
    v_and_b32 v115, 0xffff0000, v169
    v_lshlrev_b32 v116, 16, v170
    v_and_b32 v117, 0xffff0000, v170
    v_lshlrev_b32 v118, 16, v171
    v_and_b32 v119, 0xffff0000, v171
    v_lshlrev_b32 v120, 16, v80
    v_and_b32 v121, 0xffff0000, v80
    v_lshlrev_b32 v122, 16, v81
    v_and_b32 v123, 0xffff0000, v81
    v_lshlrev_b32 v124, 16, v82
    v_and_b32 v125, 0xffff0000, v82
    v_lshlrev_b32 v126, 16, v83
    v_and_b32 v127, 0xffff0000, v83
    v_pk_mul_f32 v[120:121], v[120:121], v[112:113]
    v_pk_mul_f32 v[122:123], v[122:123], v[114:115]
    v_pk_mul_f32 v[124:125], v[124:125], v[116:117]
    v_pk_mul_f32 v[126:127], v[126:127], v[118:119]
    v_cvt_pk_bf16_f32 v120, v120, v121
    v_cvt_pk_bf16_f32 v122, v122, v123
    v_cvt_pk_bf16_f32 v124, v124, v125
    v_cvt_pk_bf16_f32 v126, v126, v127
    v_and_b32 v121, 0xffff0000, v120
    v_lshlrev_b32 v120, 16, v120
    v_and_b32 v123, 0xffff0000, v122
    v_lshlrev_b32 v122, 16, v122
    v_and_b32 v125, 0xffff0000, v124
    v_lshlrev_b32 v124, 16, v124
    v_and_b32 v127, 0xffff0000, v126
    v_lshlrev_b32 v126, 16, v126
    v_pk_add_f32 v[108:109], v[108:109], v[120:121]
    v_pk_add_f32 v[108:109], v[108:109], v[122:123]
    v_pk_add_f32 v[108:109], v[108:109], v[124:125]
    v_pk_add_f32 v[108:109], v[108:109], v[126:127]
    v_lshlrev_b32 v120, 16, v84
    v_and_b32 v121, 0xffff0000, v84
    v_lshlrev_b32 v122, 16, v85
    v_and_b32 v123, 0xffff0000, v85
    v_lshlrev_b32 v124, 16, v86
    v_and_b32 v125, 0xffff0000, v86
    v_lshlrev_b32 v126, 16, v87
    v_and_b32 v127, 0xffff0000, v87
    v_pk_mul_f32 v[120:121], v[120:121], v[112:113]
    v_pk_mul_f32 v[122:123], v[122:123], v[114:115]
    v_pk_mul_f32 v[124:125], v[124:125], v[116:117]
    v_pk_mul_f32 v[126:127], v[126:127], v[118:119]
    v_cvt_pk_bf16_f32 v120, v120, v121
    v_cvt_pk_bf16_f32 v122, v122, v123
    v_cvt_pk_bf16_f32 v124, v124, v125
    v_cvt_pk_bf16_f32 v126, v126, v127
    v_and_b32 v121, 0xffff0000, v120
    v_lshlrev_b32 v120, 16, v120
    v_and_b32 v123, 0xffff0000, v122
    v_lshlrev_b32 v122, 16, v122
    v_and_b32 v125, 0xffff0000, v124
    v_lshlrev_b32 v124, 16, v124
    v_and_b32 v127, 0xffff0000, v126
    v_lshlrev_b32 v126, 16, v126
    v_pk_add_f32 v[110:111], v[110:111], v[120:121]
    v_pk_add_f32 v[110:111], v[110:111], v[122:123]
    v_pk_add_f32 v[110:111], v[110:111], v[124:125]
    v_pk_add_f32 v[110:111], v[110:111], v[126:127]
K1_g6:
    ds_read_b64_tr_b16 v[60:61], v12 offset:16384
    ds_read_b64_tr_b16 v[62:63], v12 offset:18432
    s_waitcnt lgkmcnt(8)
    v_mfma_f32_16x16x32_bf16 v[128:131], v[44:47], v[88:91], v[128:131]
    v_mfma_f32_16x16x32_bf16 v[132:135], v[44:47], v[92:95], v[132:135]
    s_waitcnt vmcnt(10)
    s_waitcnt vmcnt(8)
    s_barrier
    s_add_u32 m0, s32, 0
    s_add_u32 s34, s31, 1474560
    buffer_load_dwordx4 v6, s[16:19], s34 offen lds
    s_add_u32 m0, s32, 2048
    s_add_u32 s34, s31, 1489920
    buffer_load_dwordx4 v6, s[16:19], s34 offen lds
    s_add_u32 m0, s76, 8192
    s_add_u32 s34, s77, 768
    buffer_load_dwordx4 v30, s[12:15], s34 offen lds
    s_add_u32 m0, s76, 9216
    s_add_u32 s34, s77, 11008
    buffer_load_dwordx4 v31, s[12:15], s34 offen lds
    ds_read_b64_tr_b16 v[32:33], v8 offset:32768
    ds_read_b64_tr_b16 v[34:35], v8 offset:34816
    ds_read_b128 v[64:67], v28 offset:0
    s_waitcnt lgkmcnt(9)
    v_mfma_f32_16x16x32_bf16 v[136:139], v[48:51], v[88:91], v[136:139]
    v_mfma_f32_16x16x32_bf16 v[140:143], v[48:51], v[92:95], v[140:143]
    ds_read_b64_tr_b16 v[36:37], v9 offset:32768
    ds_read_b64_tr_b16 v[38:39], v9 offset:34816
    ds_read_b128 v[68:71], v28 offset:2048
    s_waitcnt lgkmcnt(10)
    v_mfma_f32_16x16x32_bf16 v[144:147], v[52:55], v[88:91], v[144:147]
    v_mfma_f32_16x16x32_bf16 v[148:151], v[52:55], v[92:95], v[148:151]
    ds_read_b64_tr_b16 v[40:41], v10 offset:32768
    ds_read_b64_tr_b16 v[42:43], v10 offset:34816
    ds_read_b128 v[72:75], v29 offset:0
    s_waitcnt lgkmcnt(11)
    v_mfma_f32_16x16x32_bf16 v[152:155], v[56:59], v[88:91], v[152:155]
    v_mfma_f32_16x16x32_bf16 v[156:159], v[56:59], v[92:95], v[156:159]
    ds_read_b64_tr_b16 v[44:45], v11 offset:32768
    ds_read_b64_tr_b16 v[46:47], v11 offset:34816
    ds_read_b128 v[76:79], v29 offset:2048
    s_waitcnt lgkmcnt(12)
    v_mfma_f32_16x16x32_bf16 v[160:163], v[60:63], v[88:91], v[160:163]
    v_mfma_f32_16x16x32_bf16 v[164:167], v[60:63], v[92:95], v[164:167]
    s_cmp_eq_u32 s29, 7
    s_cbranch_scc0 K1_g7
    v_lshlrev_b32 v112, 16, v168
    v_and_b32 v113, 0xffff0000, v168
    v_lshlrev_b32 v114, 16, v169
    v_and_b32 v115, 0xffff0000, v169
    v_lshlrev_b32 v116, 16, v170
    v_and_b32 v117, 0xffff0000, v170
    v_lshlrev_b32 v118, 16, v171
    v_and_b32 v119, 0xffff0000, v171
    v_lshlrev_b32 v120, 16, v88
    v_and_b32 v121, 0xffff0000, v88
    v_lshlrev_b32 v122, 16, v89
    v_and_b32 v123, 0xffff0000, v89
    v_lshlrev_b32 v124, 16, v90
    v_and_b32 v125, 0xffff0000, v90
    v_lshlrev_b32 v126, 16, v91
    v_and_b32 v127, 0xffff0000, v91
    v_pk_mul_f32 v[120:121], v[120:121], v[112:113]
    v_pk_mul_f32 v[122:123], v[122:123], v[114:115]
    v_pk_mul_f32 v[124:125], v[124:125], v[116:117]
    v_pk_mul_f32 v[126:127], v[126:127], v[118:119]
    v_cvt_pk_bf16_f32 v120, v120, v121
    v_cvt_pk_bf16_f32 v122, v122, v123
    v_cvt_pk_bf16_f32 v124, v124, v125
    v_cvt_pk_bf16_f32 v126, v126, v127
    v_and_b32 v121, 0xffff0000, v120
    v_lshlrev_b32 v120, 16, v120
    v_and_b32 v123, 0xffff0000, v122
    v_lshlrev_b32 v122, 16, v122
    v_and_b32 v125, 0xffff0000, v124
    v_lshlrev_b32 v124, 16, v124
    v_and_b32 v127, 0xffff0000, v126
    v_lshlrev_b32 v126, 16, v126
    v_pk_add_f32 v[108:109], v[108:109], v[120:121]
    v_pk_add_f32 v[108:109], v[108:109], v[122:123]
    v_pk_add_f32 v[108:109], v[108:109], v[124:125]
    v_pk_add_f32 v[108:109], v[108:109], v[126:127]
    v_lshlrev_b32 v120, 16, v92
    v_and_b32 v121, 0xffff0000, v92
    v_lshlrev_b32 v122, 16, v93
    v_and_b32 v123, 0xffff0000, v93
    v_lshlrev_b32 v124, 16, v94
    v_and_b32 v125, 0xffff0000, v94
    v_lshlrev_b32 v126, 16, v95
    v_and_b32 v127, 0xffff0000, v95
    v_pk_mul_f32 v[120:121], v[120:121], v[112:113]
    v_pk_mul_f32 v[122:123], v[122:123], v[114:115]
    v_pk_mul_f32 v[124:125], v[124:125], v[116:117]
    v_pk_mul_f32 v[126:127], v[126:127], v[118:119]
    v_cvt_pk_bf16_f32 v120, v120, v121
    v_cvt_pk_bf16_f32 v122, v122, v123
    v_cvt_pk_bf16_f32 v124, v124, v125
    v_cvt_pk_bf16_f32 v126, v126, v127
    v_and_b32 v121, 0xffff0000, v120
    v_lshlrev_b32 v120, 16, v120
    v_and_b32 v123, 0xffff0000, v122
    v_lshlrev_b32 v122, 16, v122
    v_and_b32 v125, 0xffff0000, v124
    v_lshlrev_b32 v124, 16, v124
    v_and_b32 v127, 0xffff0000, v126
    v_lshlrev_b32 v126, 16, v126
    v_pk_add_f32 v[110:111], v[110:111], v[120:121]
    v_pk_add_f32 v[110:111], v[110:111], v[122:123]
    v_pk_add_f32 v[110:111], v[110:111], v[124:125]
    v_pk_add_f32 v[110:111], v[110:111], v[126:127]
K1_g7:
    ds_read_b64_tr_b16 v[48:49], v12 offset:32768
    ds_read_b64_tr_b16 v[50:51], v12 offset:34816
    s_waitcnt lgkmcnt(2)
    v_mfma_f32_16x16x32_bf16 v[128:131], v[32:35], v[64:67], v[128:131]
    v_mfma_f32_16x16x32_bf16 v[132:135], v[32:35], v[68:71], v[132:135]
    s_waitcnt vmcnt(10)
    s_barrier
    s_add_u32 m0, s32, 16384
    s_add_u32 s34, s31, 1597440
    buffer_load_dwordx4 v6, s[16:19], s34 offen lds
    s_add_u32 m0, s32, 18432
    s_add_u32 s34, s31, 1612800
    buffer_load_dwordx4 v6, s[16:19], s34 offen lds
    ds_read_b64_tr_b16 v[52:53], v8 offset:49152
    ds_read_b64_tr_b16 v[54:55], v8 offset:51200
    v_mfma_f32_16x16x32_bf16 v[136:139], v[36:39], v[64:67], v[136:139]
    v_mfma_f32_16x16x32_bf16 v[140:143], v[36:39], v[68:71], v[140:143]
    ds_read_b64_tr_b16 v[56:57], v9 offset:49152
    ds_read_b64_tr_b16 v[58:59], v9 offset:51200
    v_mfma_f32_16x16x32_bf16 v[144:147], v[40:43], v[64:67], v[144:147]
    v_mfma_f32_16x16x32_bf16 v[148:151], v[40:43], v[68:71], v[148:151]
    ds_read_b64_tr_b16 v[60:61], v10 offset:49152
    ds_read_b64_tr_b16 v[62:63], v10 offset:51200
    v_mfma_f32_16x16x32_bf16 v[152:155], v[44:47], v[64:67], v[152:155]
    v_mfma_f32_16x16x32_bf16 v[156:159], v[44:47], v[68:71], v[156:159]
    ds_read_b64_tr_b16 v[32:33], v11 offset:49152
    ds_read_b64_tr_b16 v[34:35], v11 offset:51200
    s_waitcnt lgkmcnt(8)
    v_mfma_f32_16x16x32_bf16 v[160:163], v[48:51], v[64:67], v[160:163]
    v_mfma_f32_16x16x32_bf16 v[164:167], v[48:51], v[68:71], v[164:167]
    s_cmp_eq_u32 s29, 0
    s_cbranch_scc0 K1_g8
    v_lshlrev_b32 v112, 16, v172
    v_and_b32 v113, 0xffff0000, v172
    v_lshlrev_b32 v114, 16, v173
    v_and_b32 v115, 0xffff0000, v173
    v_lshlrev_b32 v116, 16, v174
    v_and_b32 v117, 0xffff0000, v174
    v_lshlrev_b32 v118, 16, v175
    v_and_b32 v119, 0xffff0000, v175
    v_lshlrev_b32 v120, 16, v64
    v_and_b32 v121, 0xffff0000, v64
    v_lshlrev_b32 v122, 16, v65
    v_and_b32 v123, 0xffff0000, v65
    v_lshlrev_b32 v124, 16, v66
    v_and_b32 v125, 0xffff0000, v66
    v_lshlrev_b32 v126, 16, v67
    v_and_b32 v127, 0xffff0000, v67
    v_pk_mul_f32 v[120:121], v[120:121], v[112:113]
    v_pk_mul_f32 v[122:123], v[122:123], v[114:115]
    v_pk_mul_f32 v[124:125], v[124:125], v[116:117]
    v_pk_mul_f32 v[126:127], v[126:127], v[118:119]
    v_cvt_pk_bf16_f32 v120, v120, v121
    v_cvt_pk_bf16_f32 v122, v122, v123
    v_cvt_pk_bf16_f32 v124, v124, v125
    v_cvt_pk_bf16_f32 v126, v126, v127
    v_and_b32 v121, 0xffff0000, v120
    v_lshlrev_b32 v120, 16, v120
    v_and_b32 v123, 0xffff0000, v122
    v_lshlrev_b32 v122, 16, v122
    v_and_b32 v125, 0xffff0000, v124
    v_lshlrev_b32 v124, 16, v124
    v_and_b32 v127, 0xffff0000, v126
    v_lshlrev_b32 v126, 16, v126
    v_pk_add_f32 v[108:109], v[108:109], v[120:121]
    v_pk_add_f32 v[108:109], v[108:109], v[122:123]
    v_pk_add_f32 v[108:109], v[108:109], v[124:125]
    v_pk_add_f32 v[108:109], v[108:109], v[126:127]
    v_lshlrev_b32 v120, 16, v68
    v_and_b32 v121, 0xffff0000, v68
    v_lshlrev_b32 v122, 16, v69
    v_and_b32 v123, 0xffff0000, v69
    v_lshlrev_b32 v124, 16, v70
    v_and_b32 v125, 0xffff0000, v70
    v_lshlrev_b32 v126, 16, v71
    v_and_b32 v127, 0xffff0000, v71
    v_pk_mul_f32 v[120:121], v[120:121], v[112:113]
    v_pk_mul_f32 v[122:123], v[122:123], v[114:115]
    v_pk_mul_f32 v[124:125], v[124:125], v[116:117]
    v_pk_mul_f32 v[126:127], v[126:127], v[118:119]
    v_cvt_pk_bf16_f32 v120, v120, v121
    v_cvt_pk_bf16_f32 v122, v122, v123
    v_cvt_pk_bf16_f32 v124, v124, v125
    v_cvt_pk_bf16_f32 v126, v126, v127
    v_and_b32 v121, 0xffff0000, v120
    v_lshlrev_b32 v120, 16, v120
    v_and_b32 v123, 0xffff0000, v122
    v_lshlrev_b32 v122, 16, v122
    v_and_b32 v125, 0xffff0000, v124
    v_lshlrev_b32 v124, 16, v124
    v_and_b32 v127, 0xffff0000, v126
    v_lshlrev_b32 v126, 16, v126
    v_pk_add_f32 v[110:111], v[110:111], v[120:121]
    v_pk_add_f32 v[110:111], v[110:111], v[122:123]
    v_pk_add_f32 v[110:111], v[110:111], v[124:125]
    v_pk_add_f32 v[110:111], v[110:111], v[126:127]
K1_g8:
    ds_read_b64_tr_b16 v[36:37], v12 offset:49152
    ds_read_b64_tr_b16 v[38:39], v12 offset:51200
    s_waitcnt lgkmcnt(8)
    v_mfma_f32_16x16x32_bf16 v[128:131], v[52:55], v[72:75], v[128:131]
    v_mfma_f32_16x16x32_bf16 v[132:135], v[52:55], v[76:79], v[132:135]
    s_waitcnt vmcnt(10)
    s_waitcnt vmcnt(8)
    s_barrier
    s_add_u32 m0, s32, 32768
    s_add_u32 s34, s31, 1720320
    buffer_load_dwordx4 v6, s[16:19], s34 offen lds
    s_add_u32 m0, s32, 34816
    s_add_u32 s34, s31, 1735680
    buffer_load_dwordx4 v6, s[16:19], s34 offen lds
    s_add_u32 m0, s76, 12288
    s_add_u32 s34, s77, 896
    buffer_load_dwordx4 v30, s[12:15], s34 offen lds
    s_add_u32 m0, s76, 13312
    s_add_u32 s34, s77, 11136
    buffer_load_dwordx4 v31, s[12:15], s34 offen lds
    ds_read_b64_tr_b16 v[40:41], v18 offset:0
    ds_read_b64_tr_b16 v[42:43], v18 offset:2048
    ds_read_b128 v[80:83], v28 offset:4096
    s_waitcnt lgkmcnt(9)
    v_mfma_f32_16x16x32_bf16 v[136:139], v[56:59], v[72:75], v[136:139]
    v_mfma_f32_16x16x32_bf16 v[140:143], v[56:59], v[76:79], v[140:143]
    ds_read_b64_tr_b16 v[44:45], v19 offset:0
    ds_read_b64_tr_b16 v[46:47], v19 offset:2048
    ds_read_b128 v[84:87], v28 offset:6144
    s_waitcnt lgkmcnt(10)
    v_mfma_f32_16x16x32_bf16 v[144:147], v[60:63], v[72:75], v[144:147]
    v_mfma_f32_16x16x32_bf16 v[148:151], v[60:63], v[76:79], v[148:151]
    ds_read_b64_tr_b16 v[48:49], v20 offset:0
    ds_read_b64_tr_b16 v[50:51], v20 offset:2048
    ds_read_b128 v[88:91], v29 offset:4096
    s_waitcnt lgkmcnt(11)
    v_mfma_f32_16x16x32_bf16 v[152:155], v[32:35], v[72:75], v[152:155]
    v_mfma_f32_16x16x32_bf16 v[156:159], v[32:35], v[76:79], v[156:159]
    ds_read_b64_tr_b16 v[52:53], v21 offset:0
    ds_read_b64_tr_b16 v[54:55], v21 offset:2048
    ds_read_b128 v[92:95], v29 offset:6144
    s_waitcnt lgkmcnt(12)
    v_mfma_f32_16x16x32_bf16 v[160:163], v[36:39], v[72:75], v[160:163]
    v_mfma_f32_16x16x32_bf16 v[164:167], v[36:39], v[76:79], v[164:167]
    s_cmp_eq_u32 s29, 1
    s_cbranch_scc0 K1_g9
    v_lshlrev_b32 v112, 16, v172
    v_and_b32 v113, 0xffff0000, v172
    v_lshlrev_b32 v114, 16, v173
    v_and_b32 v115, 0xffff0000, v173
    v_lshlrev_b32 v116, 16, v174
    v_and_b32 v117, 0xffff0000, v174
    v_lshlrev_b32 v118, 16, v175
    v_and_b32 v119, 0xffff0000, v175
    v_lshlrev_b32 v120, 16, v72
    v_and_b32 v121, 0xffff0000, v72
    v_lshlrev_b32 v122, 16, v73
    v_and_b32 v123, 0xffff0000, v73
    v_lshlrev_b32 v124, 16, v74
    v_and_b32 v125, 0xffff0000, v74
    v_lshlrev_b32 v126, 16, v75
    v_and_b32 v127, 0xffff0000, v75
    v_pk_mul_f32 v[120:121], v[120:121], v[112:113]
    v_pk_mul_f32 v[122:123], v[122:123], v[114:115]
    v_pk_mul_f32 v[124:125], v[124:125], v[116:117]
    v_pk_mul_f32 v[126:127], v[126:127], v[118:119]
    v_cvt_pk_bf16_f32 v120, v120, v121
    v_cvt_pk_bf16_f32 v122, v122, v123
    v_cvt_pk_bf16_f32 v124, v124, v125
    v_cvt_pk_bf16_f32 v126, v126, v127
    v_and_b32 v121, 0xffff0000, v120
    v_lshlrev_b32 v120, 16, v120
    v_and_b32 v123, 0xffff0000, v122
    v_lshlrev_b32 v122, 16, v122
    v_and_b32 v125, 0xffff0000, v124
    v_lshlrev_b32 v124, 16, v124
    v_and_b32 v127, 0xffff0000, v126
    v_lshlrev_b32 v126, 16, v126
    v_pk_add_f32 v[108:109], v[108:109], v[120:121]
    v_pk_add_f32 v[108:109], v[108:109], v[122:123]
    v_pk_add_f32 v[108:109], v[108:109], v[124:125]
    v_pk_add_f32 v[108:109], v[108:109], v[126:127]
    v_lshlrev_b32 v120, 16, v76
    v_and_b32 v121, 0xffff0000, v76
    v_lshlrev_b32 v122, 16, v77
    v_and_b32 v123, 0xffff0000, v77
    v_lshlrev_b32 v124, 16, v78
    v_and_b32 v125, 0xffff0000, v78
    v_lshlrev_b32 v126, 16, v79
    v_and_b32 v127, 0xffff0000, v79
    v_pk_mul_f32 v[120:121], v[120:121], v[112:113]
    v_pk_mul_f32 v[122:123], v[122:123], v[114:115]
    v_pk_mul_f32 v[124:125], v[124:125], v[116:117]
    v_pk_mul_f32 v[126:127], v[126:127], v[118:119]
    v_cvt_pk_bf16_f32 v120, v120, v121
    v_cvt_pk_bf16_f32 v122, v122, v123
    v_cvt_pk_bf16_f32 v124, v124, v125
    v_cvt_pk_bf16_f32 v126, v126, v127
    v_and_b32 v121, 0xffff0000, v120
    v_lshlrev_b32 v120, 16, v120
    v_and_b32 v123, 0xffff0000, v122
    v_lshlrev_b32 v122, 16, v122
    v_and_b32 v125, 0xffff0000, v124
    v_lshlrev_b32 v124, 16, v124
    v_and_b32 v127, 0xffff0000, v126
    v_lshlrev_b32 v126, 16, v126
    v_pk_add_f32 v[110:111], v[110:111], v[120:121]
    v_pk_add_f32 v[110:111], v[110:111], v[122:123]
    v_pk_add_f32 v[110:111], v[110:111], v[124:125]
    v_pk_add_f32 v[110:111], v[110:111], v[126:127]
K1_g9:
    ds_read_b64_tr_b16 v[56:57], v22 offset:0
    ds_read_b64_tr_b16 v[58:59], v22 offset:2048
    s_waitcnt lgkmcnt(2)
    v_mfma_f32_16x16x32_bf16 v[128:131], v[40:43], v[80:83], v[128:131]
    v_mfma_f32_16x16x32_bf16 v[132:135], v[40:43], v[84:87], v[132:135]
    s_waitcnt vmcnt(10)
    s_barrier
    s_add_u32 m0, s32, 49152
    s_add_u32 s34, s31, 1843200
    buffer_load_dwordx4 v6, s[16:19], s34 offen lds
    s_add_u32 m0, s32, 51200
    s_add_u32 s34, s31, 1858560
    buffer_load_dwordx4 v6, s[16:19], s34 offen lds
    ds_read_b64_tr_b16 v[60:61], v18 offset:16384
    ds_read_b64_tr_b16 v[62:63], v18 offset:18432
    v_mfma_f32_16x16x32_bf16 v[136:139], v[44:47], v[80:83], v[136:139]
    v_mfma_f32_16x16x32_bf16 v[140:143], v[44:47], v[84:87], v[140:143]
    ds_read_b64_tr_b16 v[32:33], v19 offset:16384
    ds_read_b64_tr_b16 v[34:35], v19 offset:18432
    v_mfma_f32_16x16x32_bf16 v[144:147], v[48:51], v[80:83], v[144:147]
    v_mfma_f32_16x16x32_bf16 v[148:151], v[48:51], v[84:87], v[148:151]
    ds_read_b64_tr_b16 v[36:37], v20 offset:16384
    ds_read_b64_tr_b16 v[38:39], v20 offset:18432
    v_mfma_f32_16x16x32_bf16 v[152:155], v[52:55], v[80:83], v[152:155]
    v_mfma_f32_16x16x32_bf16 v[156:159], v[52:55], v[84:87], v[156:159]
    ds_read_b64_tr_b16 v[40:41], v21 offset:16384
    ds_read_b64_tr_b16 v[42:43], v21 offset:18432
    s_waitcnt lgkmcnt(8)
    v_mfma_f32_16x16x32_bf16 v[160:163], v[56:59], v[80:83], v[160:163]
    v_mfma_f32_16x16x32_bf16 v[164:167], v[56:59], v[84:87], v[164:167]
    s_cmp_eq_u32 s29, 2
    s_cbranch_scc0 K1_g10
    v_lshlrev_b32 v112, 16, v172
    v_and_b32 v113, 0xffff0000, v172
    v_lshlrev_b32 v114, 16, v173
    v_and_b32 v115, 0xffff0000, v173
    v_lshlrev_b32 v116, 16, v174
    v_and_b32 v117, 0xffff0000, v174
    v_lshlrev_b32 v118, 16, v175
    v_and_b32 v119, 0xffff0000, v175
    v_lshlrev_b32 v120, 16, v80
    v_and_b32 v121, 0xffff0000, v80
    v_lshlrev_b32 v122, 16, v81
    v_and_b32 v123, 0xffff0000, v81
    v_lshlrev_b32 v124, 16, v82
    v_and_b32 v125, 0xffff0000, v82
    v_lshlrev_b32 v126, 16, v83
    v_and_b32 v127, 0xffff0000, v83
    v_pk_mul_f32 v[120:121], v[120:121], v[112:113]
    v_pk_mul_f32 v[122:123], v[122:123], v[114:115]
    v_pk_mul_f32 v[124:125], v[124:125], v[116:117]
    v_pk_mul_f32 v[126:127], v[126:127], v[118:119]
    v_cvt_pk_bf16_f32 v120, v120, v121
    v_cvt_pk_bf16_f32 v122, v122, v123
    v_cvt_pk_bf16_f32 v124, v124, v125
    v_cvt_pk_bf16_f32 v126, v126, v127
    v_and_b32 v121, 0xffff0000, v120
    v_lshlrev_b32 v120, 16, v120
    v_and_b32 v123, 0xffff0000, v122
    v_lshlrev_b32 v122, 16, v122
    v_and_b32 v125, 0xffff0000, v124
    v_lshlrev_b32 v124, 16, v124
    v_and_b32 v127, 0xffff0000, v126
    v_lshlrev_b32 v126, 16, v126
    v_pk_add_f32 v[108:109], v[108:109], v[120:121]
    v_pk_add_f32 v[108:109], v[108:109], v[122:123]
    v_pk_add_f32 v[108:109], v[108:109], v[124:125]
    v_pk_add_f32 v[108:109], v[108:109], v[126:127]
    v_lshlrev_b32 v120, 16, v84
    v_and_b32 v121, 0xffff0000, v84
    v_lshlrev_b32 v122, 16, v85
    v_and_b32 v123, 0xffff0000, v85
    v_lshlrev_b32 v124, 16, v86
    v_and_b32 v125, 0xffff0000, v86
    v_lshlrev_b32 v126, 16, v87
    v_and_b32 v127, 0xffff0000, v87
    v_pk_mul_f32 v[120:121], v[120:121], v[112:113]
    v_pk_mul_f32 v[122:123], v[122:123], v[114:115]
    v_pk_mul_f32 v[124:125], v[124:125], v[116:117]
    v_pk_mul_f32 v[126:127], v[126:127], v[118:119]
    v_cvt_pk_bf16_f32 v120, v120, v121
    v_cvt_pk_bf16_f32 v122, v122, v123
    v_cvt_pk_bf16_f32 v124, v124, v125
    v_cvt_pk_bf16_f32 v126, v126, v127
    v_and_b32 v121, 0xffff0000, v120
    v_lshlrev_b32 v120, 16, v120
    v_and_b32 v123, 0xffff0000, v122
    v_lshlrev_b32 v122, 16, v122
    v_and_b32 v125, 0xffff0000, v124
    v_lshlrev_b32 v124, 16, v124
    v_and_b32 v127, 0xffff0000, v126
    v_lshlrev_b32 v126, 16, v126
    v_pk_add_f32 v[110:111], v[110:111], v[120:121]
    v_pk_add_f32 v[110:111], v[110:111], v[122:123]
    v_pk_add_f32 v[110:111], v[110:111], v[124:125]
    v_pk_add_f32 v[110:111], v[110:111], v[126:127]
K1_g10:
    ds_read_b64_tr_b16 v[44:45], v22 offset:16384
    ds_read_b64_tr_b16 v[46:47], v22 offset:18432
    s_waitcnt lgkmcnt(8)
    v_mfma_f32_16x16x32_bf16 v[128:131], v[60:63], v[88:91], v[128:131]
    v_mfma_f32_16x16x32_bf16 v[132:135], v[60:63], v[92:95], v[132:135]
    s_waitcnt vmcnt(10)
    s_waitcnt vmcnt(8)
    s_barrier
    s_add_u32 m0, s32, 65536
    s_add_u32 s34, s31, 1966080
    buffer_load_dwordx4 v6, s[16:19], s34 offen lds
    s_add_u32 m0, s32, 67584
    s_add_u32 s34, s31, 1981440
    buffer_load_dwordx4 v6, s[16:19], s34 offen lds
    s_add_u32 m0, s76, 0
    s_add_u32 s34, s77, 1024
    buffer_load_dwordx4 v30, s[12:15], s34 offen lds
    s_add_u32 m0, s76, 1024
    s_add_u32 s34, s77, 11264
    buffer_load_dwordx4 v31, s[12:15], s34 offen lds
    ds_read_b64_tr_b16 v[48:49], v8 offset:0
    ds_read_b64_tr_b16 v[50:51], v8 offset:2048
    ds_read_b128 v[64:67], v28 offset:8192
    s_waitcnt lgkmcnt(9)
    v_mfma_f32_16x16x32_bf16 v[136:139], v[32:35], v[88:91], v[136:139]
    v_mfma_f32_16x16x32_bf16 v[140:143], v[32:35], v[92:95], v[140:143]
    ds_read_b64_tr_b16 v[52:53], v9 offset:0
    ds_read_b64_tr_b16 v[54:55], v9 offset:2048
    ds_read_b128 v[68:71], v28 offset:10240
    s_waitcnt lgkmcnt(10)
    v_mfma_f32_16x16x32_bf16 v[144:147], v[36:39], v[88:91], v[144:147]
    v_mfma_f32_16x16x32_bf16 v[148:151], v[36:39], v[92:95], v[148:151]
    ds_read_b64_tr_b16 v[56:57], v10 offset:0
    ds_read_b64_tr_b16 v[58:59], v10 offset:2048
    ds_read_b128 v[72:75], v29 offset:8192
    s_waitcnt lgkmcnt(11)
    v_mfma_f32_16x16x32_bf16 v[152:155], v[40:43], v[88:91], v[152:155]
    v_mfma_f32_16x16x32_bf16 v[156:159], v[40:43], v[92:95], v[156:159]
    ds_read_b64_tr_b16 v[60:61], v11 offset:0
    ds_read_b64_tr_b16 v[62:63], v11 offset:2048
    ds_read_b128 v[76:79], v29 offset:10240
    s_waitcnt lgkmcnt(12)
    v_mfma_f32_16x16x32_bf16 v[160:163], v[44:47], v[88:91], v[160:163]
    v_mfma_f32_16x16x32_bf16 v[164:167], v[44:47], v[92:95], v[164:167]
    s_cmp_eq_u32 s29, 3
    s_cbranch_scc0 K1_g11
    v_lshlrev_b32 v112, 16, v172
    v_and_b32 v113, 0xffff0000, v172
    v_lshlrev_b32 v114, 16, v173
    v_and_b32 v115, 0xffff0000, v173
    v_lshlrev_b32 v116, 16, v174
    v_and_b32 v117, 0xffff0000, v174
    v_lshlrev_b32 v118, 16, v175
    v_and_b32 v119, 0xffff0000, v175
    v_lshlrev_b32 v120, 16, v88
    v_and_b32 v121, 0xffff0000, v88
    v_lshlrev_b32 v122, 16, v89
    v_and_b32 v123, 0xffff0000, v89
    v_lshlrev_b32 v124, 16, v90
    v_and_b32 v125, 0xffff0000, v90
    v_lshlrev_b32 v126, 16, v91
    v_and_b32 v127, 0xffff0000, v91
    v_pk_mul_f32 v[120:121], v[120:121], v[112:113]
    v_pk_mul_f32 v[122:123], v[122:123], v[114:115]
    v_pk_mul_f32 v[124:125], v[124:125], v[116:117]
    v_pk_mul_f32 v[126:127], v[126:127], v[118:119]
    v_cvt_pk_bf16_f32 v120, v120, v121
    v_cvt_pk_bf16_f32 v122, v122, v123
    v_cvt_pk_bf16_f32 v124, v124, v125
    v_cvt_pk_bf16_f32 v126, v126, v127
    v_and_b32 v121, 0xffff0000, v120
    v_lshlrev_b32 v120, 16, v120
    v_and_b32 v123, 0xffff0000, v122
    v_lshlrev_b32 v122, 16, v122
    v_and_b32 v125, 0xffff0000, v124
    v_lshlrev_b32 v124, 16, v124
    v_and_b32 v127, 0xffff0000, v126
    v_lshlrev_b32 v126, 16, v126
    v_pk_add_f32 v[108:109], v[108:109], v[120:121]
    v_pk_add_f32 v[108:109], v[108:109], v[122:123]
    v_pk_add_f32 v[108:109], v[108:109], v[124:125]
    v_pk_add_f32 v[108:109], v[108:109], v[126:127]
    v_lshlrev_b32 v120, 16, v92
    v_and_b32 v121, 0xffff0000, v92
    v_lshlrev_b32 v122, 16, v93
    v_and_b32 v123, 0xffff0000, v93
    v_lshlrev_b32 v124, 16, v94
    v_and_b32 v125, 0xffff0000, v94
    v_lshlrev_b32 v126, 16, v95
    v_and_b32 v127, 0xffff0000, v95
    v_pk_mul_f32 v[120:121], v[120:121], v[112:113]
    v_pk_mul_f32 v[122:123], v[122:123], v[114:115]
    v_pk_mul_f32 v[124:125], v[124:125], v[116:117]
    v_pk_mul_f32 v[126:127], v[126:127], v[118:119]
    v_cvt_pk_bf16_f32 v120, v120, v121
    v_cvt_pk_bf16_f32 v122, v122, v123
    v_cvt_pk_bf16_f32 v124, v124, v125
    v_cvt_pk_bf16_f32 v126, v126, v127
    v_and_b32 v121, 0xffff0000, v120
    v_lshlrev_b32 v120, 16, v120
    v_and_b32 v123, 0xffff0000, v122
    v_lshlrev_b32 v122, 16, v122
    v_and_b32 v125, 0xffff0000, v124
    v_lshlrev_b32 v124, 16, v124
    v_and_b32 v127, 0xffff0000, v126
    v_lshlrev_b32 v126, 16, v126
    v_pk_add_f32 v[110:111], v[110:111], v[120:121]
    v_pk_add_f32 v[110:111], v[110:111], v[122:123]
    v_pk_add_f32 v[110:111], v[110:111], v[124:125]
    v_pk_add_f32 v[110:111], v[110:111], v[126:127]
K1_g11:
    ds_read_b64_tr_b16 v[32:33], v12 offset:0
    ds_read_b64_tr_b16 v[34:35], v12 offset:2048
    s_waitcnt lgkmcnt(2)
    v_mfma_f32_16x16x32_bf16 v[128:131], v[48:51], v[64:67], v[128:131]
    v_mfma_f32_16x16x32_bf16 v[132:135], v[48:51], v[68:71], v[132:135]
    s_waitcnt vmcnt(10)
    s_barrier
    s_add_u32 m0, s32, 81920
    s_add_u32 s34, s31, 2088960
    buffer_load_dwordx4 v6, s[16:19], s34 offen lds
    s_add_u32 m0, s32, 83968
    s_add_u32 s34, s31, 2104320
    buffer_load_dwordx4 v6, s[16:19], s34 offen lds
    ds_read_b64_tr_b16 v[36:37], v8 offset:16384
    ds_read_b64_tr_b16 v[38:39], v8 offset:18432
    v_mfma_f32_16x16x32_bf16 v[136:139], v[52:55], v[64:67], v[136:139]
    v_mfma_f32_16x16x32_bf16 v[140:143], v[52:55], v[68:71], v[140:143]
    ds_read_b64_tr_b16 v[40:41], v9 offset:16384
    ds_read_b64_tr_b16 v[42:43], v9 offset:18432
    v_mfma_f32_16x16x32_bf16 v[144:147], v[56:59], v[64:67], v[144:147]
    v_mfma_f32_16x16x32_bf16 v[148:151], v[56:59], v[68:71], v[148:151]
    ds_read_b64_tr_b16 v[44:45], v10 offset:16384
    ds_read_b64_tr_b16 v[46:47], v10 offset:18432
    v_mfma_f32_16x16x32_bf16 v[152:155], v[60:63], v[64:67], v[152:155]
    v_mfma_f32_16x16x32_bf16 v[156:159], v[60:63], v[68:71], v[156:159]
    ds_read_b64_tr_b16 v[48:49], v11 offset:16384
    ds_read_b64_tr_b16 v[50:51], v11 offset:18432
    s_waitcnt lgkmcnt(8)
    v_mfma_f32_16x16x32_bf16 v[160:163], v[32:35], v[64:67], v[160:163]
    v_mfma_f32_16x16x32_bf16 v[164:167], v[32:35], v[68:71], v[164:167]
    s_cmp_eq_u32 s29, 4
    s_cbranch_scc0 K1_g12
    v_lshlrev_b32 v112, 16, v172
    v_and_b32 v113, 0xffff0000, v172
    v_lshlrev_b32 v114, 16, v173
    v_and_b32 v115, 0xffff0000, v173
    v_lshlrev_b32 v116, 16, v174
    v_and_b32 v117, 0xffff0000, v174
    v_lshlrev_b32 v118, 16, v175
    v_and_b32 v119, 0xffff0000, v175
    v_lshlrev_b32 v120, 16, v64
    v_and_b32 v121, 0xffff0000, v64
    v_lshlrev_b32 v122, 16, v65
    v_and_b32 v123, 0xffff0000, v65
    v_lshlrev_b32 v124, 16, v66
    v_and_b32 v125, 0xffff0000, v66
    v_lshlrev_b32 v126, 16, v67
    v_and_b32 v127, 0xffff0000, v67
    v_pk_mul_f32 v[120:121], v[120:121], v[112:113]
    v_pk_mul_f32 v[122:123], v[122:123], v[114:115]
    v_pk_mul_f32 v[124:125], v[124:125], v[116:117]
    v_pk_mul_f32 v[126:127], v[126:127], v[118:119]
    v_cvt_pk_bf16_f32 v120, v120, v121
    v_cvt_pk_bf16_f32 v122, v122, v123
    v_cvt_pk_bf16_f32 v124, v124, v125
    v_cvt_pk_bf16_f32 v126, v126, v127
    v_and_b32 v121, 0xffff0000, v120
    v_lshlrev_b32 v120, 16, v120
    v_and_b32 v123, 0xffff0000, v122
    v_lshlrev_b32 v122, 16, v122
    v_and_b32 v125, 0xffff0000, v124
    v_lshlrev_b32 v124, 16, v124
    v_and_b32 v127, 0xffff0000, v126
    v_lshlrev_b32 v126, 16, v126
    v_pk_add_f32 v[108:109], v[108:109], v[120:121]
    v_pk_add_f32 v[108:109], v[108:109], v[122:123]
    v_pk_add_f32 v[108:109], v[108:109], v[124:125]
    v_pk_add_f32 v[108:109], v[108:109], v[126:127]
    v_lshlrev_b32 v120, 16, v68
    v_and_b32 v121, 0xffff0000, v68
    v_lshlrev_b32 v122, 16, v69
    v_and_b32 v123, 0xffff0000, v69
    v_lshlrev_b32 v124, 16, v70
    v_and_b32 v125, 0xffff0000, v70
    v_lshlrev_b32 v126, 16, v71
    v_and_b32 v127, 0xffff0000, v71
    v_pk_mul_f32 v[120:121], v[120:121], v[112:113]
    v_pk_mul_f32 v[122:123], v[122:123], v[114:115]
    v_pk_mul_f32 v[124:125], v[124:125], v[116:117]
    v_pk_mul_f32 v[126:127], v[126:127], v[118:119]
    v_cvt_pk_bf16_f32 v120, v120, v121
    v_cvt_pk_bf16_f32 v122, v122, v123
    v_cvt_pk_bf16_f32 v124, v124, v125
    v_cvt_pk_bf16_f32 v126, v126, v127
    v_and_b32 v121, 0xffff0000, v120
    v_lshlrev_b32 v120, 16, v120
    v_and_b32 v123, 0xffff0000, v122
    v_lshlrev_b32 v122, 16, v122
    v_and_b32 v125, 0xffff0000, v124
    v_lshlrev_b32 v124, 16, v124
    v_and_b32 v127, 0xffff0000, v126
    v_lshlrev_b32 v126, 16, v126
    v_pk_add_f32 v[110:111], v[110:111], v[120:121]
    v_pk_add_f32 v[110:111], v[110:111], v[122:123]
    v_pk_add_f32 v[110:111], v[110:111], v[124:125]
    v_pk_add_f32 v[110:111], v[110:111], v[126:127]
K1_g12:
    ds_read_b64_tr_b16 v[52:53], v12 offset:16384
    ds_read_b64_tr_b16 v[54:55], v12 offset:18432
    s_waitcnt lgkmcnt(8)
    v_mfma_f32_16x16x32_bf16 v[128:131], v[36:39], v[72:75], v[128:131]
    v_mfma_f32_16x16x32_bf16 v[132:135], v[36:39], v[76:79], v[132:135]
    s_waitcnt vmcnt(10)
    s_waitcnt vmcnt(8)
    s_barrier
    s_add_u32 m0, s32, 0
    s_add_u32 s34, s31, 2211840
    buffer_load_dwordx4 v6, s[16:19], s34 offen lds
    s_add_u32 m0, s32, 2048
    s_add_u32 s34, s31, 2227200
    buffer_load_dwordx4 v6, s[16:19], s34 offen lds
    s_add_u32 m0, s76, 4096
    s_add_u32 s34, s77, 1152
    buffer_load_dwordx4 v30, s[12:15], s34 offen lds
    s_add_u32 m0, s76, 5120
    s_add_u32 s34, s77, 11392
    buffer_load_dwordx4 v31, s[12:15], s34 offen lds
    ds_read_b64_tr_b16 v[56:57], v8 offset:32768
    ds_read_b64_tr_b16 v[58:59], v8 offset:34816
    ds_read_b128 v[80:83], v28 offset:12288
    s_waitcnt lgkmcnt(9)
    v_mfma_f32_16x16x32_bf16 v[136:139], v[40:43], v[72:75], v[136:139]
    v_mfma_f32_16x16x32_bf16 v[140:143], v[40:43], v[76:79], v[140:143]
    ds_read_b64_tr_b16 v[60:61], v9 offset:32768
    ds_read_b64_tr_b16 v[62:63], v9 offset:34816
    ds_read_b128 v[84:87], v28 offset:14336
    s_waitcnt lgkmcnt(10)
    v_mfma_f32_16x16x32_bf16 v[144:147], v[44:47], v[72:75], v[144:147]
    v_mfma_f32_16x16x32_bf16 v[148:151], v[44:47], v[76:79], v[148:151]
    ds_read_b64_tr_b16 v[32:33], v10 offset:32768
    ds_read_b64_tr_b16 v[34:35], v10 offset:34816
    ds_read_b128 v[88:91], v29 offset:12288
    s_waitcnt lgkmcnt(11)
    v_mfma_f32_16x16x32_bf16 v[152:155], v[48:51], v[72:75], v[152:155]
    v_mfma_f32_16x16x32_bf16 v[156:159], v[48:51], v[76:79], v[156:159]
    ds_read_b64_tr_b16 v[36:37], v11 offset:32768
    ds_read_b64_tr_b16 v[38:39], v11 offset:34816
    ds_read_b128 v[92:95], v29 offset:14336
    s_waitcnt lgkmcnt(12)
    v_mfma_f32_16x16x32_bf16 v[160:163], v[52:55], v[72:75], v[160:163]
    v_mfma_f32_16x16x32_bf16 v[164:167], v[52:55], v[76:79], v[164:167]
    s_cmp_eq_u32 s29, 5
    s_cbranch_scc0 K1_g13
    v_lshlrev_b32 v112, 16, v172
    v_and_b32 v113, 0xffff0000, v172
    v_lshlrev_b32 v114, 16, v173
    v_and_b32 v115, 0xffff0000, v173
    v_lshlrev_b32 v116, 16, v174
    v_and_b32 v117, 0xffff0000, v174
    v_lshlrev_b32 v118, 16, v175
    v_and_b32 v119, 0xffff0000, v175
    v_lshlrev_b32 v120, 16, v72
    v_and_b32 v121, 0xffff0000, v72
    v_lshlrev_b32 v122, 16, v73
    v_and_b32 v123, 0xffff0000, v73
    v_lshlrev_b32 v124, 16, v74
    v_and_b32 v125, 0xffff0000, v74
    v_lshlrev_b32 v126, 16, v75
    v_and_b32 v127, 0xffff0000, v75
    v_pk_mul_f32 v[120:121], v[120:121], v[112:113]
    v_pk_mul_f32 v[122:123], v[122:123], v[114:115]
    v_pk_mul_f32 v[124:125], v[124:125], v[116:117]
    v_pk_mul_f32 v[126:127], v[126:127], v[118:119]
    v_cvt_pk_bf16_f32 v120, v120, v121
    v_cvt_pk_bf16_f32 v122, v122, v123
    v_cvt_pk_bf16_f32 v124, v124, v125
    v_cvt_pk_bf16_f32 v126, v126, v127
    v_and_b32 v121, 0xffff0000, v120
    v_lshlrev_b32 v120, 16, v120
    v_and_b32 v123, 0xffff0000, v122
    v_lshlrev_b32 v122, 16, v122
    v_and_b32 v125, 0xffff0000, v124
    v_lshlrev_b32 v124, 16, v124
    v_and_b32 v127, 0xffff0000, v126
    v_lshlrev_b32 v126, 16, v126
    v_pk_add_f32 v[108:109], v[108:109], v[120:121]
    v_pk_add_f32 v[108:109], v[108:109], v[122:123]
    v_pk_add_f32 v[108:109], v[108:109], v[124:125]
    v_pk_add_f32 v[108:109], v[108:109], v[126:127]
    v_lshlrev_b32 v120, 16, v76
    v_and_b32 v121, 0xffff0000, v76
    v_lshlrev_b32 v122, 16, v77
    v_and_b32 v123, 0xffff0000, v77
    v_lshlrev_b32 v124, 16, v78
    v_and_b32 v125, 0xffff0000, v78
    v_lshlrev_b32 v126, 16, v79
    v_and_b32 v127, 0xffff0000, v79
    v_pk_mul_f32 v[120:121], v[120:121], v[112:113]
    v_pk_mul_f32 v[122:123], v[122:123], v[114:115]
    v_pk_mul_f32 v[124:125], v[124:125], v[116:117]
    v_pk_mul_f32 v[126:127], v[126:127], v[118:119]
    v_cvt_pk_bf16_f32 v120, v120, v121
    v_cvt_pk_bf16_f32 v122, v122, v123
    v_cvt_pk_bf16_f32 v124, v124, v125
    v_cvt_pk_bf16_f32 v126, v126, v127
    v_and_b32 v121, 0xffff0000, v120
    v_lshlrev_b32 v120, 16, v120
    v_and_b32 v123, 0xffff0000, v122
    v_lshlrev_b32 v122, 16, v122
    v_and_b32 v125, 0xffff0000, v124
    v_lshlrev_b32 v124, 16, v124
    v_and_b32 v127, 0xffff0000, v126
    v_lshlrev_b32 v126, 16, v126
    v_pk_add_f32 v[110:111], v[110:111], v[120:121]
    v_pk_add_f32 v[110:111], v[110:111], v[122:123]
    v_pk_add_f32 v[110:111], v[110:111], v[124:125]
    v_pk_add_f32 v[110:111], v[110:111], v[126:127]
K1_g13:
    ds_read_b64_tr_b16 v[40:41], v12 offset:32768
    ds_read_b64_tr_b16 v[42:43], v12 offset:34816
    s_waitcnt lgkmcnt(2)
    v_mfma_f32_16x16x32_bf16 v[128:131], v[56:59], v[80:83], v[128:131]
    v_mfma_f32_16x16x32_bf16 v[132:135], v[56:59], v[84:87], v[132:135]
    s_waitcnt vmcnt(10)
    s_barrier
    s_add_u32 m0, s32, 16384
    s_add_u32 s34, s31, 2334720
    buffer_load_dwordx4 v6, s[16:19], s34 offen lds
    s_add_u32 m0, s32, 18432
    s_add_u32 s34, s31, 2350080
    buffer_load_dwordx4 v6, s[16:19], s34 offen lds
    ds_read_b64_tr_b16 v[44:45], v8 offset:49152
    ds_read_b64_tr_b16 v[46:47], v8 offset:51200
    v_mfma_f32_16x16x32_bf16 v[136:139], v[60:63], v[80:83], v[136:139]
    v_mfma_f32_16x16x32_bf16 v[140:143], v[60:63], v[84:87], v[140:143]
    ds_read_b64_tr_b16 v[48:49], v9 offset:49152
    ds_read_b64_tr_b16 v[50:51], v9 offset:51200
    v_mfma_f32_16x16x32_bf16 v[144:147], v[32:35], v[80:83], v[144:147]
    v_mfma_f32_16x16x32_bf16 v[148:151], v[32:35], v[84:87], v[148:151]
    ds_read_b64_tr_b16 v[52:53], v10 offset:49152
    ds_read_b64_tr_b16 v[54:55], v10 offset:51200
    v_mfma_f32_16x16x32_bf16 v[152:155], v[36:39], v[80:83], v[152:155]
    v_mfma_f32_16x16x32_bf16 v[156:159], v[36:39], v[84:87], v[156:159]
    ds_read_b64_tr_b16 v[56:57], v11 offset:49152
    ds_read_b64_tr_b16 v[58:59], v11 offset:51200
    s_waitcnt lgkmcnt(8)
    v_mfma_f32_16x16x32_bf16 v[160:163], v[40:43], v[80:83], v[160:163]
    v_mfma_f32_16x16x32_bf16 v[164:167], v[40:43], v[84:87], v[164:167]
    s_cmp_eq_u32 s29, 6
    s_cbranch_scc0 K1_g14
    v_lshlrev_b32 v112, 16, v172
    v_and_b32 v113, 0xffff0000, v172
    v_lshlrev_b32 v114, 16, v173
    v_and_b32 v115, 0xffff0000, v173
    v_lshlrev_b32 v116, 16, v174
    v_and_b32 v117, 0xffff0000, v174
    v_lshlrev_b32 v118, 16, v175
    v_and_b32 v119, 0xffff0000, v175
    v_lshlrev_b32 v120, 16, v80
    v_and_b32 v121, 0xffff0000, v80
    v_lshlrev_b32 v122, 16, v81
    v_and_b32 v123, 0xffff0000, v81
    v_lshlrev_b32 v124, 16, v82
    v_and_b32 v125, 0xffff0000, v82
    v_lshlrev_b32 v126, 16, v83
    v_and_b32 v127, 0xffff0000, v83
    v_pk_mul_f32 v[120:121], v[120:121], v[112:113]
    v_pk_mul_f32 v[122:123], v[122:123], v[114:115]
    v_pk_mul_f32 v[124:125], v[124:125], v[116:117]
    v_pk_mul_f32 v[126:127], v[126:127], v[118:119]
    v_cvt_pk_bf16_f32 v120, v120, v121
    v_cvt_pk_bf16_f32 v122, v122, v123
    v_cvt_pk_bf16_f32 v124, v124, v125
    v_cvt_pk_bf16_f32 v126, v126, v127
    v_and_b32 v121, 0xffff0000, v120
    v_lshlrev_b32 v120, 16, v120
    v_and_b32 v123, 0xffff0000, v122
    v_lshlrev_b32 v122, 16, v122
    v_and_b32 v125, 0xffff0000, v124
    v_lshlrev_b32 v124, 16, v124
    v_and_b32 v127, 0xffff0000, v126
    v_lshlrev_b32 v126, 16, v126
    v_pk_add_f32 v[108:109], v[108:109], v[120:121]
    v_pk_add_f32 v[108:109], v[108:109], v[122:123]
    v_pk_add_f32 v[108:109], v[108:109], v[124:125]
    v_pk_add_f32 v[108:109], v[108:109], v[126:127]
    v_lshlrev_b32 v120, 16, v84
    v_and_b32 v121, 0xffff0000, v84
    v_lshlrev_b32 v122, 16, v85
    v_and_b32 v123, 0xffff0000, v85
    v_lshlrev_b32 v124, 16, v86
    v_and_b32 v125, 0xffff0000, v86
    v_lshlrev_b32 v126, 16, v87
    v_and_b32 v127, 0xffff0000, v87
    v_pk_mul_f32 v[120:121], v[120:121], v[112:113]
    v_pk_mul_f32 v[122:123], v[122:123], v[114:115]
    v_pk_mul_f32 v[124:125], v[124:125], v[116:117]
    v_pk_mul_f32 v[126:127], v[126:127], v[118:119]
    v_cvt_pk_bf16_f32 v120, v120, v121
    v_cvt_pk_bf16_f32 v122, v122, v123
    v_cvt_pk_bf16_f32 v124, v124, v125
    v_cvt_pk_bf16_f32 v126, v126, v127
    v_and_b32 v121, 0xffff0000, v120
    v_lshlrev_b32 v120, 16, v120
    v_and_b32 v123, 0xffff0000, v122
    v_lshlrev_b32 v122, 16, v122
    v_and_b32 v125, 0xffff0000, v124
    v_lshlrev_b32 v124, 16, v124
    v_and_b32 v127, 0xffff0000, v126
    v_lshlrev_b32 v126, 16, v126
    v_pk_add_f32 v[110:111], v[110:111], v[120:121]
    v_pk_add_f32 v[110:111], v[110:111], v[122:123]
    v_pk_add_f32 v[110:111], v[110:111], v[124:125]
    v_pk_add_f32 v[110:111], v[110:111], v[126:127]
K1_g14:
    ds_read_b64_tr_b16 v[60:61], v12 offset:49152
    ds_read_b64_tr_b16 v[62:63], v12 offset:51200
    s_waitcnt lgkmcnt(8)
    v_mfma_f32_16x16x32_bf16 v[128:131], v[44:47], v[88:91], v[128:131]
    v_mfma_f32_16x16x32_bf16 v[132:135], v[44:47], v[92:95], v[132:135]
    s_waitcnt vmcnt(10)
    s_waitcnt vmcnt(8)
    s_barrier
    ds_read_b64_tr_b16 v[32:33], v18 offset:0
    ds_read_b64_tr_b16 v[34:35], v18 offset:2048
    ds_read_b128 v[64:67], v28 offset:0
    s_waitcnt lgkmcnt(9)
    v_mfma_f32_16x16x32_bf16 v[136:139], v[48:51], v[88:91], v[136:139]
    v_mfma_f32_16x16x32_bf16 v[140:143], v[48:51], v[92:95], v[140:143]
    ds_read_b64_tr_b16 v[36:37], v19 offset:0
    ds_read_b64_tr_b16 v[38:39], v19 offset:2048
    ds_read_b128 v[68:71], v28 offset:2048
    s_waitcnt lgkmcnt(10)
    v_mfma_f32_16x16x32_bf16 v[144:147], v[52:55], v[88:91], v[144:147]
    v_mfma_f32_16x16x32_bf16 v[148:151], v[52:55], v[92:95], v[148:151]
    ds_read_b64_tr_b16 v[40:41], v20 offset:0
    ds_read_b64_tr_b16 v[42:43], v20 offset:2048
    ds_read_b128 v[72:75], v29 offset:0
    s_waitcnt lgkmcnt(11)
    v_mfma_f32_16x16x32_bf16 v[152:155], v[56:59], v[88:91], v[152:155]
    v_mfma_f32_16x16x32_bf16 v[156:159], v[56:59], v[92:95], v[156:159]
    ds_read_b64_tr_b16 v[44:45], v21 offset:0
    ds_read_b64_tr_b16 v[46:47], v21 offset:2048
    ds_read_b128 v[76:79], v29 offset:2048
    s_waitcnt lgkmcnt(12)
    v_mfma_f32_16x16x32_bf16 v[160:163], v[60:63], v[88:91], v[160:163]
    v_mfma_f32_16x16x32_bf16 v[164:167], v[60:63], v[92:95], v[164:167]
    s_cmp_eq_u32 s29, 7
    s_cbranch_scc0 K1_g15
    v_lshlrev_b32 v112, 16, v172
    v_and_b32 v113, 0xffff0000, v172
    v_lshlrev_b32 v114, 16, v173
    v_and_b32 v115, 0xffff0000, v173
    v_lshlrev_b32 v116, 16, v174
    v_and_b32 v117, 0xffff0000, v174
    v_lshlrev_b32 v118, 16, v175
    v_and_b32 v119, 0xffff0000, v175
    v_lshlrev_b32 v120, 16, v88
    v_and_b32 v121, 0xffff0000, v88
    v_lshlrev_b32 v122, 16, v89
    v_and_b32 v123, 0xffff0000, v89
    v_lshlrev_b32 v124, 16, v90
    v_and_b32 v125, 0xffff0000, v90
    v_lshlrev_b32 v126, 16, v91
    v_and_b32 v127, 0xffff0000, v91
    v_pk_mul_f32 v[120:121], v[120:121], v[112:113]
    v_pk_mul_f32 v[122:123], v[122:123], v[114:115]
    v_pk_mul_f32 v[124:125], v[124:125], v[116:117]
    v_pk_mul_f32 v[126:127], v[126:127], v[118:119]
    v_cvt_pk_bf16_f32 v120, v120, v121
    v_cvt_pk_bf16_f32 v122, v122, v123
    v_cvt_pk_bf16_f32 v124, v124, v125
    v_cvt_pk_bf16_f32 v126, v126, v127
    v_and_b32 v121, 0xffff0000, v120
    v_lshlrev_b32 v120, 16, v120
    v_and_b32 v123, 0xffff0000, v122
    v_lshlrev_b32 v122, 16, v122
    v_and_b32 v125, 0xffff0000, v124
    v_lshlrev_b32 v124, 16, v124
    v_and_b32 v127, 0xffff0000, v126
    v_lshlrev_b32 v126, 16, v126
    v_pk_add_f32 v[108:109], v[108:109], v[120:121]
    v_pk_add_f32 v[108:109], v[108:109], v[122:123]
    v_pk_add_f32 v[108:109], v[108:109], v[124:125]
    v_pk_add_f32 v[108:109], v[108:109], v[126:127]
    v_lshlrev_b32 v120, 16, v92
    v_and_b32 v121, 0xffff0000, v92
    v_lshlrev_b32 v122, 16, v93
    v_and_b32 v123, 0xffff0000, v93
    v_lshlrev_b32 v124, 16, v94
    v_and_b32 v125, 0xffff0000, v94
    v_lshlrev_b32 v126, 16, v95
    v_and_b32 v127, 0xffff0000, v95
    v_pk_mul_f32 v[120:121], v[120:121], v[112:113]
    v_pk_mul_f32 v[122:123], v[122:123], v[114:115]
    v_pk_mul_f32 v[124:125], v[124:125], v[116:117]
    v_pk_mul_f32 v[126:127], v[126:127], v[118:119]
    v_cvt_pk_bf16_f32 v120, v120, v121
    v_cvt_pk_bf16_f32 v122, v122, v123
    v_cvt_pk_bf16_f32 v124, v124, v125
    v_cvt_pk_bf16_f32 v126, v126, v127
    v_and_b32 v121, 0xffff0000, v120
    v_lshlrev_b32 v120, 16, v120
    v_and_b32 v123, 0xffff0000, v122
    v_lshlrev_b32 v122, 16, v122
    v_and_b32 v125, 0xffff0000, v124
    v_lshlrev_b32 v124, 16, v124
    v_and_b32 v127, 0xffff0000, v126
    v_lshlrev_b32 v126, 16, v126
    v_pk_add_f32 v[110:111], v[110:111], v[120:121]
    v_pk_add_f32 v[110:111], v[110:111], v[122:123]
    v_pk_add_f32 v[110:111], v[110:111], v[124:125]
    v_pk_add_f32 v[110:111], v[110:111], v[126:127]
K1_g15:
    ds_read_b64_tr_b16 v[48:49], v22 offset:0
    ds_read_b64_tr_b16 v[50:51], v22 offset:2048
    s_waitcnt lgkmcnt(2)
    v_mfma_f32_16x16x32_bf16 v[128:131], v[32:35], v[64:67], v[128:131]
    v_mfma_f32_16x16x32_bf16 v[132:135], v[32:35], v[68:71], v[132:135]
    s_waitcnt vmcnt(6)
    s_barrier
    ds_read_b64_tr_b16 v[52:53], v18 offset:16384
    ds_read_b64_tr_b16 v[54:55], v18 offset:18432
    v_mfma_f32_16x16x32_bf16 v[136:139], v[36:39], v[64:67], v[136:139]
    v_mfma_f32_16x16x32_bf16 v[140:143], v[36:39], v[68:71], v[140:143]
    ds_read_b64_tr_b16 v[56:57], v19 offset:16384
    ds_read_b64_tr_b16 v[58:59], v19 offset:18432
    v_mfma_f32_16x16x32_bf16 v[144:147], v[40:43], v[64:67], v[144:147]
    v_mfma_f32_16x16x32_bf16 v[148:151], v[40:43], v[68:71], v[148:151]
    ds_read_b64_tr_b16 v[60:61], v20 offset:16384
    ds_read_b64_tr_b16 v[62:63], v20 offset:18432
    v_mfma_f32_16x16x32_bf16 v[152:155], v[44:47], v[64:67], v[152:155]
    v_mfma_f32_16x16x32_bf16 v[156:159], v[44:47], v[68:71], v[156:159]
    ds_read_b64_tr_b16 v[32:33], v21 offset:16384
    ds_read_b64_tr_b16 v[34:35], v21 offset:18432
    s_waitcnt lgkmcnt(8)
    v_mfma_f32_16x16x32_bf16 v[160:163], v[48:51], v[64:67], v[160:163]
    v_mfma_f32_16x16x32_bf16 v[164:167], v[48:51], v[68:71], v[164:167]
    s_cmp_eq_u32 s29, 0
    s_cbranch_scc0 K1_g16
    v_lshlrev_b32 v112, 16, v176
    v_and_b32 v113, 0xffff0000, v176
    v_lshlrev_b32 v114, 16, v177
    v_and_b32 v115, 0xffff0000, v177
    v_lshlrev_b32 v116, 16, v178
    v_and_b32 v117, 0xffff0000, v178
    v_lshlrev_b32 v118, 16, v179
    v_and_b32 v119, 0xffff0000, v179
    v_lshlrev_b32 v120, 16, v64
    v_and_b32 v121, 0xffff0000, v64
    v_lshlrev_b32 v122, 16, v65
    v_and_b32 v123, 0xffff0000, v65
    v_lshlrev_b32 v124, 16, v66
    v_and_b32 v125, 0xffff0000, v66
    v_lshlrev_b32 v126, 16, v67
    v_and_b32 v127, 0xffff0000, v67
    v_pk_mul_f32 v[120:121], v[120:121], v[112:113]
    v_pk_mul_f32 v[122:123], v[122:123], v[114:115]
    v_pk_mul_f32 v[124:125], v[124:125], v[116:117]
    v_pk_mul_f32 v[126:127], v[126:127], v[118:119]
    v_cvt_pk_bf16_f32 v120, v120, v121
    v_cvt_pk_bf16_f32 v122, v122, v123
    v_cvt_pk_bf16_f32 v124, v124, v125
    v_cvt_pk_bf16_f32 v126, v126, v127
    v_and_b32 v121, 0xffff0000, v120
    v_lshlrev_b32 v120, 16, v120
    v_and_b32 v123, 0xffff0000, v122
    v_lshlrev_b32 v122, 16, v122
    v_and_b32 v125, 0xffff0000, v124
    v_lshlrev_b32 v124, 16, v124
    v_and_b32 v127, 0xffff0000, v126
    v_lshlrev_b32 v126, 16, v126
    v_pk_add_f32 v[108:109], v[108:109], v[120:121]
    v_pk_add_f32 v[108:109], v[108:109], v[122:123]
    v_pk_add_f32 v[108:109], v[108:109], v[124:125]
    v_pk_add_f32 v[108:109], v[108:109], v[126:127]
    v_lshlrev_b32 v120, 16, v68
    v_and_b32 v121, 0xffff0000, v68
    v_lshlrev_b32 v122, 16, v69
    v_and_b32 v123, 0xffff0000, v69
    v_lshlrev_b32 v124, 16, v70
    v_and_b32 v125, 0xffff0000, v70
    v_lshlrev_b32 v126, 16, v71
    v_and_b32 v127, 0xffff0000, v71
    v_pk_mul_f32 v[120:121], v[120:121], v[112:113]
    v_pk_mul_f32 v[122:123], v[122:123], v[114:115]
    v_pk_mul_f32 v[124:125], v[124:125], v[116:117]
    v_pk_mul_f32 v[126:127], v[126:127], v[118:119]
    v_cvt_pk_bf16_f32 v120, v120, v121
    v_cvt_pk_bf16_f32 v122, v122, v123
    v_cvt_pk_bf16_f32 v124, v124, v125
    v_cvt_pk_bf16_f32 v126, v126, v127
    v_and_b32 v121, 0xffff0000, v120
    v_lshlrev_b32 v120, 16, v120
    v_and_b32 v123, 0xffff0000, v122
    v_lshlrev_b32 v122, 16, v122
    v_and_b32 v125, 0xffff0000, v124
    v_lshlrev_b32 v124, 16, v124
    v_and_b32 v127, 0xffff0000, v126
    v_lshlrev_b32 v126, 16, v126
    v_pk_add_f32 v[110:111], v[110:111], v[120:121]
    v_pk_add_f32 v[110:111], v[110:111], v[122:123]
    v_pk_add_f32 v[110:111], v[110:111], v[124:125]
    v_pk_add_f32 v[110:111], v[110:111], v[126:127]
K1_g16:
    ds_read_b64_tr_b16 v[36:37], v22 offset:16384
    ds_read_b64_tr_b16 v[38:39], v22 offset:18432
    s_waitcnt lgkmcnt(8)
    v_mfma_f32_16x16x32_bf16 v[128:131], v[52:55], v[72:75], v[128:131]
    v_mfma_f32_16x16x32_bf16 v[132:135], v[52:55], v[76:79], v[132:135]
    s_waitcnt vmcnt(4)
    s_waitcnt vmcnt(2)
    s_barrier
    ds_read_b64_tr_b16 v[40:41], v8 offset:0
    ds_read_b64_tr_b16 v[42:43], v8 offset:2048
    ds_read_b128 v[80:83], v28 offset:4096
    s_waitcnt lgkmcnt(9)
    v_mfma_f32_16x16x32_bf16 v[136:139], v[56:59], v[72:75], v[136:139]
    v_mfma_f32_16x16x32_bf16 v[140:143], v[56:59], v[76:79], v[140:143]
    ds_read_b64_tr_b16 v[44:45], v9 offset:0
    ds_read_b64_tr_b16 v[46:47], v9 offset:2048
    ds_read_b128 v[84:87], v28 offset:6144
    s_waitcnt lgkmcnt(10)
    v_mfma_f32_16x16x32_bf16 v[144:147], v[60:63], v[72:75], v[144:147]
    v_mfma_f32_16x16x32_bf16 v[148:151], v[60:63], v[76:79], v[148:151]
    ds_read_b64_tr_b16 v[48:49], v10 offset:0
    ds_read_b64_tr_b16 v[50:51], v10 offset:2048
    ds_read_b128 v[88:91], v29 offset:4096
    s_waitcnt lgkmcnt(11)
    v_mfma_f32_16x16x32_bf16 v[152:155], v[32:35], v[72:75], v[152:155]
    v_mfma_f32_16x16x32_bf16 v[156:159], v[32:35], v[76:79], v[156:159]
    ds_read_b64_tr_b16 v[52:53], v11 offset:0
    ds_read_b64_tr_b16 v[54:55], v11 offset:2048
    ds_read_b128 v[92:95], v29 offset:6144
    s_waitcnt lgkmcnt(12)
    v_mfma_f32_16x16x32_bf16 v[160:163], v[36:39], v[72:75], v[160:163]
    v_mfma_f32_16x16x32_bf16 v[164:167], v[36:39], v[76:79], v[164:167]
    s_cmp_eq_u32 s29, 1
    s_cbranch_scc0 K1_g17
    v_lshlrev_b32 v112, 16, v176
    v_and_b32 v113, 0xffff0000, v176
    v_lshlrev_b32 v114, 16, v177
    v_and_b32 v115, 0xffff0000, v177
    v_lshlrev_b32 v116, 16, v178
    v_and_b32 v117, 0xffff0000, v178
    v_lshlrev_b32 v118, 16, v179
    v_and_b32 v119, 0xffff0000, v179
    v_lshlrev_b32 v120, 16, v72
    v_and_b32 v121, 0xffff0000, v72
    v_lshlrev_b32 v122, 16, v73
    v_and_b32 v123, 0xffff0000, v73
    v_lshlrev_b32 v124, 16, v74
    v_and_b32 v125, 0xffff0000, v74
    v_lshlrev_b32 v126, 16, v75
    v_and_b32 v127, 0xffff0000, v75
    v_pk_mul_f32 v[120:121], v[120:121], v[112:113]
    v_pk_mul_f32 v[122:123], v[122:123], v[114:115]
    v_pk_mul_f32 v[124:125], v[124:125], v[116:117]
    v_pk_mul_f32 v[126:127], v[126:127], v[118:119]
    v_cvt_pk_bf16_f32 v120, v120, v121
    v_cvt_pk_bf16_f32 v122, v122, v123
    v_cvt_pk_bf16_f32 v124, v124, v125
    v_cvt_pk_bf16_f32 v126, v126, v127
    v_and_b32 v121, 0xffff0000, v120
    v_lshlrev_b32 v120, 16, v120
    v_and_b32 v123, 0xffff0000, v122
    v_lshlrev_b32 v122, 16, v122
    v_and_b32 v125, 0xffff0000, v124
    v_lshlrev_b32 v124, 16, v124
    v_and_b32 v127, 0xffff0000, v126
    v_lshlrev_b32 v126, 16, v126
    v_pk_add_f32 v[108:109], v[108:109], v[120:121]
    v_pk_add_f32 v[108:109], v[108:109], v[122:123]
    v_pk_add_f32 v[108:109], v[108:109], v[124:125]
    v_pk_add_f32 v[108:109], v[108:109], v[126:127]
    v_lshlrev_b32 v120, 16, v76
    v_and_b32 v121, 0xffff0000, v76
    v_lshlrev_b32 v122, 16, v77
    v_and_b32 v123, 0xffff0000, v77
    v_lshlrev_b32 v124, 16, v78
    v_and_b32 v125, 0xffff0000, v78
    v_lshlrev_b32 v126, 16, v79
    v_and_b32 v127, 0xffff0000, v79
    v_pk_mul_f32 v[120:121], v[120:121], v[112:113]
    v_pk_mul_f32 v[122:123], v[122:123], v[114:115]
    v_pk_mul_f32 v[124:125], v[124:125], v[116:117]
    v_pk_mul_f32 v[126:127], v[126:127], v[118:119]
    v_cvt_pk_bf16_f32 v120, v120, v121
    v_cvt_pk_bf16_f32 v122, v122, v123
    v_cvt_pk_bf16_f32 v124, v124, v125
    v_cvt_pk_bf16_f32 v126, v126, v127
    v_and_b32 v121, 0xffff0000, v120
    v_lshlrev_b32 v120, 16, v120
    v_and_b32 v123, 0xffff0000, v122
    v_lshlrev_b32 v122, 16, v122
    v_and_b32 v125, 0xffff0000, v124
    v_lshlrev_b32 v124, 16, v124
    v_and_b32 v127, 0xffff0000, v126
    v_lshlrev_b32 v126, 16, v126
    v_pk_add_f32 v[110:111], v[110:111], v[120:121]
    v_pk_add_f32 v[110:111], v[110:111], v[122:123]
    v_pk_add_f32 v[110:111], v[110:111], v[124:125]
    v_pk_add_f32 v[110:111], v[110:111], v[126:127]
K1_g17:
    ds_read_b64_tr_b16 v[56:57], v12 offset:0
    ds_read_b64_tr_b16 v[58:59], v12 offset:2048
    s_waitcnt lgkmcnt(2)
    v_mfma_f32_16x16x32_bf16 v[128:131], v[40:43], v[80:83], v[128:131]
    v_mfma_f32_16x16x32_bf16 v[132:135], v[40:43], v[84:87], v[132:135]
    s_waitcnt vmcnt(0)
    s_barrier
    s_lshl_b32 s88, s28, 3
    s_add_u32 s88, s88, s29
    s_sub_u32 s88, s88, 8
    s_lshl_b32 s88, s88, 3
    s_add_u32 s88, s88, s30
    s_cmp_lt_u32 s29, 8
    s_cselect_b32 s88, 0xffff, s88
    s_cmp_ge_u32 s88, 592
    s_cbranch_scc1 K1_nopp_q
    s_cmp_lt_u32 s88, 432
    s_cselect_b32 s80, s90, s92
    s_cselect_b32 s81, s91, s93
    s_mov_b32 s82, 819200
    s_cselect_b32 s82, 2211840, s82
    s_mov_b32 s83, 0x00020000
    s_mov_b32 s84, 19398656
    s_cselect_b32 s84, 16777216, s84
    s_mov_b32 s86, 819200
    s_cselect_b32 s86, 2211840, s86
    s_cselect_b32 s89, 0, 432
    s_cselect_b32 s33, 54, 20
    s_add_u32 s84, s84, s10
    s_addc_u32 s85, s11, 0
    s_mov_b32 s87, 0x00020000
    s_sub_u32 s89, s88, s89
    s_lshr_b32 s34, s89, 3
    s_and_b32 s89, s89, 7
    s_mul_i32 s33, s33, s89
    s_add_u32 s33, s33, s34
    s_mul_i32 s34, s34, 40960
    s_mul_i32 s89, s89, 160
    s_add_u32 s34, s34, s89
    s_mul_i32 s89, s33, 5120
    v_add_u32 v125, 0, v1
    v_mul_u32_u24 v126, 6554, v125
    v_lshrrev_b32 v126, 16, v126
    v_mul_u32_u24 v127, 10, v126
    v_sub_u32 v127, v125, v127
    v_mul_u32_u24 v126, 1280, v126
    v_lshlrev_b32 v127, 4, v127
    v_add_u32 v120, v126, v127
    v_add_u32 v125, 64, v1
    v_mul_u32_u24 v126, 6554, v125
    v_lshrrev_b32 v126, 16, v126
    v_mul_u32_u24 v127, 10, v126
    v_sub_u32 v127, v125, v127
    v_mul_u32_u24 v126, 1280, v126
    v_lshlrev_b32 v127, 4, v127
    v_add_u32 v121, v126, v127
    v_add_u32 v125, 128, v1
    v_mul_u32_u24 v126, 6554, v125
    v_lshrrev_b32 v126, 16, v126
    v_mul_u32_u24 v127, 10, v126
    v_sub_u32 v127, v125, v127
    v_mul_u32_u24 v126, 1280, v126
    v_lshlrev_b32 v127, 4, v127
    v_add_u32 v122, v126, v127
    v_add_u32 v125, 192, v1
    v_mul_u32_u24 v126, 6554, v125
    v_lshrrev_b32 v126, 16, v126
    v_mul_u32_u24 v127, 10, v126
    v_sub_u32 v127, v125, v127
    v_mul_u32_u24 v126, 1280, v126
    v_lshlrev_b32 v127, 4, v127
    v_add_u32 v123, v126, v127
    v_add_u32 v125, 256, v1
    v_mul_u32_u24 v126, 6554, v125
    v_lshrrev_b32 v126, 16, v126
    v_mul_u32_u24 v127, 10, v126
    v_sub_u32 v127, v125, v127
    v_mul_u32_u24 v126, 1280, v126
    v_lshlrev_b32 v127, 4, v127
    v_add_u32 v124, v126, v127
    s_add_u32 m0, s78, 0
    s_nop 0
    buffer_load_dwordx4 v120, s[80:83], s34 offen lds
    s_add_u32 m0, s78, 1024
    s_nop 0
    buffer_load_dwordx4 v121, s[80:83], s34 offen lds
    s_add_u32 m0, s78, 2048
    s_nop 0
    buffer_load_dwordx4 v122, s[80:83], s34 offen lds
    s_add_u32 m0, s78, 3072
    s_nop 0
    buffer_load_dwordx4 v123, s[80:83], s34 offen lds
    s_add_u32 m0, s78, 4096
    s_nop 0
    buffer_load_dwordx4 v124, s[80:83], s34 offen lds
K1_nopp_q:
    ds_read_b64_tr_b16 v[60:61], v8 offset:16384
    ds_read_b64_tr_b16 v[62:63], v8 offset:18432
    v_mfma_f32_16x16x32_bf16 v[136:139], v[44:47], v[80:83], v[136:139]
    v_mfma_f32_16x16x32_bf16 v[140:143], v[44:47], v[84:87], v[140:143]
    ds_read_b64_tr_b16 v[32:33], v9 offset:16384
    ds_read_b64_tr_b16 v[34:35], v9 offset:18432
    v_mfma_f32_16x16x32_bf16 v[144:147], v[48:51], v[80:83], v[144:147]
    v_mfma_f32_16x16x32_bf16 v[148:151], v[48:51], v[84:87], v[148:151]
    ds_read_b64_tr_b16 v[36:37], v10 offset:16384
    ds_read_b64_tr_b16 v[38:39], v10 offset:18432
    v_mfma_f32_16x16x32_bf16 v[152:155], v[52:55], v[80:83], v[152:155]
    v_mfma_f32_16x16x32_bf16 v[156:159], v[52:55], v[84:87], v[156:159]
    ds_read_b64_tr_b16 v[40:41], v11 offset:16384
    ds_read_b64_tr_b16 v[42:43], v11 offset:18432
    s_waitcnt lgkmcnt(8)
    v_mfma_f32_16x16x32_bf16 v[160:163], v[56:59], v[80:83], v[160:163]
    v_mfma_f32_16x16x32_bf16 v[164:167], v[56:59], v[84:87], v[164:167]
    s_cmp_eq_u32 s29, 2
    s_cbranch_scc0 K1_g18
    v_lshlrev_b32 v112, 16, v176
    v_and_b32 v113, 0xffff0000, v176
    v_lshlrev_b32 v114, 16, v177
    v_and_b32 v115, 0xffff0000, v177
    v_lshlrev_b32 v116, 16, v178
    v_and_b32 v117, 0xffff0000, v178
    v_lshlrev_b32 v118, 16, v179
    v_and_b32 v119, 0xffff0000, v179
    v_lshlrev_b32 v120, 16, v80
    v_and_b32 v121, 0xffff0000, v80
    v_lshlrev_b32 v122, 16, v81
    v_and_b32 v123, 0xffff0000, v81
    v_lshlrev_b32 v124, 16, v82
    v_and_b32 v125, 0xffff0000, v82
    v_lshlrev_b32 v126, 16, v83
    v_and_b32 v127, 0xffff0000, v83
    v_pk_mul_f32 v[120:121], v[120:121], v[112:113]
    v_pk_mul_f32 v[122:123], v[122:123], v[114:115]
    v_pk_mul_f32 v[124:125], v[124:125], v[116:117]
    v_pk_mul_f32 v[126:127], v[126:127], v[118:119]
    v_cvt_pk_bf16_f32 v120, v120, v121
    v_cvt_pk_bf16_f32 v122, v122, v123
    v_cvt_pk_bf16_f32 v124, v124, v125
    v_cvt_pk_bf16_f32 v126, v126, v127
    v_and_b32 v121, 0xffff0000, v120
    v_lshlrev_b32 v120, 16, v120
    v_and_b32 v123, 0xffff0000, v122
    v_lshlrev_b32 v122, 16, v122
    v_and_b32 v125, 0xffff0000, v124
    v_lshlrev_b32 v124, 16, v124
    v_and_b32 v127, 0xffff0000, v126
    v_lshlrev_b32 v126, 16, v126
    v_pk_add_f32 v[108:109], v[108:109], v[120:121]
    v_pk_add_f32 v[108:109], v[108:109], v[122:123]
    v_pk_add_f32 v[108:109], v[108:109], v[124:125]
    v_pk_add_f32 v[108:109], v[108:109], v[126:127]
    v_lshlrev_b32 v120, 16, v84
    v_and_b32 v121, 0xffff0000, v84
    v_lshlrev_b32 v122, 16, v85
    v_and_b32 v123, 0xffff0000, v85
    v_lshlrev_b32 v124, 16, v86
    v_and_b32 v125, 0xffff0000, v86
    v_lshlrev_b32 v126, 16, v87
    v_and_b32 v127, 0xffff0000, v87
    v_pk_mul_f32 v[120:121], v[120:121], v[112:113]
    v_pk_mul_f32 v[122:123], v[122:123], v[114:115]
    v_pk_mul_f32 v[124:125], v[124:125], v[116:117]
    v_pk_mul_f32 v[126:127], v[126:127], v[118:119]
    v_cvt_pk_bf16_f32 v120, v120, v121
    v_cvt_pk_bf16_f32 v122, v122, v123
    v_cvt_pk_bf16_f32 v124, v124, v125
    v_cvt_pk_bf16_f32 v126, v126, v127
    v_and_b32 v121, 0xffff0000, v120
    v_lshlrev_b32 v120, 16, v120
    v_and_b32 v123, 0xffff0000, v122
    v_lshlrev_b32 v122, 16, v122
    v_and_b32 v125, 0xffff0000, v124
    v_lshlrev_b32 v124, 16, v124
    v_and_b32 v127, 0xffff0000, v126
    v_lshlrev_b32 v126, 16, v126
    v_pk_add_f32 v[110:111], v[110:111], v[120:121]
    v_pk_add_f32 v[110:111], v[110:111], v[122:123]
    v_pk_add_f32 v[110:111], v[110:111], v[124:125]
    v_pk_add_f32 v[110:111], v[110:111], v[126:127]
K1_g18:
    ds_read_b64_tr_b16 v[44:45], v12 offset:16384
    ds_read_b64_tr_b16 v[46:47], v12 offset:18432
    s_waitcnt lgkmcnt(8)
    v_mfma_f32_16x16x32_bf16 v[128:131], v[60:63], v[88:91], v[128:131]
    v_mfma_f32_16x16x32_bf16 v[132:135], v[60:63], v[92:95], v[132:135]
    s_waitcnt lgkmcnt(6)
    v_mfma_f32_16x16x32_bf16 v[136:139], v[32:35], v[88:91], v[136:139]
    v_mfma_f32_16x16x32_bf16 v[140:143], v[32:35], v[92:95], v[140:143]
    s_waitcnt lgkmcnt(4)
    v_mfma_f32_16x16x32_bf16 v[144:147], v[36:39], v[88:91], v[144:147]
    v_mfma_f32_16x16x32_bf16 v[148:151], v[36:39], v[92:95], v[148:151]
    s_waitcnt lgkmcnt(2)
    v_mfma_f32_16x16x32_bf16 v[152:155], v[40:43], v[88:91], v[152:155]
    v_mfma_f32_16x16x32_bf16 v[156:159], v[40:43], v[92:95], v[156:159]
    s_waitcnt lgkmcnt(0)
    v_mfma_f32_16x16x32_bf16 v[160:163], v[44:47], v[88:91], v[160:163]
    v_mfma_f32_16x16x32_bf16 v[164:167], v[44:47], v[92:95], v[164:167]
    s_cmp_eq_u32 s29, 3
    s_cbranch_scc0 K1_g19
    v_lshlrev_b32 v112, 16, v176
    v_and_b32 v113, 0xffff0000, v176
    v_lshlrev_b32 v114, 16, v177
    v_and_b32 v115, 0xffff0000, v177
    v_lshlrev_b32 v116, 16, v178
    v_and_b32 v117, 0xffff0000, v178
    v_lshlrev_b32 v118, 16, v179
    v_and_b32 v119, 0xffff0000, v179
    v_lshlrev_b32 v120, 16, v88
    v_and_b32 v121, 0xffff0000, v88
    v_lshlrev_b32 v122, 16, v89
    v_and_b32 v123, 0xffff0000, v89
    v_lshlrev_b32 v124, 16, v90
    v_and_b32 v125, 0xffff0000, v90
    v_lshlrev_b32 v126, 16, v91
    v_and_b32 v127, 0xffff0000, v91
    v_pk_mul_f32 v[120:121], v[120:121], v[112:113]
    v_pk_mul_f32 v[122:123], v[122:123], v[114:115]
    v_pk_mul_f32 v[124:125], v[124:125], v[116:117]
    v_pk_mul_f32 v[126:127], v[126:127], v[118:119]
    v_cvt_pk_bf16_f32 v120, v120, v121
    v_cvt_pk_bf16_f32 v122, v122, v123
    v_cvt_pk_bf16_f32 v124, v124, v125
    v_cvt_pk_bf16_f32 v126, v126, v127
    v_and_b32 v121, 0xffff0000, v120
    v_lshlrev_b32 v120, 16, v120
    v_and_b32 v123, 0xffff0000, v122
    v_lshlrev_b32 v122, 16, v122
    v_and_b32 v125, 0xffff0000, v124
    v_lshlrev_b32 v124, 16, v124
    v_and_b32 v127, 0xffff0000, v126
    v_lshlrev_b32 v126, 16, v126
    v_pk_add_f32 v[108:109], v[108:109], v[120:121]
    v_pk_add_f32 v[108:109], v[108:109], v[122:123]
    v_pk_add_f32 v[108:109], v[108:109], v[124:125]
    v_pk_add_f32 v[108:109], v[108:109], v[126:127]
    v_lshlrev_b32 v120, 16, v92
    v_and_b32 v121, 0xffff0000, v92
    v_lshlrev_b32 v122, 16, v93
    v_and_b32 v123, 0xffff0000, v93
    v_lshlrev_b32 v124, 16, v94
    v_and_b32 v125, 0xffff0000, v94
    v_lshlrev_b32 v126, 16, v95
    v_and_b32 v127, 0xffff0000, v95
    v_pk_mul_f32 v[120:121], v[120:121], v[112:113]
    v_pk_mul_f32 v[122:123], v[122:123], v[114:115]
    v_pk_mul_f32 v[124:125], v[124:125], v[116:117]
    v_pk_mul_f32 v[126:127], v[126:127], v[118:119]
    v_cvt_pk_bf16_f32 v120, v120, v121
    v_cvt_pk_bf16_f32 v122, v122, v123
    v_cvt_pk_bf16_f32 v124, v124, v125
    v_cvt_pk_bf16_f32 v126, v126, v127
    v_and_b32 v121, 0xffff0000, v120
    v_lshlrev_b32 v120, 16, v120
    v_and_b32 v123, 0xffff0000, v122
    v_lshlrev_b32 v122, 16, v122
    v_and_b32 v125, 0xffff0000, v124
    v_lshlrev_b32 v124, 16, v124
    v_and_b32 v127, 0xffff0000, v126
    v_lshlrev_b32 v126, 16, v126
    v_pk_add_f32 v[110:111], v[110:111], v[120:121]
    v_pk_add_f32 v[110:111], v[110:111], v[122:123]
    v_pk_add_f32 v[110:111], v[110:111], v[124:125]
    v_pk_add_f32 v[110:111], v[110:111], v[126:127]
K1_g19:
    s_nop 7
    s_nop 1
    v_add_f32 v108, v108, v109
    v_add_f32 v110, v110, v111
    v_xor_b32 v10, 16, v1
    v_lshlrev_b32 v10, 2, v10
    v_xor_b32 v11, 32, v1
    v_lshlrev_b32 v11, 2, v11
    ds_bpermute_b32 v109, v10, v108
    ds_bpermute_b32 v111, v10, v110
    s_waitcnt lgkmcnt(0)
    v_add_f32 v108, v108, v109
    v_add_f32 v110, v110, v111
    ds_bpermute_b32 v109, v11, v108
    ds_bpermute_b32 v111, v11, v110
    s_waitcnt lgkmcnt(0)
    v_add_f32 v108, v108, v109
    v_add_f32 v110, v110, v111
    s_lshl_b32 s33, s28, 7
    s_lshl_b32 s34, s74, 5
    s_add_u32 s33, s33, s34
    v_and_b32 v10, 15, v1
    v_add_u32 v10, s33, v10
    v_lshlrev_b32 v10, 2, v10
    s_lshl_b32 s33, s29, 13
    buffer_store_dword v108, v10, s[64:67], s33 offen
    buffer_store_dword v110, v10, s[64:67], s33 offen offset:64
    s_lshl_b32 s33, s28, 3
    s_lshl_b32 s34, s74, 1
    s_add_u32 s33, s33, s34
    s_mul_i32 s33, s33, 20480
    v_lshlrev_b32 v2, 4, v1
    v_add_u32 v2, s33, v2
    s_mul_i32 s3, s29, 5
    v_cvt_pk_bf16_f32 v68, v128, v129
    v_cvt_pk_bf16_f32 v69, v130, v131
    v_cvt_pk_bf16_f32 v70, v136, v137
    v_cvt_pk_bf16_f32 v71, v138, v139
    v_cvt_pk_bf16_f32 v72, v144, v145
    v_cvt_pk_bf16_f32 v73, v146, v147
    v_cvt_pk_bf16_f32 v74, v152, v153
    v_cvt_pk_bf16_f32 v75, v154, v155
    v_cvt_pk_bf16_f32 v76, v160, v161
    v_cvt_pk_bf16_f32 v77, v162, v163
    v_lshlrev_b32 v8, 16, v68
    v_and_b32 v9, 0xffff0000, v68
    v_lshlrev_b32 v10, 16, v69
    v_and_b32 v11, 0xffff0000, v69
    v_lshlrev_b32 v12, 16, v70
    v_and_b32 v13, 0xffff0000, v70
    v_lshlrev_b32 v14, 16, v71
    v_and_b32 v15, 0xffff0000, v71
    v_lshlrev_b32 v16, 16, v72
    v_and_b32 v17, 0xffff0000, v72
    v_lshlrev_b32 v18, 16, v73
    v_and_b32 v19, 0xffff0000, v73
    v_lshlrev_b32 v20, 16, v74
    v_and_b32 v21, 0xffff0000, v74
    v_lshlrev_b32 v22, 16, v75
    v_and_b32 v23, 0xffff0000, v75
    v_lshlrev_b32 v24, 16, v76
    v_and_b32 v25, 0xffff0000, v76
    v_lshlrev_b32 v26, 16, v77
    v_and_b32 v27, 0xffff0000, v77
    v_mul_f32 v28, s38, v8
    v_mul_f32 v29, s38, v9
    v_mul_f32 v30, s38, v10
    v_mul_f32 v31, s38, v11
    v_mul_f32 v32, s38, v12
    v_mul_f32 v33, s38, v13
    v_mul_f32 v34, s38, v14
    v_mul_f32 v35, s38, v15
    v_mul_f32 v36, s38, v16
    v_mul_f32 v37, s38, v17
    v_mul_f32 v38, s38, v18
    v_mul_f32 v39, s38, v19
    v_mul_f32 v40, s38, v20
    v_mul_f32 v41, s38, v21
    v_mul_f32 v42, s38, v22
    v_mul_f32 v43, s38, v23
    v_mul_f32 v44, s38, v24
    v_mul_f32 v45, s38, v25
    v_mul_f32 v46, s38, v26
    v_mul_f32 v47, s38, v27
    v_exp_f32 v28, v28
    v_exp_f32 v29, v29
    v_exp_f32 v30, v30
    v_exp_f32 v31, v31
    v_exp_f32 v32, v32
    v_exp_f32 v33, v33
    v_exp_f32 v34, v34
    v_exp_f32 v35, v35
    v_exp_f32 v36, v36
    v_exp_f32 v37, v37
    v_exp_f32 v38, v38
    v_exp_f32 v39, v39
    v_exp_f32 v40, v40
    v_exp_f32 v41, v41
    v_exp_f32 v42, v42
    v_exp_f32 v43, v43
    v_exp_f32 v44, v44
    v_exp_f32 v45, v45
    v_exp_f32 v46, v46
    v_exp_f32 v47, v47
    v_add_f32 v48, 1.0, v8
    v_add_f32 v49, 1.0, v9
    v_add_f32 v50, 1.0, v10
    v_add_f32 v51, 1.0, v11
    v_add_f32 v52, 1.0, v12
    v_add_f32 v53, 1.0, v13
    v_add_f32 v54, 1.0, v14
    v_add_f32 v55, 1.0, v15
    v_add_f32 v56, 1.0, v16
    v_add_f32 v57, 1.0, v17
    v_add_f32 v58, 1.0, v18
    v_add_f32 v59, 1.0, v19
    v_add_f32 v60, 1.0, v20
    v_add_f32 v61, 1.0, v21
    v_add_f32 v62, 1.0, v22
    v_add_f32 v63, 1.0, v23
    v_add_f32 v64, 1.0, v24
    v_add_f32 v65, 1.0, v25
    v_add_f32 v66, 1.0, v26
    v_add_f32 v67, 1.0, v27
    v_cmp_gt_f32 s[40:41], v8, 0
    v_cmp_gt_f32 s[42:43], v9, 0
    v_cmp_gt_f32 s[44:45], v10, 0
    v_cmp_gt_f32 s[46:47], v11, 0
    v_cmp_gt_f32 s[48:49], v12, 0
    v_cmp_gt_f32 s[50:51], v13, 0
    v_cmp_gt_f32 s[52:53], v14, 0
    v_cmp_gt_f32 s[54:55], v15, 0
    s_nop 1
    v_cndmask_b32 v28, v28, v48, s[40:41]
    v_cndmask_b32 v29, v29, v49, s[42:43]
    v_cndmask_b32 v30, v30, v50, s[44:45]
    v_cndmask_b32 v31, v31, v51, s[46:47]
    v_cndmask_b32 v32, v32, v52, s[48:49]
    v_cndmask_b32 v33, v33, v53, s[50:51]
    v_cndmask_b32 v34, v34, v54, s[52:53]
    v_cndmask_b32 v35, v35, v55, s[54:55]
    v_cmp_gt_f32 s[40:41], v16, 0
    v_cmp_gt_f32 s[42:43], v17, 0
    v_cmp_gt_f32 s[44:45], v18, 0
    v_cmp_gt_f32 s[46:47], v19, 0
    v_cmp_gt_f32 s[48:49], v20, 0
    v_cmp_gt_f32 s[50:51], v21, 0
    v_cmp_gt_f32 s[52:53], v22, 0
    v_cmp_gt_f32 s[54:55], v23, 0
    s_nop 1
    v_cndmask_b32 v36, v36, v56, s[40:41]
    v_cndmask_b32 v37, v37, v57, s[42:43]
    v_cndmask_b32 v38, v38, v58, s[44:45]
    v_cndmask_b32 v39, v39, v59, s[46:47]
    v_cndmask_b32 v40, v40, v60, s[48:49]
    v_cndmask_b32 v41, v41, v61, s[50:51]
    v_cndmask_b32 v42, v42, v62, s[52:53]
    v_cndmask_b32 v43, v43, v63, s[54:55]
    v_cmp_gt_f32 s[40:41], v24, 0
    v_cmp_gt_f32 s[42:43], v25, 0
    v_cmp_gt_f32 s[44:45], v26, 0
    v_cmp_gt_f32 s[46:47], v27, 0
    s_nop 1
    v_cndmask_b32 v44, v44, v64, s[40:41]
    v_cndmask_b32 v45, v45, v65, s[42:43]
    v_cndmask_b32 v46, v46, v66, s[44:45]
    v_cndmask_b32 v47, v47, v67, s[46:47]
    v_cvt_pk_bf16_f32 v68, v28, v29
    v_cvt_pk_bf16_f32 v69, v30, v31
    v_cvt_pk_bf16_f32 v70, v32, v33
    v_cvt_pk_bf16_f32 v71, v34, v35
    v_cvt_pk_bf16_f32 v72, v36, v37
    v_cvt_pk_bf16_f32 v73, v38, v39
    v_cvt_pk_bf16_f32 v74, v40, v41
    v_cvt_pk_bf16_f32 v75, v42, v43
    v_cvt_pk_bf16_f32 v76, v44, v45
    v_cvt_pk_bf16_f32 v77, v46, v47
    v_lshlrev_b32 v8, 16, v68
    v_and_b32 v9, 0xffff0000, v68
    v_lshlrev_b32 v10, 16, v69
    v_and_b32 v11, 0xffff0000, v69
    v_lshlrev_b32 v12, 16, v70
    v_and_b32 v13, 0xffff0000, v70
    v_lshlrev_b32 v14, 16, v71
    v_and_b32 v15, 0xffff0000, v71
    v_lshlrev_b32 v16, 16, v72
    v_and_b32 v17, 0xffff0000, v72
    v_lshlrev_b32 v18, 16, v73
    v_and_b32 v19, 0xffff0000, v73
    v_lshlrev_b32 v20, 16, v74
    v_and_b32 v21, 0xffff0000, v74
    v_lshlrev_b32 v22, 16, v75
    v_and_b32 v23, 0xffff0000, v75
    v_lshlrev_b32 v24, 16, v76
    v_and_b32 v25, 0xffff0000, v76
    v_lshlrev_b32 v26, 16, v77
    v_and_b32 v27, 0xffff0000, v77
    v_add_f32 v8, s39, v8
    v_add_f32 v9, s39, v9
    v_add_f32 v10, s39, v10
    v_add_f32 v11, s39, v11
    v_add_f32 v12, s39, v12
    v_add_f32 v13, s39, v13
    v_add_f32 v14, s39, v14
    v_add_f32 v15, s39, v15
    v_add_f32 v16, s39, v16
    v_add_f32 v17, s39, v17
    v_add_f32 v18, s39, v18
    v_add_f32 v19, s39, v19
    v_add_f32 v20, s39, v20
    v_add_f32 v21, s39, v21
    v_add_f32 v22, s39, v22
    v_add_f32 v23, s39, v23
    v_add_f32 v24, s39, v24
    v_add_f32 v25, s39, v25
    v_add_f32 v26, s39, v26
    v_add_f32 v27, s39, v27
    v_cvt_pk_bf16_f32 v68, v8, v9
    v_cvt_pk_bf16_f32 v69, v10, v11
    v_cvt_pk_bf16_f32 v70, v12, v13
    v_cvt_pk_bf16_f32 v71, v14, v15
    v_cvt_pk_bf16_f32 v72, v16, v17
    v_cvt_pk_bf16_f32 v73, v18, v19
    v_cvt_pk_bf16_f32 v74, v20, v21
    v_cvt_pk_bf16_f32 v75, v22, v23
    v_cvt_pk_bf16_f32 v76, v24, v25
    v_cvt_pk_bf16_f32 v77, v26, v27
    s_add_u32 s33, s3, 0
    s_lshr_b32 s34, s33, 1
    s_lshl_b32 s34, s34, 10
    s_and_b32 s33, s33, 1
    s_lshl_b32 s33, s33, 3
    s_add_u32 s34, s34, s33
    s_add_u32 s34, s34, 0
    buffer_store_dwordx2 v[68:69], v2, s[20:23], s34 offen
    s_add_u32 s33, s3, 1
    s_lshr_b32 s34, s33, 1
    s_lshl_b32 s34, s34, 10
    s_and_b32 s33, s33, 1
    s_lshl_b32 s33, s33, 3
    s_add_u32 s34, s34, s33
    s_add_u32 s34, s34, 0
    buffer_store_dwordx2 v[70:71], v2, s[20:23], s34 offen
    s_add_u32 s33, s3, 2
    s_lshr_b32 s34, s33, 1
    s_lshl_b32 s34, s34, 10
    s_and_b32 s33, s33, 1
    s_lshl_b32 s33, s33, 3
    s_add_u32 s34, s34, s33
    s_add_u32 s34, s34, 0
    buffer_store_dwordx2 v[72:73], v2, s[20:23], s34 offen
    s_add_u32 s33, s3, 3
    s_lshr_b32 s34, s33, 1
    s_lshl_b32 s34, s34, 10
    s_and_b32 s33, s33, 1
    s_lshl_b32 s33, s33, 3
    s_add_u32 s34, s34, s33
    s_add_u32 s34, s34, 0
    buffer_store_dwordx2 v[74:75], v2, s[20:23], s34 offen
    s_add_u32 s33, s3, 4
    s_lshr_b32 s34, s33, 1
    s_lshl_b32 s34, s34, 10
    s_and_b32 s33, s33, 1
    s_lshl_b32 s33, s33, 3
    s_add_u32 s34, s34, s33
    s_add_u32 s34, s34, 0
    buffer_store_dwordx2 v[76:77], v2, s[20:23], s34 offen
    s_nop 1
    v_cvt_pk_bf16_f32 v68, v132, v133
    v_cvt_pk_bf16_f32 v69, v134, v135
    v_cvt_pk_bf16_f32 v70, v140, v141
    v_cvt_pk_bf16_f32 v71, v142, v143
    v_cvt_pk_bf16_f32 v72, v148, v149
    v_cvt_pk_bf16_f32 v73, v150, v151
    v_cvt_pk_bf16_f32 v74, v156, v157
    v_cvt_pk_bf16_f32 v75, v158, v159
    v_cvt_pk_bf16_f32 v76, v164, v165
    v_cvt_pk_bf16_f32 v77, v166, v167
    v_lshlrev_b32 v8, 16, v68
    v_and_b32 v9, 0xffff0000, v68
    v_lshlrev_b32 v10, 16, v69
    v_and_b32 v11, 0xffff0000, v69
    v_lshlrev_b32 v12, 16, v70
    v_and_b32 v13, 0xffff0000, v70
    v_lshlrev_b32 v14, 16, v71
    v_and_b32 v15, 0xffff0000, v71
    v_lshlrev_b32 v16, 16, v72
    v_and_b32 v17, 0xffff0000, v72
    v_lshlrev_b32 v18, 16, v73
    v_and_b32 v19, 0xffff0000, v73
    v_lshlrev_b32 v20, 16, v74
    v_and_b32 v21, 0xffff0000, v74
    v_lshlrev_b32 v22, 16, v75
    v_and_b32 v23, 0xffff0000, v75
    v_lshlrev_b32 v24, 16, v76
    v_and_b32 v25, 0xffff0000, v76
    v_lshlrev_b32 v26, 16, v77
    v_and_b32 v27, 0xffff0000, v77
    v_mul_f32 v28, s38, v8
    v_mul_f32 v29, s38, v9
    v_mul_f32 v30, s38, v10
    v_mul_f32 v31, s38, v11
    v_mul_f32 v32, s38, v12
    v_mul_f32 v33, s38, v13
    v_mul_f32 v34, s38, v14
    v_mul_f32 v35, s38, v15
    v_mul_f32 v36, s38, v16
    v_mul_f32 v37, s38, v17
    v_mul_f32 v38, s38, v18
    v_mul_f32 v39, s38, v19
    v_mul_f32 v40, s38, v20
    v_mul_f32 v41, s38, v21
    v_mul_f32 v42, s38, v22
    v_mul_f32 v43, s38, v23
    v_mul_f32 v44, s38, v24
    v_mul_f32 v45, s38, v25
    v_mul_f32 v46, s38, v26
    v_mul_f32 v47, s38, v27
    v_exp_f32 v28, v28
    v_exp_f32 v29, v29
    v_exp_f32 v30, v30
    v_exp_f32 v31, v31
    v_exp_f32 v32, v32
    v_exp_f32 v33, v33
    v_exp_f32 v34, v34
    v_exp_f32 v35, v35
    v_exp_f32 v36, v36
    v_exp_f32 v37, v37
    v_exp_f32 v38, v38
    v_exp_f32 v39, v39
    v_exp_f32 v40, v40
    v_exp_f32 v41, v41
    v_exp_f32 v42, v42
    v_exp_f32 v43, v43
    v_exp_f32 v44, v44
    v_exp_f32 v45, v45
    v_exp_f32 v46, v46
    v_exp_f32 v47, v47
    v_add_f32 v48, 1.0, v8
    v_add_f32 v49, 1.0, v9
    v_add_f32 v50, 1.0, v10
    v_add_f32 v51, 1.0, v11
    v_add_f32 v52, 1.0, v12
    v_add_f32 v53, 1.0, v13
    v_add_f32 v54, 1.0, v14
    v_add_f32 v55, 1.0, v15
    v_add_f32 v56, 1.0, v16
    v_add_f32 v57, 1.0, v17
    v_add_f32 v58, 1.0, v18
    v_add_f32 v59, 1.0, v19
    v_add_f32 v60, 1.0, v20
    v_add_f32 v61, 1.0, v21
    v_add_f32 v62, 1.0, v22
    v_add_f32 v63, 1.0, v23
    v_add_f32 v64, 1.0, v24
    v_add_f32 v65, 1.0, v25
    v_add_f32 v66, 1.0, v26
    v_add_f32 v67, 1.0, v27
    v_cmp_gt_f32 s[40:41], v8, 0
    v_cmp_gt_f32 s[42:43], v9, 0
    v_cmp_gt_f32 s[44:45], v10, 0
    v_cmp_gt_f32 s[46:47], v11, 0
    v_cmp_gt_f32 s[48:49], v12, 0
    v_cmp_gt_f32 s[50:51], v13, 0
    v_cmp_gt_f32 s[52:53], v14, 0
    v_cmp_gt_f32 s[54:55], v15, 0
    s_nop 1
    v_cndmask_b32 v28, v28, v48, s[40:41]
    v_cndmask_b32 v29, v29, v49, s[42:43]
    v_cndmask_b32 v30, v30, v50, s[44:45]
    v_cndmask_b32 v31, v31, v51, s[46:47]
    v_cndmask_b32 v32, v32, v52, s[48:49]
    v_cndmask_b32 v33, v33, v53, s[50:51]
    v_cndmask_b32 v34, v34, v54, s[52:53]
    v_cndmask_b32 v35, v35, v55, s[54:55]
    v_cmp_gt_f32 s[40:41], v16, 0
    v_cmp_gt_f32 s[42:43], v17, 0
    v_cmp_gt_f32 s[44:45], v18, 0
    v_cmp_gt_f32 s[46:47], v19, 0
    v_cmp_gt_f32 s[48:49], v20, 0
    v_cmp_gt_f32 s[50:51], v21, 0
    v_cmp_gt_f32 s[52:53], v22, 0
    v_cmp_gt_f32 s[54:55], v23, 0
    s_nop 1
    v_cndmask_b32 v36, v36, v56, s[40:41]
    v_cndmask_b32 v37, v37, v57, s[42:43]
    v_cndmask_b32 v38, v38, v58, s[44:45]
    v_cndmask_b32 v39, v39, v59, s[46:47]
    v_cndmask_b32 v40, v40, v60, s[48:49]
    v_cndmask_b32 v41, v41, v61, s[50:51]
    v_cndmask_b32 v42, v42, v62, s[52:53]
    v_cndmask_b32 v43, v43, v63, s[54:55]
    v_cmp_gt_f32 s[40:41], v24, 0
    v_cmp_gt_f32 s[42:43], v25, 0
    v_cmp_gt_f32 s[44:45], v26, 0
    v_cmp_gt_f32 s[46:47], v27, 0
    s_nop 1
    v_cndmask_b32 v44, v44, v64, s[40:41]
    v_cndmask_b32 v45, v45, v65, s[42:43]
    v_cndmask_b32 v46, v46, v66, s[44:45]
    v_cndmask_b32 v47, v47, v67, s[46:47]
    v_cvt_pk_bf16_f32 v68, v28, v29
    v_cvt_pk_bf16_f32 v69, v30, v31
    v_cvt_pk_bf16_f32 v70, v32, v33
    v_cvt_pk_bf16_f32 v71, v34, v35
    v_cvt_pk_bf16_f32 v72, v36, v37
    v_cvt_pk_bf16_f32 v73, v38, v39
    v_cvt_pk_bf16_f32 v74, v40, v41
    v_cvt_pk_bf16_f32 v75, v42, v43
    v_cvt_pk_bf16_f32 v76, v44, v45
    v_cvt_pk_bf16_f32 v77, v46, v47
    v_lshlrev_b32 v8, 16, v68
    v_and_b32 v9, 0xffff0000, v68
    v_lshlrev_b32 v10, 16, v69
    v_and_b32 v11, 0xffff0000, v69
    v_lshlrev_b32 v12, 16, v70
    v_and_b32 v13, 0xffff0000, v70
    v_lshlrev_b32 v14, 16, v71
    v_and_b32 v15, 0xffff0000, v71
    v_lshlrev_b32 v16, 16, v72
    v_and_b32 v17, 0xffff0000, v72
    v_lshlrev_b32 v18, 16, v73
    v_and_b32 v19, 0xffff0000, v73
    v_lshlrev_b32 v20, 16, v74
    v_and_b32 v21, 0xffff0000, v74
    v_lshlrev_b32 v22, 16, v75
    v_and_b32 v23, 0xffff0000, v75
    v_lshlrev_b32 v24, 16, v76
    v_and_b32 v25, 0xffff0000, v76
    v_lshlrev_b32 v26, 16, v77
    v_and_b32 v27, 0xffff0000, v77
    v_add_f32 v8, s39, v8
    v_add_f32 v9, s39, v9
    v_add_f32 v10, s39, v10
    v_add_f32 v11, s39, v11
    v_add_f32 v12, s39, v12
    v_add_f32 v13, s39, v13
    v_add_f32 v14, s39, v14
    v_add_f32 v15, s39, v15
    v_add_f32 v16, s39, v16
    v_add_f32 v17, s39, v17
    v_add_f32 v18, s39, v18
    v_add_f32 v19, s39, v19
    v_add_f32 v20, s39, v20
    v_add_f32 v21, s39, v21
    v_add_f32 v22, s39, v22
    v_add_f32 v23, s39, v23
    v_add_f32 v24, s39, v24
    v_add_f32 v25, s39, v25
    v_add_f32 v26, s39, v26
    v_add_f32 v27, s39, v27
    v_cvt_pk_bf16_f32 v68, v8, v9
    v_cvt_pk_bf16_f32 v69, v10, v11
    v_cvt_pk_bf16_f32 v70, v12, v13
    v_cvt_pk_bf16_f32 v71, v14, v15
    v_cvt_pk_bf16_f32 v72, v16, v17
    v_cvt_pk_bf16_f32 v73, v18, v19
    v_cvt_pk_bf16_f32 v74, v20, v21
    v_cvt_pk_bf16_f32 v75, v22, v23
    v_cvt_pk_bf16_f32 v76, v24, v25
    v_cvt_pk_bf16_f32 v77, v26, v27
    s_add_u32 s33, s3, 0
    s_lshr_b32 s34, s33, 1
    s_lshl_b32 s34, s34, 10
    s_and_b32 s33, s33, 1
    s_lshl_b32 s33, s33, 3
    s_add_u32 s34, s34, s33
    s_add_u32 s34, s34, 20480
    buffer_store_dwordx2 v[68:69], v2, s[20:23], s34 offen
    s_add_u32 s33, s3, 1
    s_lshr_b32 s34, s33, 1
    s_lshl_b32 s34, s34, 10
    s_and_b32 s33, s33, 1
    s_lshl_b32 s33, s33, 3
    s_add_u32 s34, s34, s33
    s_add_u32 s34, s34, 20480
    buffer_store_dwordx2 v[70:71], v2, s[20:23], s34 offen
    s_add_u32 s33, s3, 2
    s_lshr_b32 s34, s33, 1
    s_lshl_b32 s34, s34, 10
    s_and_b32 s33, s33, 1
    s_lshl_b32 s33, s33, 3
    s_add_u32 s34, s34, s33
    s_add_u32 s34, s34, 20480
    buffer_store_dwordx2 v[72:73], v2, s[20:23], s34 offen
    s_add_u32 s33, s3, 3
    s_lshr_b32 s34, s33, 1
    s_lshl_b32 s34, s34, 10
    s_and_b32 s33, s33, 1
    s_lshl_b32 s33, s33, 3
    s_add_u32 s34, s34, s33
    s_add_u32 s34, s34, 20480
    buffer_store_dwordx2 v[74:75], v2, s[20:23], s34 offen
    s_add_u32 s33, s3, 4
    s_lshr_b32 s34, s33, 1
    s_lshl_b32 s34, s34, 10
    s_and_b32 s33, s33, 1
    s_lshl_b32 s33, s33, 3
    s_add_u32 s34, s34, s33
    s_add_u32 s34, s34, 20480
    buffer_store_dwordx2 v[76:77], v2, s[20:23], s34 offen
    s_nop 1
    s_barrier
K1_kvsum:
    s_barrier
    v_lshlrev_b32 v2, 4, v1
    s_lshl_b32 s33, s30, 10
    v_add_u32 v3, s33, v2
    v_add_u32 v4, 55296, v3
    s_lshl_b32 s33, s28, 3
    s_add_u32 s33, s33, s29
    s_mul_i32 s33, s33, 18432
    ds_read_b128 v[8:11], v3 offset:0
    ds_read_b128 v[12:15], v3 offset:18432
    ds_read_b128 v[16:19], v3 offset:36864
    ds_read_b128 v[20:23], v4 offset:0
    s_waitcnt lgkmcnt(0)
    v_pk_add_f32 v[8:9], v[8:9], v[12:13]
    v_pk_add_f32 v[10:11], v[10:11], v[14:15]
    v_pk_add_f32 v[16:17], v[16:17], v[20:21]
    v_pk_add_f32 v[18:19], v[18:19], v[22:23]
    v_pk_add_f32 v[24:25], v[8:9], v[16:17]
    v_pk_add_f32 v[26:27], v[10:11], v[18:19]
    buffer_store_dwordx4 v[24:27], v3, s[24:27], s33 offen
    s_add_u32 s33, s33, 8192
    ds_read_b128 v[8:11], v3 offset:8192
    ds_read_b128 v[12:15], v3 offset:26624
    ds_read_b128 v[16:19], v3 offset:45056
    ds_read_b128 v[20:23], v4 offset:8192
    s_waitcnt lgkmcnt(0)
    v_pk_add_f32 v[8:9], v[8:9], v[12:13]
    v_pk_add_f32 v[10:11], v[10:11], v[14:15]
    v_pk_add_f32 v[16:17], v[16:17], v[20:21]
    v_pk_add_f32 v[18:19], v[18:19], v[22:23]
    v_pk_add_f32 v[28:29], v[8:9], v[16:17]
    v_pk_add_f32 v[30:31], v[10:11], v[18:19]
    buffer_store_dwordx4 v[28:31], v3, s[24:27], s33 offen
    s_add_u32 s33, s33, 8192
    s_cmp_ge_u32 s30, 2
    s_cbranch_scc1 K1_fin
    ds_read_b128 v[8:11], v3 offset:16384
    ds_read_b128 v[12:15], v3 offset:34816
    ds_read_b128 v[16:19], v3 offset:53248
    ds_read_b128 v[20:23], v4 offset:16384
    s_waitcnt lgkmcnt(0)
    v_pk_add_f32 v[8:9], v[8:9], v[12:13]
    v_pk_add_f32 v[10:11], v[10:11], v[14:15]
    v_pk_add_f32 v[16:17], v[16:17], v[20:21]
    v_pk_add_f32 v[18:19], v[18:19], v[22:23]
    v_pk_add_f32 v[32:33], v[8:9], v[16:17]
    v_pk_add_f32 v[34:35], v[10:11], v[18:19]
    buffer_store_dwordx4 v[32:35], v3, s[24:27], s33 offen
    s_add_u32 s33, s33, 8192
    s_branch K1_fin
K1_ffn:
    s_mov_b32 s16, s8
    s_mov_b32 s17, s9
    s_mov_b32 s18, 2211840
    s_mov_b32 s19, 0x00020000
    s_add_u32 s20, s10, 2621440
    s_addc_u32 s21, s11, 0
    s_mov_b32 s22, 7077888
    s_mov_b32 s23, 0x00020000
    s_mov_b32 s24, s36
    s_mov_b32 s25, s37
    s_mov_b32 s26, 3456
    s_mov_b32 s27, 0x00020000
    s_mul_i32 s31, s3, 3456
    s_sub_u32 s33, s29, 8
    s_mul_i32 s73, s33, 14
    s_cmp_eq_u32 s33, 7
    s_cselect_b32 s73, 96, s73
    s_cmp_lt_u32 s33, 6
    s_cselect_b32 s72, 14, 12
    v_cmp_gt_u32 vcc, s72, v5
    s_nop 1
    v_cndmask_b32 v5, 0, v5, vcc
    v_add_u32 v5, s73, v5
    v_lshlrev_b32 v6, 5, v5
    v_mul_u32_u24 v4, 3456, v24
    v_add_u32 v6, v6, v4
    v_lshlrev_b32 v4, 4, v25
    v_add_u32 v6, v6, v4
    s_mul_i32 s79, s75, 7
    s_add_u32 s33, s73, s79
    s_lshl_b32 s33, s33, 5
    v_add_u32 v7, s33, v7
    v_mov_b32 v2, v26
    v_mov_b32 v3, v27
    s_add_u32 s33, s79, 0
    v_xor_b32 v4, s33, v2
    v_lshlrev_b32 v4, 5, v4
    v_add_u32 v8, v3, v4
    v_add_u32 v18, 0x10000, v8
    s_add_u32 s33, s79, 1
    v_xor_b32 v4, s33, v2
    v_lshlrev_b32 v4, 5, v4
    v_add_u32 v9, v3, v4
    v_add_u32 v19, 0x10000, v9
    s_add_u32 s33, s79, 2
    v_xor_b32 v4, s33, v2
    v_lshlrev_b32 v4, 5, v4
    v_add_u32 v10, v3, v4
    v_add_u32 v20, 0x10000, v10
    s_add_u32 s33, s79, 3
    v_xor_b32 v4, s33, v2
    v_lshlrev_b32 v4, 5, v4
    v_add_u32 v11, v3, v4
    v_add_u32 v21, 0x10000, v11
    s_add_u32 s33, s79, 4
    v_xor_b32 v4, s33, v2
    v_lshlrev_b32 v4, 5, v4
    v_add_u32 v12, v3, v4
    v_add_u32 v22, 0x10000, v12
    s_add_u32 s33, s79, 5
    v_xor_b32 v4, s33, v2
    v_lshlrev_b32 v4, 5, v4
    v_add_u32 v13, v3, v4
    v_add_u32 v23, 0x10000, v13
    s_add_u32 s33, s79, 6
    v_xor_b32 v4, s33, v2
    v_lshlrev_b32 v4, 5, v4
    v_add_u32 v14, v3, v4
    v_add_u32 v24, 0x10000, v14
    s_add_u32 m0, s32, 0
    s_add_u32 s34, s31, 0
    buffer_load_dwordx4 v6, s[16:19], s34 offen lds
    s_add_u32 m0, s32, 2048
    s_add_u32 s34, s31, 13824
    buffer_load_dwordx4 v6, s[16:19], s34 offen lds
    s_add_u32 m0, s76, 0
    s_add_u32 s34, s77, 0
    buffer_load_dwordx4 v30, s[12:15], s34 offen lds
    s_add_u32 m0, s76, 1024
    s_add_u32 s34, s77, 10240
    buffer_load_dwordx4 v31, s[12:15], s34 offen lds
    s_add_u32 m0, s32, 16384
    s_add_u32 s34, s31, 110592
    buffer_load_dwordx4 v6, s[16:19], s34 offen lds
    s_add_u32 m0, s32, 18432
    s_add_u32 s34, s31, 124416
    buffer_load_dwordx4 v6, s[16:19], s34 offen lds
    s_add_u32 m0, s32, 32768
    s_add_u32 s34, s31, 221184
    buffer_load_dwordx4 v6, s[16:19], s34 offen lds
    s_add_u32 m0, s32, 34816
    s_add_u32 s34, s31, 235008
    buffer_load_dwordx4 v6, s[16:19], s34 offen lds
    s_add_u32 m0, s76, 4096
    s_add_u32 s34, s77, 128
    buffer_load_dwordx4 v30, s[12:15], s34 offen lds
    s_add_u32 m0, s76, 5120
    s_add_u32 s34, s77, 10368
    buffer_load_dwordx4 v31, s[12:15], s34 offen lds
    s_add_u32 m0, s32, 49152
    s_add_u32 s34, s31, 331776
    buffer_load_dwordx4 v6, s[16:19], s34 offen lds
    s_add_u32 m0, s32, 51200
    s_add_u32 s34, s31, 345600
    buffer_load_dwordx4 v6, s[16:19], s34 offen lds
    s_waitcnt vmcnt(10)
    s_waitcnt vmcnt(8)
    s_barrier
    s_add_u32 m0, s32, 65536
    s_add_u32 s34, s31, 442368
    buffer_load_dwordx4 v6, s[16:19], s34 offen lds
    s_add_u32 m0, s32, 67584
    s_add_u32 s34, s31, 456192
    buffer_load_dwordx4 v6, s[16:19], s34 offen lds
    s_add_u32 m0, s76, 8192
    s_add_u32 s34, s77, 256
    buffer_load_dwordx4 v30, s[12:15], s34 offen lds
    s_add_u32 m0, s76, 9216
    s_add_u32 s34, s77, 10496
    buffer_load_dwordx4 v31, s[12:15], s34 offen lds
    ds_read_b128 v[64:67], v28 offset:0
    ds_read_b128 v[68:71], v28 offset:2048
    ds_read_b128 v[72:75], v29 offset:0
    ds_read_b128 v[76:79], v29 offset:2048
    ds_read_b64_tr_b16 v[32:33], v8 offset:0
    ds_read_b64_tr_b16 v[34:35], v8 offset:2048
    ds_read_b64_tr_b16 v[36:37], v9 offset:0
    ds_read_b64_tr_b16 v[38:39], v9 offset:2048
    ds_read_b64_tr_b16 v[40:41], v10 offset:0
    ds_read_b64_tr_b16 v[42:43], v10 offset:2048
    ds_read_b64_tr_b16 v[44:45], v11 offset:0
    ds_read_b64_tr_b16 v[46:47], v11 offset:2048
    ds_read_b64_tr_b16 v[48:49], v12 offset:0
    ds_read_b64_tr_b16 v[50:51], v12 offset:2048
    s_waitcnt lgkmcnt(8)
    v_mfma_f32_16x16x32_bf16 v[128:131], v[32:35], v[64:67], 0
    v_mfma_f32_16x16x32_bf16 v[132:135], v[32:35], v[68:71], 0
    ds_read_b64_tr_b16 v[52:53], v13 offset:0
    ds_read_b64_tr_b16 v[54:55], v13 offset:2048
    s_waitcnt lgkmcnt(8)
    v_mfma_f32_16x16x32_bf16 v[136:139], v[36:39], v[64:67], 0
    v_mfma_f32_16x16x32_bf16 v[140:143], v[36:39], v[68:71], 0
    ds_read_b64_tr_b16 v[56:57], v14 offset:0
    ds_read_b64_tr_b16 v[58:59], v14 offset:2048
    s_waitcnt lgkmcnt(8)
    v_mfma_f32_16x16x32_bf16 v[144:147], v[40:43], v[64:67], 0
    v_mfma_f32_16x16x32_bf16 v[148:151], v[40:43], v[68:71], 0
    s_waitcnt vmcnt(10)
    s_barrier
    s_add_u32 m0, s32, 81920
    s_add_u32 s34, s31, 552960
    buffer_load_dwordx4 v6, s[16:19], s34 offen lds
    s_add_u32 m0, s32, 83968
    s_add_u32 s34, s31, 566784
    buffer_load_dwordx4 v6, s[16:19], s34 offen lds
    ds_read_b64_tr_b16 v[60:61], v8 offset:16384
    ds_read_b64_tr_b16 v[62:63], v8 offset:18432
    s_waitcnt lgkmcnt(8)
    v_mfma_f32_16x16x32_bf16 v[152:155], v[44:47], v[64:67], 0
    v_mfma_f32_16x16x32_bf16 v[156:159], v[44:47], v[68:71], 0
    ds_read_b64_tr_b16 v[32:33], v9 offset:16384
    ds_read_b64_tr_b16 v[34:35], v9 offset:18432
    s_waitcnt lgkmcnt(8)
    v_mfma_f32_16x16x32_bf16 v[160:163], v[48:51], v[64:67], 0
    v_mfma_f32_16x16x32_bf16 v[164:167], v[48:51], v[68:71], 0
    ds_read_b64_tr_b16 v[36:37], v10 offset:16384
    ds_read_b64_tr_b16 v[38:39], v10 offset:18432
    s_waitcnt lgkmcnt(8)
    v_mfma_f32_16x16x32_bf16 v[168:171], v[52:55], v[64:67], 0
    v_mfma_f32_16x16x32_bf16 v[172:175], v[52:55], v[68:71], 0
    ds_read_b64_tr_b16 v[40:41], v11 offset:16384
    ds_read_b64_tr_b16 v[42:43], v11 offset:18432
    s_waitcnt lgkmcnt(8)
    v_mfma_f32_16x16x32_bf16 v[176:179], v[56:59], v[64:67], 0
    v_mfma_f32_16x16x32_bf16 v[180:183], v[56:59], v[68:71], 0
    ds_read_b64_tr_b16 v[44:45], v12 offset:16384
    ds_read_b64_tr_b16 v[46:47], v12 offset:18432
    s_waitcnt lgkmcnt(8)
    v_mfma_f32_16x16x32_bf16 v[128:131], v[60:63], v[72:75], v[128:131]
    v_mfma_f32_16x16x32_bf16 v[132:135], v[60:63], v[76:79], v[132:135]
    ds_read_b64_tr_b16 v[48:49], v13 offset:16384
    ds_read_b64_tr_b16 v[50:51], v13 offset:18432
    s_waitcnt lgkmcnt(8)
    v_mfma_f32_16x16x32_bf16 v[136:139], v[32:35], v[72:75], v[136:139]
    v_mfma_f32_16x16x32_bf16 v[140:143], v[32:35], v[76:79], v[140:143]
    ds_read_b64_tr_b16 v[52:53], v14 offset:16384
    ds_read_b64_tr_b16 v[54:55], v14 offset:18432
    s_waitcnt lgkmcnt(8)
    v_mfma_f32_16x16x32_bf16 v[144:147], v[36:39], v[72:75], v[144:147]
    v_mfma_f32_16x16x32_bf16 v[148:151], v[36:39], v[76:79], v[148:151]
    s_waitcnt vmcnt(10)
    s_waitcnt vmcnt(8)
    s_barrier
    s_add_u32 m0, s32, 0
    s_add_u32 s34, s31, 663552
    buffer_load_dwordx4 v6, s[16:19], s34 offen lds
    s_add_u32 m0, s32, 2048
    s_add_u32 s34, s31, 677376
    buffer_load_dwordx4 v6, s[16:19], s34 offen lds
    s_add_u32 m0, s76, 12288
    s_add_u32 s34, s77, 384
    buffer_load_dwordx4 v30, s[12:15], s34 offen lds
    s_add_u32 m0, s76, 13312
    s_add_u32 s34, s77, 10624
    buffer_load_dwordx4 v31, s[12:15], s34 offen lds
    ds_read_b64_tr_b16 v[56:57], v8 offset:32768
    ds_read_b64_tr_b16 v[58:59], v8 offset:34816
    ds_read_b128 v[80:83], v28 offset:4096
    s_waitcnt lgkmcnt(9)
    v_mfma_f32_16x16x32_bf16 v[152:155], v[40:43], v[72:75], v[152:155]
    v_mfma_f32_16x16x32_bf16 v[156:159], v[40:43], v[76:79], v[156:159]
    ds_read_b64_tr_b16 v[60:61], v9 offset:32768
    ds_read_b64_tr_b16 v[62:63], v9 offset:34816
    ds_read_b128 v[84:87], v28 offset:6144
    s_waitcnt lgkmcnt(10)
    v_mfma_f32_16x16x32_bf16 v[160:163], v[44:47], v[72:75], v[160:163]
    v_mfma_f32_16x16x32_bf16 v[164:167], v[44:47], v[76:79], v[164:167]
    ds_read_b64_tr_b16 v[32:33], v10 offset:32768
    ds_read_b64_tr_b16 v[34:35], v10 offset:34816
    ds_read_b128 v[88:91], v29 offset:4096
    s_waitcnt lgkmcnt(11)
    v_mfma_f32_16x16x32_bf16 v[168:171], v[48:51], v[72:75], v[168:171]
    v_mfma_f32_16x16x32_bf16 v[172:175], v[48:51], v[76:79], v[172:175]
    ds_read_b64_tr_b16 v[36:37], v11 offset:32768
    ds_read_b64_tr_b16 v[38:39], v11 offset:34816
    ds_read_b128 v[92:95], v29 offset:6144
    s_waitcnt lgkmcnt(12)
    v_mfma_f32_16x16x32_bf16 v[176:179], v[52:55], v[72:75], v[176:179]
    v_mfma_f32_16x16x32_bf16 v[180:183], v[52:55], v[76:79], v[180:183]
    ds_read_b64_tr_b16 v[40:41], v12 offset:32768
    ds_read_b64_tr_b16 v[42:43], v12 offset:34816
    s_waitcnt lgkmcnt(2)
    v_mfma_f32_16x16x32_bf16 v[128:131], v[56:59], v[80:83], v[128:131]
    v_mfma_f32_16x16x32_bf16 v[132:135], v[56:59], v[84:87], v[132:135]
    ds_read_b64_tr_b16 v[44:45], v13 offset:32768
    ds_read_b64_tr_b16 v[46:47], v13 offset:34816
    v_mfma_f32_16x16x32_bf16 v[136:139], v[60:63], v[80:83], v[136:139]
    v_mfma_f32_16x16x32_bf16 v[140:143], v[60:63], v[84:87], v[140:143]
    ds_read_b64_tr_b16 v[48:49], v14 offset:32768
    ds_read_b64_tr_b16 v[50:51], v14 offset:34816
    v_mfma_f32_16x16x32_bf16 v[144:147], v[32:35], v[80:83], v[144:147]
    v_mfma_f32_16x16x32_bf16 v[148:151], v[32:35], v[84:87], v[148:151]
    s_waitcnt vmcnt(10)
    s_barrier
    s_add_u32 m0, s32, 16384
    s_add_u32 s34, s31, 774144
    buffer_load_dwordx4 v6, s[16:19], s34 offen lds
    s_add_u32 m0, s32, 18432
    s_add_u32 s34, s31, 787968
    buffer_load_dwordx4 v6, s[16:19], s34 offen lds
    ds_read_b64_tr_b16 v[52:53], v8 offset:49152
    ds_read_b64_tr_b16 v[54:55], v8 offset:51200
    v_mfma_f32_16x16x32_bf16 v[152:155], v[36:39], v[80:83], v[152:155]
    v_mfma_f32_16x16x32_bf16 v[156:159], v[36:39], v[84:87], v[156:159]
    ds_read_b64_tr_b16 v[56:57], v9 offset:49152
    ds_read_b64_tr_b16 v[58:59], v9 offset:51200
    s_waitcnt lgkmcnt(8)
    v_mfma_f32_16x16x32_bf16 v[160:163], v[40:43], v[80:83], v[160:163]
    v_mfma_f32_16x16x32_bf16 v[164:167], v[40:43], v[84:87], v[164:167]
    ds_read_b64_tr_b16 v[60:61], v10 offset:49152
    ds_read_b64_tr_b16 v[62:63], v10 offset:51200
    s_waitcnt lgkmcnt(8)
    v_mfma_f32_16x16x32_bf16 v[168:171], v[44:47], v[80:83], v[168:171]
    v_mfma_f32_16x16x32_bf16 v[172:175], v[44:47], v[84:87], v[172:175]
    ds_read_b64_tr_b16 v[32:33], v11 offset:49152
    ds_read_b64_tr_b16 v[34:35], v11 offset:51200
    s_waitcnt lgkmcnt(8)
    v_mfma_f32_16x16x32_bf16 v[176:179], v[48:51], v[80:83], v[176:179]
    v_mfma_f32_16x16x32_bf16 v[180:183], v[48:51], v[84:87], v[180:183]
    ds_read_b64_tr_b16 v[36:37], v12 offset:49152
    ds_read_b64_tr_b16 v[38:39], v12 offset:51200
    s_waitcnt lgkmcnt(8)
    v_mfma_f32_16x16x32_bf16 v[128:131], v[52:55], v[88:91], v[128:131]
    v_mfma_f32_16x16x32_bf16 v[132:135], v[52:55], v[92:95], v[132:135]
    ds_read_b64_tr_b16 v[40:41], v13 offset:49152
    ds_read_b64_tr_b16 v[42:43], v13 offset:51200
    s_waitcnt lgkmcnt(8)
    v_mfma_f32_16x16x32_bf16 v[136:139], v[56:59], v[88:91], v[136:139]
    v_mfma_f32_16x16x32_bf16 v[140:143], v[56:59], v[92:95], v[140:143]
    ds_read_b64_tr_b16 v[44:45], v14 offset:49152
    ds_read_b64_tr_b16 v[46:47], v14 offset:51200
    s_waitcnt lgkmcnt(8)
    v_mfma_f32_16x16x32_bf16 v[144:147], v[60:63], v[88:91], v[144:147]
    v_mfma_f32_16x16x32_bf16 v[148:151], v[60:63], v[92:95], v[148:151]
    s_waitcnt vmcnt(10)
    s_waitcnt vmcnt(8)
    s_barrier
    s_add_u32 m0, s32, 32768
    s_add_u32 s34, s31, 884736
    buffer_load_dwordx4 v6, s[16:19], s34 offen lds
    s_add_u32 m0, s32, 34816
    s_add_u32 s34, s31, 898560
    buffer_load_dwordx4 v6, s[16:19], s34 offen lds
    s_add_u32 m0, s76, 0
    s_add_u32 s34, s77, 512
    buffer_load_dwordx4 v30, s[12:15], s34 offen lds
    s_add_u32 m0, s76, 1024
    s_add_u32 s34, s77, 10752
    buffer_load_dwordx4 v31, s[12:15], s34 offen lds
    ds_read_b64_tr_b16 v[48:49], v18 offset:0
    ds_read_b64_tr_b16 v[50:51], v18 offset:2048
    ds_read_b128 v[64:67], v28 offset:8192
    s_waitcnt lgkmcnt(9)
    v_mfma_f32_16x16x32_bf16 v[152:155], v[32:35], v[88:91], v[152:155]
    v_mfma_f32_16x16x32_bf16 v[156:159], v[32:35], v[92:95], v[156:159]
    ds_read_b64_tr_b16 v[52:53], v19 offset:0
    ds_read_b64_tr_b16 v[54:55], v19 offset:2048
    ds_read_b128 v[68:71], v28 offset:10240
    s_waitcnt lgkmcnt(10)
    v_mfma_f32_16x16x32_bf16 v[160:163], v[36:39], v[88:91], v[160:163]
    v_mfma_f32_16x16x32_bf16 v[164:167], v[36:39], v[92:95], v[164:167]
    ds_read_b64_tr_b16 v[56:57], v20 offset:0
    ds_read_b64_tr_b16 v[58:59], v20 offset:2048
    ds_read_b128 v[72:75], v29 offset:8192
    s_waitcnt lgkmcnt(11)
    v_mfma_f32_16x16x32_bf16 v[168:171], v[40:43], v[88:91], v[168:171]
    v_mfma_f32_16x16x32_bf16 v[172:175], v[40:43], v[92:95], v[172:175]
    ds_read_b64_tr_b16 v[60:61], v21 offset:0
    ds_read_b64_tr_b16 v[62:63], v21 offset:2048
    ds_read_b128 v[76:79], v29 offset:10240
    s_waitcnt lgkmcnt(12)
    v_mfma_f32_16x16x32_bf16 v[176:179], v[44:47], v[88:91], v[176:179]
    v_mfma_f32_16x16x32_bf16 v[180:183], v[44:47], v[92:95], v[180:183]
    ds_read_b64_tr_b16 v[32:33], v22 offset:0
    ds_read_b64_tr_b16 v[34:35], v22 offset:2048
    s_waitcnt lgkmcnt(2)
    v_mfma_f32_16x16x32_bf16 v[128:131], v[48:51], v[64:67], v[128:131]
    v_mfma_f32_16x16x32_bf16 v[132:135], v[48:51], v[68:71], v[132:135]
    ds_read_b64_tr_b16 v[36:37], v23 offset:0
    ds_read_b64_tr_b16 v[38:39], v23 offset:2048
    v_mfma_f32_16x16x32_bf16 v[136:139], v[52:55], v[64:67], v[136:139]
    v_mfma_f32_16x16x32_bf16 v[140:143], v[52:55], v[68:71], v[140:143]
    ds_read_b64_tr_b16 v[40:41], v24 offset:0
    ds_read_b64_tr_b16 v[42:43], v24 offset:2048
    v_mfma_f32_16x16x32_bf16 v[144:147], v[56:59], v[64:67], v[144:147]
    v_mfma_f32_16x16x32_bf16 v[148:151], v[56:59], v[68:71], v[148:151]
    s_waitcnt vmcnt(10)
    s_barrier
    s_add_u32 m0, s32, 49152
    s_add_u32 s34, s31, 995328
    buffer_load_dwordx4 v6, s[16:19], s34 offen lds
    s_add_u32 m0, s32, 51200
    s_add_u32 s34, s31, 1009152
    buffer_load_dwordx4 v6, s[16:19], s34 offen lds
    ds_read_b64_tr_b16 v[44:45], v18 offset:16384
    ds_read_b64_tr_b16 v[46:47], v18 offset:18432
    v_mfma_f32_16x16x32_bf16 v[152:155], v[60:63], v[64:67], v[152:155]
    v_mfma_f32_16x16x32_bf16 v[156:159], v[60:63], v[68:71], v[156:159]
    ds_read_b64_tr_b16 v[48:49], v19 offset:16384
    ds_read_b64_tr_b16 v[50:51], v19 offset:18432
    s_waitcnt lgkmcnt(8)
    v_mfma_f32_16x16x32_bf16 v[160:163], v[32:35], v[64:67], v[160:163]
    v_mfma_f32_16x16x32_bf16 v[164:167], v[32:35], v[68:71], v[164:167]
    ds_read_b64_tr_b16 v[52:53], v20 offset:16384
    ds_read_b64_tr_b16 v[54:55], v20 offset:18432
    s_waitcnt lgkmcnt(8)
    v_mfma_f32_16x16x32_bf16 v[168:171], v[36:39], v[64:67], v[168:171]
    v_mfma_f32_16x16x32_bf16 v[172:175], v[36:39], v[68:71], v[172:175]
    ds_read_b64_tr_b16 v[56:57], v21 offset:16384
    ds_read_b64_tr_b16 v[58:59], v21 offset:18432
    s_waitcnt lgkmcnt(8)
    v_mfma_f32_16x16x32_bf16 v[176:179], v[40:43], v[64:67], v[176:179]
    v_mfma_f32_16x16x32_bf16 v[180:183], v[40:43], v[68:71], v[180:183]
    ds_read_b64_tr_b16 v[60:61], v22 offset:16384
    ds_read_b64_tr_b16 v[62:63], v22 offset:18432
    s_waitcnt lgkmcnt(8)
    v_mfma_f32_16x16x32_bf16 v[128:131], v[44:47], v[72:75], v[128:131]
    v_mfma_f32_16x16x32_bf16 v[132:135], v[44:47], v[76:79], v[132:135]
    ds_read_b64_tr_b16 v[32:33], v23 offset:16384
    ds_read_b64_tr_b16 v[34:35], v23 offset:18432
    s_waitcnt lgkmcnt(8)
    v_mfma_f32_16x16x32_bf16 v[136:139], v[48:51], v[72:75], v[136:139]
    v_mfma_f32_16x16x32_bf16 v[140:143], v[48:51], v[76:79], v[140:143]
    ds_read_b64_tr_b16 v[36:37], v24 offset:16384
    ds_read_b64_tr_b16 v[38:39], v24 offset:18432
    s_waitcnt lgkmcnt(8)
    v_mfma_f32_16x16x32_bf16 v[144:147], v[52:55], v[72:75], v[144:147]
    v_mfma_f32_16x16x32_bf16 v[148:151], v[52:55], v[76:79], v[148:151]
    s_waitcnt vmcnt(10)
    s_waitcnt vmcnt(8)
    s_barrier
    s_add_u32 m0, s32, 65536
    s_add_u32 s34, s31, 1105920
    buffer_load_dwordx4 v6, s[16:19], s34 offen lds
    s_add_u32 m0, s32, 67584
    s_add_u32 s34, s31, 1119744
    buffer_load_dwordx4 v6, s[16:19], s34 offen lds
    s_add_u32 m0, s76, 4096
    s_add_u32 s34, s77, 640
    buffer_load_dwordx4 v30, s[12:15], s34 offen lds
    s_add_u32 m0, s76, 5120
    s_add_u32 s34, s77, 10880
    buffer_load_dwordx4 v31, s[12:15], s34 offen lds
    ds_read_b64_tr_b16 v[40:41], v8 offset:0
    ds_read_b64_tr_b16 v[42:43], v8 offset:2048
    ds_read_b128 v[80:83], v28 offset:12288
    s_waitcnt lgkmcnt(9)
    v_mfma_f32_16x16x32_bf16 v[152:155], v[56:59], v[72:75], v[152:155]
    v_mfma_f32_16x16x32_bf16 v[156:159], v[56:59], v[76:79], v[156:159]
    ds_read_b64_tr_b16 v[44:45], v9 offset:0
    ds_read_b64_tr_b16 v[46:47], v9 offset:2048
    ds_read_b128 v[84:87], v28 offset:14336
    s_waitcnt lgkmcnt(10)
    v_mfma_f32_16x16x32_bf16 v[160:163], v[60:63], v[72:75], v[160:163]
    v_mfma_f32_16x16x32_bf16 v[164:167], v[60:63], v[76:79], v[164:167]
    ds_read_b64_tr_b16 v[48:49], v10 offset:0
    ds_read_b64_tr_b16 v[50:51], v10 offset:2048
    ds_read_b128 v[88:91], v29 offset:12288
    s_waitcnt lgkmcnt(11)
    v_mfma_f32_16x16x32_bf16 v[168:171], v[32:35], v[72:75], v[168:171]
    v_mfma_f32_16x16x32_bf16 v[172:175], v[32:35], v[76:79], v[172:175]
    ds_read_b64_tr_b16 v[52:53], v11 offset:0
    ds_read_b64_tr_b16 v[54:55], v11 offset:2048
    ds_read_b128 v[92:95], v29 offset:14336
    s_waitcnt lgkmcnt(12)
    v_mfma_f32_16x16x32_bf16 v[176:179], v[36:39], v[72:75], v[176:179]
    v_mfma_f32_16x16x32_bf16 v[180:183], v[36:39], v[76:79], v[180:183]
    ds_read_b64_tr_b16 v[56:57], v12 offset:0
    ds_read_b64_tr_b16 v[58:59], v12 offset:2048
    s_waitcnt lgkmcnt(2)
    v_mfma_f32_16x16x32_bf16 v[128:131], v[40:43], v[80:83], v[128:131]
    v_mfma_f32_16x16x32_bf16 v[132:135], v[40:43], v[84:87], v[132:135]
    ds_read_b64_tr_b16 v[60:61], v13 offset:0
    ds_read_b64_tr_b16 v[62:63], v13 offset:2048
    v_mfma_f32_16x16x32_bf16 v[136:139], v[44:47], v[80:83], v[136:139]
    v_mfma_f32_16x16x32_bf16 v[140:143], v[44:47], v[84:87], v[140:143]
    ds_read_b64_tr_b16 v[32:33], v14 offset:0
    ds_read_b64_tr_b16 v[34:35], v14 offset:2048
    v_mfma_f32_16x16x32_bf16 v[144:147], v[48:51], v[80:83], v[144:147]
    v_mfma_f32_16x16x32_bf16 v[148:151], v[48:51], v[84:87], v[148:151]
    s_waitcnt vmcnt(10)
    s_barrier
    s_add_u32 m0, s32, 81920
    s_add_u32 s34, s31, 1216512
    buffer_load_dwordx4 v6, s[16:19], s34 offen lds
    s_add_u32 m0, s32, 83968
    s_add_u32 s34, s31, 1230336
    buffer_load_dwordx4 v6, s[16:19], s34 offen lds
    ds_read_b64_tr_b16 v[36:37], v8 offset:16384
    ds_read_b64_tr_b16 v[38:39], v8 offset:18432
    v_mfma_f32_16x16x32_bf16 v[152:155], v[52:55], v[80:83], v[152:155]
    v_mfma_f32_16x16x32_bf16 v[156:159], v[52:55], v[84:87], v[156:159]
    ds_read_b64_tr_b16 v[40:41], v9 offset:16384
    ds_read_b64_tr_b16 v[42:43], v9 offset:18432
    s_waitcnt lgkmcnt(8)
    v_mfma_f32_16x16x32_bf16 v[160:163], v[56:59], v[80:83], v[160:163]
    v_mfma_f32_16x16x32_bf16 v[164:167], v[56:59], v[84:87], v[164:167]
    ds_read_b64_tr_b16 v[44:45], v10 offset:16384
    ds_read_b64_tr_b16 v[46:47], v10 offset:18432
    s_waitcnt lgkmcnt(8)
    v_mfma_f32_16x16x32_bf16 v[168:171], v[60:63], v[80:83], v[168:171]
    v_mfma_f32_16x16x32_bf16 v[172:175], v[60:63], v[84:87], v[172:175]
    ds_read_b64_tr_b16 v[48:49], v11 offset:16384
    ds_read_b64_tr_b16 v[50:51], v11 offset:18432
    s_waitcnt lgkmcnt(8)
    v_mfma_f32_16x16x32_bf16 v[176:179], v[32:35], v[80:83], v[176:179]
    v_mfma_f32_16x16x32_bf16 v[180:183], v[32:35], v[84:87], v[180:183]
    ds_read_b64_tr_b16 v[52:53], v12 offset:16384
    ds_read_b64_tr_b16 v[54:55], v12 offset:18432
    s_waitcnt lgkmcnt(8)
    v_mfma_f32_16x16x32_bf16 v[128:131], v[36:39], v[88:91], v[128:131]
    v_mfma_f32_16x16x32_bf16 v[132:135], v[36:39], v[92:95], v[132:135]
    ds_read_b64_tr_b16 v[56:57], v13 offset:16384
    ds_read_b64_tr_b16 v[58:59], v13 offset:18432
    s_waitcnt lgkmcnt(8)
    v_mfma_f32_16x16x32_bf16 v[136:139], v[40:43], v[88:91], v[136:139]
    v_mfma_f32_16x16x32_bf16 v[140:143], v[40:43], v[92:95], v[140:143]
    ds_read_b64_tr_b16 v[60:61], v14 offset:16384
    ds_read_b64_tr_b16 v[62:63], v14 offset:18432
    s_waitcnt lgkmcnt(8)
    v_mfma_f32_16x16x32_bf16 v[144:147], v[44:47], v[88:91], v[144:147]
    v_mfma_f32_16x16x32_bf16 v[148:151], v[44:47], v[92:95], v[148:151]
    s_waitcnt vmcnt(10)
    s_waitcnt vmcnt(8)
    s_barrier
    s_add_u32 m0, s32, 0
    s_add_u32 s34, s31, 1327104
    buffer_load_dwordx4 v6, s[16:19], s34 offen lds
    s_add_u32 m0, s32, 2048
    s_add_u32 s34, s31, 1340928
    buffer_load_dwordx4 v6, s[16:19], s34 offen lds
    s_add_u32 m0, s76, 8192
    s_add_u32 s34, s77, 768
    buffer_load_dwordx4 v30, s[12:15], s34 offen lds
    s_add_u32 m0, s76, 9216
    s_add_u32 s34, s77, 11008
    buffer_load_dwordx4 v31, s[12:15], s34 offen lds
    ds_read_b64_tr_b16 v[32:33], v8 offset:32768
    ds_read_b64_tr_b16 v[34:35], v8 offset:34816
    ds_read_b128 v[64:67], v28 offset:0
    s_waitcnt lgkmcnt(9)
    v_mfma_f32_16x16x32_bf16 v[152:155], v[48:51], v[88:91], v[152:155]
    v_mfma_f32_16x16x32_bf16 v[156:159], v[48:51], v[92:95], v[156:159]
    ds_read_b64_tr_b16 v[36:37], v9 offset:32768
    ds_read_b64_tr_b16 v[38:39], v9 offset:34816
    ds_read_b128 v[68:71], v28 offset:2048
    s_waitcnt lgkmcnt(10)
    v_mfma_f32_16x16x32_bf16 v[160:163], v[52:55], v[88:91], v[160:163]
    v_mfma_f32_16x16x32_bf16 v[164:167], v[52:55], v[92:95], v[164:167]
    ds_read_b64_tr_b16 v[40:41], v10 offset:32768
    ds_read_b64_tr_b16 v[42:43], v10 offset:34816
    ds_read_b128 v[72:75], v29 offset:0
    s_waitcnt lgkmcnt(11)
    v_mfma_f32_16x16x32_bf16 v[168:171], v[56:59], v[88:91], v[168:171]
    v_mfma_f32_16x16x32_bf16 v[172:175], v[56:59], v[92:95], v[172:175]
    ds_read_b64_tr_b16 v[44:45], v11 offset:32768
    ds_read_b64_tr_b16 v[46:47], v11 offset:34816
    ds_read_b128 v[76:79], v29 offset:2048
    s_waitcnt lgkmcnt(12)
    v_mfma_f32_16x16x32_bf16 v[176:179], v[60:63], v[88:91], v[176:179]
    v_mfma_f32_16x16x32_bf16 v[180:183], v[60:63], v[92:95], v[180:183]
    ds_read_b64_tr_b16 v[48:49], v12 offset:32768
    ds_read_b64_tr_b16 v[50:51], v12 offset:34816
    s_waitcnt lgkmcnt(2)
    v_mfma_f32_16x16x32_bf16 v[128:131], v[32:35], v[64:67], v[128:131]
    v_mfma_f32_16x16x32_bf16 v[132:135], v[32:35], v[68:71], v[132:135]
    ds_read_b64_tr_b16 v[52:53], v13 offset:32768
    ds_read_b64_tr_b16 v[54:55], v13 offset:34816
    v_mfma_f32_16x16x32_bf16 v[136:139], v[36:39], v[64:67], v[136:139]
    v_mfma_f32_16x16x32_bf16 v[140:143], v[36:39], v[68:71], v[140:143]
    ds_read_b64_tr_b16 v[56:57], v14 offset:32768
    ds_read_b64_tr_b16 v[58:59], v14 offset:34816
    v_mfma_f32_16x16x32_bf16 v[144:147], v[40:43], v[64:67], v[144:147]
    v_mfma_f32_16x16x32_bf16 v[148:151], v[40:43], v[68:71], v[148:151]
    s_waitcnt vmcnt(10)
    s_barrier
    s_add_u32 m0, s32, 16384
    s_add_u32 s34, s31, 1437696
    buffer_load_dwordx4 v6, s[16:19], s34 offen lds
    s_add_u32 m0, s32, 18432
    s_add_u32 s34, s31, 1451520
    buffer_load_dwordx4 v6, s[16:19], s34 offen lds
    ds_read_b64_tr_b16 v[60:61], v8 offset:49152
    ds_read_b64_tr_b16 v[62:63], v8 offset:51200
    v_mfma_f32_16x16x32_bf16 v[152:155], v[44:47], v[64:67], v[152:155]
    v_mfma_f32_16x16x32_bf16 v[156:159], v[44:47], v[68:71], v[156:159]
    ds_read_b64_tr_b16 v[32:33], v9 offset:49152
    ds_read_b64_tr_b16 v[34:35], v9 offset:51200
    s_waitcnt lgkmcnt(8)
    v_mfma_f32_16x16x32_bf16 v[160:163], v[48:51], v[64:67], v[160:163]
    v_mfma_f32_16x16x32_bf16 v[164:167], v[48:51], v[68:71], v[164:167]
    ds_read_b64_tr_b16 v[36:37], v10 offset:49152
    ds_read_b64_tr_b16 v[38:39], v10 offset:51200
    s_waitcnt lgkmcnt(8)
    v_mfma_f32_16x16x32_bf16 v[168:171], v[52:55], v[64:67], v[168:171]
    v_mfma_f32_16x16x32_bf16 v[172:175], v[52:55], v[68:71], v[172:175]
    ds_read_b64_tr_b16 v[40:41], v11 offset:49152
    ds_read_b64_tr_b16 v[42:43], v11 offset:51200
    s_waitcnt lgkmcnt(8)
    v_mfma_f32_16x16x32_bf16 v[176:179], v[56:59], v[64:67], v[176:179]
    v_mfma_f32_16x16x32_bf16 v[180:183], v[56:59], v[68:71], v[180:183]
    ds_read_b64_tr_b16 v[44:45], v12 offset:49152
    ds_read_b64_tr_b16 v[46:47], v12 offset:51200
    s_waitcnt lgkmcnt(8)
    v_mfma_f32_16x16x32_bf16 v[128:131], v[60:63], v[72:75], v[128:131]
    v_mfma_f32_16x16x32_bf16 v[132:135], v[60:63], v[76:79], v[132:135]
    ds_read_b64_tr_b16 v[48:49], v13 offset:49152
    ds_read_b64_tr_b16 v[50:51], v13 offset:51200
    s_waitcnt lgkmcnt(8)
    v_mfma_f32_16x16x32_bf16 v[136:139], v[32:35], v[72:75], v[136:139]
    v_mfma_f32_16x16x32_bf16 v[140:143], v[32:35], v[76:79], v[140:143]
    ds_read_b64_tr_b16 v[52:53], v14 offset:49152
    ds_read_b64_tr_b16 v[54:55], v14 offset:51200
    s_waitcnt lgkmcnt(8)
    v_mfma_f32_16x16x32_bf16 v[144:147], v[36:39], v[72:75], v[144:147]
    v_mfma_f32_16x16x32_bf16 v[148:151], v[36:39], v[76:79], v[148:151]
    s_waitcnt vmcnt(10)
    s_waitcnt vmcnt(8)
    s_barrier
    s_add_u32 m0, s32, 32768
    s_add_u32 s34, s31, 1548288
    buffer_load_dwordx4 v6, s[16:19], s34 offen lds
    s_add_u32 m0, s32, 34816
    s_add_u32 s34, s31, 1562112
    buffer_load_dwordx4 v6, s[16:19], s34 offen lds
    s_add_u32 m0, s76, 12288
    s_add_u32 s34, s77, 896
    buffer_load_dwordx4 v30, s[12:15], s34 offen lds
    s_add_u32 m0, s76, 13312
    s_add_u32 s34, s77, 11136
    buffer_load_dwordx4 v31, s[12:15], s34 offen lds
    ds_read_b64_tr_b16 v[56:57], v18 offset:0
    ds_read_b64_tr_b16 v[58:59], v18 offset:2048
    ds_read_b128 v[80:83], v28 offset:4096
    s_waitcnt lgkmcnt(9)
    v_mfma_f32_16x16x32_bf16 v[152:155], v[40:43], v[72:75], v[152:155]
    v_mfma_f32_16x16x32_bf16 v[156:159], v[40:43], v[76:79], v[156:159]
    ds_read_b64_tr_b16 v[60:61], v19 offset:0
    ds_read_b64_tr_b16 v[62:63], v19 offset:2048
    ds_read_b128 v[84:87], v28 offset:6144
    s_waitcnt lgkmcnt(10)
    v_mfma_f32_16x16x32_bf16 v[160:163], v[44:47], v[72:75], v[160:163]
    v_mfma_f32_16x16x32_bf16 v[164:167], v[44:47], v[76:79], v[164:167]
    ds_read_b64_tr_b16 v[32:33], v20 offset:0
    ds_read_b64_tr_b16 v[34:35], v20 offset:2048
    ds_read_b128 v[88:91], v29 offset:4096
    s_waitcnt lgkmcnt(11)
    v_mfma_f32_16x16x32_bf16 v[168:171], v[48:51], v[72:75], v[168:171]
    v_mfma_f32_16x16x32_bf16 v[172:175], v[48:51], v[76:79], v[172:175]
    ds_read_b64_tr_b16 v[36:37], v21 offset:0
    ds_read_b64_tr_b16 v[38:39], v21 offset:2048
    ds_read_b128 v[92:95], v29 offset:6144
    s_waitcnt lgkmcnt(12)
    v_mfma_f32_16x16x32_bf16 v[176:179], v[52:55], v[72:75], v[176:179]
    v_mfma_f32_16x16x32_bf16 v[180:183], v[52:55], v[76:79], v[180:183]
    ds_read_b64_tr_b16 v[40:41], v22 offset:0
    ds_read_b64_tr_b16 v[42:43], v22 offset:2048
    s_waitcnt lgkmcnt(2)
    v_mfma_f32_16x16x32_bf16 v[128:131], v[56:59], v[80:83], v[128:131]
    v_mfma_f32_16x16x32_bf16 v[132:135], v[56:59], v[84:87], v[132:135]
    ds_read_b64_tr_b16 v[44:45], v23 offset:0
    ds_read_b64_tr_b16 v[46:47], v23 offset:2048
    v_mfma_f32_16x16x32_bf16 v[136:139], v[60:63], v[80:83], v[136:139]
    v_mfma_f32_16x16x32_bf16 v[140:143], v[60:63], v[84:87], v[140:143]
    ds_read_b64_tr_b16 v[48:49], v24 offset:0
    ds_read_b64_tr_b16 v[50:51], v24 offset:2048
    v_mfma_f32_16x16x32_bf16 v[144:147], v[32:35], v[80:83], v[144:147]
    v_mfma_f32_16x16x32_bf16 v[148:151], v[32:35], v[84:87], v[148:151]
    s_waitcnt vmcnt(10)
    s_barrier
    s_add_u32 m0, s32, 49152
    s_add_u32 s34, s31, 1658880
    buffer_load_dwordx4 v6, s[16:19], s34 offen lds
    s_add_u32 m0, s32, 51200
    s_add_u32 s34, s31, 1672704
    buffer_load_dwordx4 v6, s[16:19], s34 offen lds
    ds_read_b64_tr_b16 v[52:53], v18 offset:16384
    ds_read_b64_tr_b16 v[54:55], v18 offset:18432
    v_mfma_f32_16x16x32_bf16 v[152:155], v[36:39], v[80:83], v[152:155]
    v_mfma_f32_16x16x32_bf16 v[156:159], v[36:39], v[84:87], v[156:159]
    ds_read_b64_tr_b16 v[56:57], v19 offset:16384
    ds_read_b64_tr_b16 v[58:59], v19 offset:18432
    s_waitcnt lgkmcnt(8)
    v_mfma_f32_16x16x32_bf16 v[160:163], v[40:43], v[80:83], v[160:163]
    v_mfma_f32_16x16x32_bf16 v[164:167], v[40:43], v[84:87], v[164:167]
    ds_read_b64_tr_b16 v[60:61], v20 offset:16384
    ds_read_b64_tr_b16 v[62:63], v20 offset:18432
    s_waitcnt lgkmcnt(8)
    v_mfma_f32_16x16x32_bf16 v[168:171], v[44:47], v[80:83], v[168:171]
    v_mfma_f32_16x16x32_bf16 v[172:175], v[44:47], v[84:87], v[172:175]
    ds_read_b64_tr_b16 v[32:33], v21 offset:16384
    ds_read_b64_tr_b16 v[34:35], v21 offset:18432
    s_waitcnt lgkmcnt(8)
    v_mfma_f32_16x16x32_bf16 v[176:179], v[48:51], v[80:83], v[176:179]
    v_mfma_f32_16x16x32_bf16 v[180:183], v[48:51], v[84:87], v[180:183]
    ds_read_b64_tr_b16 v[36:37], v22 offset:16384
    ds_read_b64_tr_b16 v[38:39], v22 offset:18432
    s_waitcnt lgkmcnt(8)
    v_mfma_f32_16x16x32_bf16 v[128:131], v[52:55], v[88:91], v[128:131]
    v_mfma_f32_16x16x32_bf16 v[132:135], v[52:55], v[92:95], v[132:135]
    ds_read_b64_tr_b16 v[40:41], v23 offset:16384
    ds_read_b64_tr_b16 v[42:43], v23 offset:18432
    s_waitcnt lgkmcnt(8)
    v_mfma_f32_16x16x32_bf16 v[136:139], v[56:59], v[88:91], v[136:139]
    v_mfma_f32_16x16x32_bf16 v[140:143], v[56:59], v[92:95], v[140:143]
    ds_read_b64_tr_b16 v[44:45], v24 offset:16384
    ds_read_b64_tr_b16 v[46:47], v24 offset:18432
    s_waitcnt lgkmcnt(8)
    v_mfma_f32_16x16x32_bf16 v[144:147], v[60:63], v[88:91], v[144:147]
    v_mfma_f32_16x16x32_bf16 v[148:151], v[60:63], v[92:95], v[148:151]
    s_waitcnt vmcnt(10)
    s_waitcnt vmcnt(8)
    s_barrier
    s_add_u32 m0, s32, 65536
    s_add_u32 s34, s31, 1769472
    buffer_load_dwordx4 v6, s[16:19], s34 offen lds
    s_add_u32 m0, s32, 67584
    s_add_u32 s34, s31, 1783296
    buffer_load_dwordx4 v6, s[16:19], s34 offen lds
    s_add_u32 m0, s76, 0
    s_add_u32 s34, s77, 1024
    buffer_load_dwordx4 v30, s[12:15], s34 offen lds
    s_add_u32 m0, s76, 1024
    s_add_u32 s34, s77, 11264
    buffer_load_dwordx4 v31, s[12:15], s34 offen lds
    ds_read_b64_tr_b16 v[48:49], v8 offset:0
    ds_read_b64_tr_b16 v[50:51], v8 offset:2048
    ds_read_b128 v[64:67], v28 offset:8192
    s_waitcnt lgkmcnt(9)
    v_mfma_f32_16x16x32_bf16 v[152:155], v[32:35], v[88:91], v[152:155]
    v_mfma_f32_16x16x32_bf16 v[156:159], v[32:35], v[92:95], v[156:159]
    ds_read_b64_tr_b16 v[52:53], v9 offset:0
    ds_read_b64_tr_b16 v[54:55], v9 offset:2048
    ds_read_b128 v[68:71], v28 offset:10240
    s_waitcnt lgkmcnt(10)
    v_mfma_f32_16x16x32_bf16 v[160:163], v[36:39], v[88:91], v[160:163]
    v_mfma_f32_16x16x32_bf16 v[164:167], v[36:39], v[92:95], v[164:167]
    ds_read_b64_tr_b16 v[56:57], v10 offset:0
    ds_read_b64_tr_b16 v[58:59], v10 offset:2048
    ds_read_b128 v[72:75], v29 offset:8192
    s_waitcnt lgkmcnt(11)
    v_mfma_f32_16x16x32_bf16 v[168:171], v[40:43], v[88:91], v[168:171]
    v_mfma_f32_16x16x32_bf16 v[172:175], v[40:43], v[92:95], v[172:175]
    ds_read_b64_tr_b16 v[60:61], v11 offset:0
    ds_read_b64_tr_b16 v[62:63], v11 offset:2048
    ds_read_b128 v[76:79], v29 offset:10240
    s_waitcnt lgkmcnt(12)
    v_mfma_f32_16x16x32_bf16 v[176:179], v[44:47], v[88:91], v[176:179]
    v_mfma_f32_16x16x32_bf16 v[180:183], v[44:47], v[92:95], v[180:183]
    ds_read_b64_tr_b16 v[32:33], v12 offset:0
    ds_read_b64_tr_b16 v[34:35], v12 offset:2048
    s_waitcnt lgkmcnt(2)
    v_mfma_f32_16x16x32_bf16 v[128:131], v[48:51], v[64:67], v[128:131]
    v_mfma_f32_16x16x32_bf16 v[132:135], v[48:51], v[68:71], v[132:135]
    ds_read_b64_tr_b16 v[36:37], v13 offset:0
    ds_read_b64_tr_b16 v[38:39], v13 offset:2048
    v_mfma_f32_16x16x32_bf16 v[136:139], v[52:55], v[64:67], v[136:139]
    v_mfma_f32_16x16x32_bf16 v[140:143], v[52:55], v[68:71], v[140:143]
    ds_read_b64_tr_b16 v[40:41], v14 offset:0
    ds_read_b64_tr_b16 v[42:43], v14 offset:2048
    v_mfma_f32_16x16x32_bf16 v[144:147], v[56:59], v[64:67], v[144:147]
    v_mfma_f32_16x16x32_bf16 v[148:151], v[56:59], v[68:71], v[148:151]
    s_waitcnt vmcnt(10)
    s_barrier
    s_add_u32 m0, s32, 81920
    s_add_u32 s34, s31, 1880064
    buffer_load_dwordx4 v6, s[16:19], s34 offen lds
    s_add_u32 m0, s32, 83968
    s_add_u32 s34, s31, 1893888
    buffer_load_dwordx4 v6, s[16:19], s34 offen lds
    ds_read_b64_tr_b16 v[44:45], v8 offset:16384
    ds_read_b64_tr_b16 v[46:47], v8 offset:18432
    v_mfma_f32_16x16x32_bf16 v[152:155], v[60:63], v[64:67], v[152:155]
    v_mfma_f32_16x16x32_bf16 v[156:159], v[60:63], v[68:71], v[156:159]
    ds_read_b64_tr_b16 v[48:49], v9 offset:16384
    ds_read_b64_tr_b16 v[50:51], v9 offset:18432
    s_waitcnt lgkmcnt(8)
    v_mfma_f32_16x16x32_bf16 v[160:163], v[32:35], v[64:67], v[160:163]
    v_mfma_f32_16x16x32_bf16 v[164:167], v[32:35], v[68:71], v[164:167]
    ds_read_b64_tr_b16 v[52:53], v10 offset:16384
    ds_read_b64_tr_b16 v[54:55], v10 offset:18432
    s_waitcnt lgkmcnt(8)
    v_mfma_f32_16x16x32_bf16 v[168:171], v[36:39], v[64:67], v[168:171]
    v_mfma_f32_16x16x32_bf16 v[172:175], v[36:39], v[68:71], v[172:175]
    ds_read_b64_tr_b16 v[56:57], v11 offset:16384
    ds_read_b64_tr_b16 v[58:59], v11 offset:18432
    s_waitcnt lgkmcnt(8)
    v_mfma_f32_16x16x32_bf16 v[176:179], v[40:43], v[64:67], v[176:179]
    v_mfma_f32_16x16x32_bf16 v[180:183], v[40:43], v[68:71], v[180:183]
    ds_read_b64_tr_b16 v[60:61], v12 offset:16384
    ds_read_b64_tr_b16 v[62:63], v12 offset:18432
    s_waitcnt lgkmcnt(8)
    v_mfma_f32_16x16x32_bf16 v[128:131], v[44:47], v[72:75], v[128:131]
    v_mfma_f32_16x16x32_bf16 v[132:135], v[44:47], v[76:79], v[132:135]
    ds_read_b64_tr_b16 v[32:33], v13 offset:16384
    ds_read_b64_tr_b16 v[34:35], v13 offset:18432
    s_waitcnt lgkmcnt(8)
    v_mfma_f32_16x16x32_bf16 v[136:139], v[48:51], v[72:75], v[136:139]
    v_mfma_f32_16x16x32_bf16 v[140:143], v[48:51], v[76:79], v[140:143]
    ds_read_b64_tr_b16 v[36:37], v14 offset:16384
    ds_read_b64_tr_b16 v[38:39], v14 offset:18432
    s_waitcnt lgkmcnt(8)
    v_mfma_f32_16x16x32_bf16 v[144:147], v[52:55], v[72:75], v[144:147]
    v_mfma_f32_16x16x32_bf16 v[148:151], v[52:55], v[76:79], v[148:151]
    s_waitcnt vmcnt(10)
    s_waitcnt vmcnt(8)
    s_barrier
    s_add_u32 m0, s32, 0
    s_add_u32 s34, s31, 1990656
    buffer_load_dwordx4 v6, s[16:19], s34 offen lds
    s_add_u32 m0, s32, 2048
    s_add_u32 s34, s31, 2004480
    buffer_load_dwordx4 v6, s[16:19], s34 offen lds
    s_add_u32 m0, s76, 4096
    s_add_u32 s34, s77, 1152
    buffer_load_dwordx4 v30, s[12:15], s34 offen lds
    s_add_u32 m0, s76, 5120
    s_add_u32 s34, s77, 11392
    buffer_load_dwordx4 v31, s[12:15], s34 offen lds
    ds_read_b64_tr_b16 v[40:41], v8 offset:32768
    ds_read_b64_tr_b16 v[42:43], v8 offset:34816
    ds_read_b128 v[80:83], v28 offset:12288
    s_waitcnt lgkmcnt(9)
    v_mfma_f32_16x16x32_bf16 v[152:155], v[56:59], v[72:75], v[152:155]
    v_mfma_f32_16x16x32_bf16 v[156:159], v[56:59], v[76:79], v[156:159]
    ds_read_b64_tr_b16 v[44:45], v9 offset:32768
    ds_read_b64_tr_b16 v[46:47], v9 offset:34816
    ds_read_b128 v[84:87], v28 offset:14336
    s_waitcnt lgkmcnt(10)
    v_mfma_f32_16x16x32_bf16 v[160:163], v[60:63], v[72:75], v[160:163]
    v_mfma_f32_16x16x32_bf16 v[164:167], v[60:63], v[76:79], v[164:167]
    ds_read_b64_tr_b16 v[48:49], v10 offset:32768
    ds_read_b64_tr_b16 v[50:51], v10 offset:34816
    ds_read_b128 v[88:91], v29 offset:12288
    s_waitcnt lgkmcnt(11)
    v_mfma_f32_16x16x32_bf16 v[168:171], v[32:35], v[72:75], v[168:171]
    v_mfma_f32_16x16x32_bf16 v[172:175], v[32:35], v[76:79], v[172:175]
    ds_read_b64_tr_b16 v[52:53], v11 offset:32768
    ds_read_b64_tr_b16 v[54:55], v11 offset:34816
    ds_read_b128 v[92:95], v29 offset:14336
    s_waitcnt lgkmcnt(12)
    v_mfma_f32_16x16x32_bf16 v[176:179], v[36:39], v[72:75], v[176:179]
    v_mfma_f32_16x16x32_bf16 v[180:183], v[36:39], v[76:79], v[180:183]
    ds_read_b64_tr_b16 v[56:57], v12 offset:32768
    ds_read_b64_tr_b16 v[58:59], v12 offset:34816
    s_waitcnt lgkmcnt(2)
    v_mfma_f32_16x16x32_bf16 v[128:131], v[40:43], v[80:83], v[128:131]
    v_mfma_f32_16x16x32_bf16 v[132:135], v[40:43], v[84:87], v[132:135]
    ds_read_b64_tr_b16 v[60:61], v13 offset:32768
    ds_read_b64_tr_b16 v[62:63], v13 offset:34816
    v_mfma_f32_16x16x32_bf16 v[136:139], v[44:47], v[80:83], v[136:139]
    v_mfma_f32_16x16x32_bf16 v[140:143], v[44:47], v[84:87], v[140:143]
    ds_read_b64_tr_b16 v[32:33], v14 offset:32768
    ds_read_b64_tr_b16 v[34:35], v14 offset:34816
    v_mfma_f32_16x16x32_bf16 v[144:147], v[48:51], v[80:83], v[144:147]
    v_mfma_f32_16x16x32_bf16 v[148:151], v[48:51], v[84:87], v[148:151]
    s_waitcnt vmcnt(10)
    s_barrier
    s_add_u32 m0, s32, 16384
    s_add_u32 s34, s31, 2101248
    buffer_load_dwordx4 v6, s[16:19], s34 offen lds
    s_add_u32 m0, s32, 18432
    s_add_u32 s34, s31, 2115072
    buffer_load_dwordx4 v6, s[16:19], s34 offen lds
    ds_read_b64_tr_b16 v[36:37], v8 offset:49152
    ds_read_b64_tr_b16 v[38:39], v8 offset:51200
    v_mfma_f32_16x16x32_bf16 v[152:155], v[52:55], v[80:83], v[152:155]
    v_mfma_f32_16x16x32_bf16 v[156:159], v[52:55], v[84:87], v[156:159]
    ds_read_b64_tr_b16 v[40:41], v9 offset:49152
    ds_read_b64_tr_b16 v[42:43], v9 offset:51200
    s_waitcnt lgkmcnt(8)
    v_mfma_f32_16x16x32_bf16 v[160:163], v[56:59], v[80:83], v[160:163]
    v_mfma_f32_16x16x32_bf16 v[164:167], v[56:59], v[84:87], v[164:167]
    ds_read_b64_tr_b16 v[44:45], v10 offset:49152
    ds_read_b64_tr_b16 v[46:47], v10 offset:51200
    s_waitcnt lgkmcnt(8)
    v_mfma_f32_16x16x32_bf16 v[168:171], v[60:63], v[80:83], v[168:171]
    v_mfma_f32_16x16x32_bf16 v[172:175], v[60:63], v[84:87], v[172:175]
    ds_read_b64_tr_b16 v[48:49], v11 offset:49152
    ds_read_b64_tr_b16 v[50:51], v11 offset:51200
    s_waitcnt lgkmcnt(8)
    v_mfma_f32_16x16x32_bf16 v[176:179], v[32:35], v[80:83], v[176:179]
    v_mfma_f32_16x16x32_bf16 v[180:183], v[32:35], v[84:87], v[180:183]
    ds_read_b64_tr_b16 v[52:53], v12 offset:49152
    ds_read_b64_tr_b16 v[54:55], v12 offset:51200
    s_waitcnt lgkmcnt(8)
    v_mfma_f32_16x16x32_bf16 v[128:131], v[36:39], v[88:91], v[128:131]
    v_mfma_f32_16x16x32_bf16 v[132:135], v[36:39], v[92:95], v[132:135]
    ds_read_b64_tr_b16 v[56:57], v13 offset:49152
    ds_read_b64_tr_b16 v[58:59], v13 offset:51200
    s_waitcnt lgkmcnt(8)
    v_mfma_f32_16x16x32_bf16 v[136:139], v[40:43], v[88:91], v[136:139]
    v_mfma_f32_16x16x32_bf16 v[140:143], v[40:43], v[92:95], v[140:143]
    ds_read_b64_tr_b16 v[60:61], v14 offset:49152
    ds_read_b64_tr_b16 v[62:63], v14 offset:51200
    s_waitcnt lgkmcnt(8)
    v_mfma_f32_16x16x32_bf16 v[144:147], v[44:47], v[88:91], v[144:147]
    v_mfma_f32_16x16x32_bf16 v[148:151], v[44:47], v[92:95], v[148:151]
    s_waitcnt vmcnt(10)
    s_waitcnt vmcnt(8)
    s_barrier
    ds_read_b64_tr_b16 v[32:33], v18 offset:0
    ds_read_b64_tr_b16 v[34:35], v18 offset:2048
    ds_read_b128 v[64:67], v28 offset:0
    s_waitcnt lgkmcnt(9)
    v_mfma_f32_16x16x32_bf16 v[152:155], v[48:51], v[88:91], v[152:155]
    v_mfma_f32_16x16x32_bf16 v[156:159], v[48:51], v[92:95], v[156:159]
    ds_read_b64_tr_b16 v[36:37], v19 offset:0
    ds_read_b64_tr_b16 v[38:39], v19 offset:2048
    ds_read_b128 v[68:71], v28 offset:2048
    s_waitcnt lgkmcnt(10)
    v_mfma_f32_16x16x32_bf16 v[160:163], v[52:55], v[88:91], v[160:163]
    v_mfma_f32_16x16x32_bf16 v[164:167], v[52:55], v[92:95], v[164:167]
    ds_read_b64_tr_b16 v[40:41], v20 offset:0
    ds_read_b64_tr_b16 v[42:43], v20 offset:2048
    ds_read_b128 v[72:75], v29 offset:0
    s_waitcnt lgkmcnt(11)
    v_mfma_f32_16x16x32_bf16 v[168:171], v[56:59], v[88:91], v[168:171]
    v_mfma_f32_16x16x32_bf16 v[172:175], v[56:59], v[92:95], v[172:175]
    ds_read_b64_tr_b16 v[44:45], v21 offset:0
    ds_read_b64_tr_b16 v[46:47], v21 offset:2048
    ds_read_b128 v[76:79], v29 offset:2048
    s_waitcnt lgkmcnt(12)
    v_mfma_f32_16x16x32_bf16 v[176:179], v[60:63], v[88:91], v[176:179]
    v_mfma_f32_16x16x32_bf16 v[180:183], v[60:63], v[92:95], v[180:183]
    ds_read_b64_tr_b16 v[48:49], v22 offset:0
    ds_read_b64_tr_b16 v[50:51], v22 offset:2048
    s_waitcnt lgkmcnt(2)
    v_mfma_f32_16x16x32_bf16 v[128:131], v[32:35], v[64:67], v[128:131]
    v_mfma_f32_16x16x32_bf16 v[132:135], v[32:35], v[68:71], v[132:135]
    ds_read_b64_tr_b16 v[52:53], v23 offset:0
    ds_read_b64_tr_b16 v[54:55], v23 offset:2048
    v_mfma_f32_16x16x32_bf16 v[136:139], v[36:39], v[64:67], v[136:139]
    v_mfma_f32_16x16x32_bf16 v[140:143], v[36:39], v[68:71], v[140:143]
    ds_read_b64_tr_b16 v[56:57], v24 offset:0
    ds_read_b64_tr_b16 v[58:59], v24 offset:2048
    v_mfma_f32_16x16x32_bf16 v[144:147], v[40:43], v[64:67], v[144:147]
    v_mfma_f32_16x16x32_bf16 v[148:151], v[40:43], v[68:71], v[148:151]
    s_waitcnt vmcnt(6)
    s_barrier
    ds_read_b64_tr_b16 v[60:61], v18 offset:16384
    ds_read_b64_tr_b16 v[62:63], v18 offset:18432
    v_mfma_f32_16x16x32_bf16 v[152:155], v[44:47], v[64:67], v[152:155]
    v_mfma_f32_16x16x32_bf16 v[156:159], v[44:47], v[68:71], v[156:159]
    ds_read_b64_tr_b16 v[32:33], v19 offset:16384
    ds_read_b64_tr_b16 v[34:35], v19 offset:18432
    s_waitcnt lgkmcnt(8)
    v_mfma_f32_16x16x32_bf16 v[160:163], v[48:51], v[64:67], v[160:163]
    v_mfma_f32_16x16x32_bf16 v[164:167], v[48:51], v[68:71], v[164:167]
    ds_read_b64_tr_b16 v[36:37], v20 offset:16384
    ds_read_b64_tr_b16 v[38:39], v20 offset:18432
    s_waitcnt lgkmcnt(8)
    v_mfma_f32_16x16x32_bf16 v[168:171], v[52:55], v[64:67], v[168:171]
    v_mfma_f32_16x16x32_bf16 v[172:175], v[52:55], v[68:71], v[172:175]
    ds_read_b64_tr_b16 v[40:41], v21 offset:16384
    ds_read_b64_tr_b16 v[42:43], v21 offset:18432
    s_waitcnt lgkmcnt(8)
    v_mfma_f32_16x16x32_bf16 v[176:179], v[56:59], v[64:67], v[176:179]
    v_mfma_f32_16x16x32_bf16 v[180:183], v[56:59], v[68:71], v[180:183]
    ds_read_b64_tr_b16 v[44:45], v22 offset:16384
    ds_read_b64_tr_b16 v[46:47], v22 offset:18432
    s_waitcnt lgkmcnt(8)
    v_mfma_f32_16x16x32_bf16 v[128:131], v[60:63], v[72:75], v[128:131]
    v_mfma_f32_16x16x32_bf16 v[132:135], v[60:63], v[76:79], v[132:135]
    ds_read_b64_tr_b16 v[48:49], v23 offset:16384
    ds_read_b64_tr_b16 v[50:51], v23 offset:18432
    s_waitcnt lgkmcnt(8)
    v_mfma_f32_16x16x32_bf16 v[136:139], v[32:35], v[72:75], v[136:139]
    v_mfma_f32_16x16x32_bf16 v[140:143], v[32:35], v[76:79], v[140:143]
    ds_read_b64_tr_b16 v[52:53], v24 offset:16384
    ds_read_b64_tr_b16 v[54:55], v24 offset:18432
    s_waitcnt lgkmcnt(8)
    v_mfma_f32_16x16x32_bf16 v[144:147], v[36:39], v[72:75], v[144:147]
    v_mfma_f32_16x16x32_bf16 v[148:151], v[36:39], v[76:79], v[148:151]
    s_waitcnt vmcnt(4)
    s_waitcnt vmcnt(2)
    s_barrier
    ds_read_b64_tr_b16 v[56:57], v8 offset:0
    ds_read_b64_tr_b16 v[58:59], v8 offset:2048
    ds_read_b128 v[80:83], v28 offset:4096
    s_waitcnt lgkmcnt(9)
    v_mfma_f32_16x16x32_bf16 v[152:155], v[40:43], v[72:75], v[152:155]
    v_mfma_f32_16x16x32_bf16 v[156:159], v[40:43], v[76:79], v[156:159]
    ds_read_b64_tr_b16 v[60:61], v9 offset:0
    ds_read_b64_tr_b16 v[62:63], v9 offset:2048
    ds_read_b128 v[84:87], v28 offset:6144
    s_waitcnt lgkmcnt(10)
    v_mfma_f32_16x16x32_bf16 v[160:163], v[44:47], v[72:75], v[160:163]
    v_mfma_f32_16x16x32_bf16 v[164:167], v[44:47], v[76:79], v[164:167]
    ds_read_b64_tr_b16 v[32:33], v10 offset:0
    ds_read_b64_tr_b16 v[34:35], v10 offset:2048
    ds_read_b128 v[88:91], v29 offset:4096
    s_waitcnt lgkmcnt(11)
    v_mfma_f32_16x16x32_bf16 v[168:171], v[48:51], v[72:75], v[168:171]
    v_mfma_f32_16x16x32_bf16 v[172:175], v[48:51], v[76:79], v[172:175]
    ds_read_b64_tr_b16 v[36:37], v11 offset:0
    ds_read_b64_tr_b16 v[38:39], v11 offset:2048
    ds_read_b128 v[92:95], v29 offset:6144
    s_waitcnt lgkmcnt(12)
    v_mfma_f32_16x16x32_bf16 v[176:179], v[52:55], v[72:75], v[176:179]
    v_mfma_f32_16x16x32_bf16 v[180:183], v[52:55], v[76:79], v[180:183]
    ds_read_b64_tr_b16 v[40:41], v12 offset:0
    ds_read_b64_tr_b16 v[42:43], v12 offset:2048
    s_waitcnt lgkmcnt(2)
    v_mfma_f32_16x16x32_bf16 v[128:131], v[56:59], v[80:83], v[128:131]
    v_mfma_f32_16x16x32_bf16 v[132:135], v[56:59], v[84:87], v[132:135]
    ds_read_b64_tr_b16 v[44:45], v13 offset:0
    ds_read_b64_tr_b16 v[46:47], v13 offset:2048
    v_mfma_f32_16x16x32_bf16 v[136:139], v[60:63], v[80:83], v[136:139]
    v_mfma_f32_16x16x32_bf16 v[140:143], v[60:63], v[84:87], v[140:143]
    ds_read_b64_tr_b16 v[48:49], v14 offset:0
    ds_read_b64_tr_b16 v[50:51], v14 offset:2048
    v_mfma_f32_16x16x32_bf16 v[144:147], v[32:35], v[80:83], v[144:147]
    v_mfma_f32_16x16x32_bf16 v[148:151], v[32:35], v[84:87], v[148:151]
    s_waitcnt vmcnt(0)
    s_barrier
    s_lshl_b32 s88, s28, 3
    s_add_u32 s88, s88, s29
    s_sub_u32 s88, s88, 8
    s_lshl_b32 s88, s88, 3
    s_add_u32 s88, s88, s30
    s_cmp_lt_u32 s29, 8
    s_cselect_b32 s88, 0xffff, s88
    s_cmp_ge_u32 s88, 592
    s_cbranch_scc1 K1_nopp_f
    s_cmp_lt_u32 s88, 432
    s_cselect_b32 s80, s90, s92
    s_cselect_b32 s81, s91, s93
    s_mov_b32 s82, 819200
    s_cselect_b32 s82, 2211840, s82
    s_mov_b32 s83, 0x00020000
    s_mov_b32 s84, 19398656
    s_cselect_b32 s84, 16777216, s84
    s_mov_b32 s86, 819200
    s_cselect_b32 s86, 2211840, s86
    s_cselect_b32 s89, 0, 432
    s_cselect_b32 s33, 54, 20
    s_add_u32 s84, s84, s10
    s_addc_u32 s85, s11, 0
    s_mov_b32 s87, 0x00020000
    s_sub_u32 s89, s88, s89
    s_lshr_b32 s34, s89, 3
    s_and_b32 s89, s89, 7
    s_mul_i32 s33, s33, s89
    s_add_u32 s33, s33, s34
    s_mul_i32 s34, s34, 40960
    s_mul_i32 s89, s89, 160
    s_add_u32 s34, s34, s89
    s_mul_i32 s89, s33, 5120
    v_add_u32 v125, 0, v1
    v_mul_u32_u24 v126, 6554, v125
    v_lshrrev_b32 v126, 16, v126
    v_mul_u32_u24 v127, 10, v126
    v_sub_u32 v127, v125, v127
    v_mul_u32_u24 v126, 1280, v126
    v_lshlrev_b32 v127, 4, v127
    v_add_u32 v120, v126, v127
    v_add_u32 v125, 64, v1
    v_mul_u32_u24 v126, 6554, v125
    v_lshrrev_b32 v126, 16, v126
    v_mul_u32_u24 v127, 10, v126
    v_sub_u32 v127, v125, v127
    v_mul_u32_u24 v126, 1280, v126
    v_lshlrev_b32 v127, 4, v127
    v_add_u32 v121, v126, v127
    v_add_u32 v125, 128, v1
    v_mul_u32_u24 v126, 6554, v125
    v_lshrrev_b32 v126, 16, v126
    v_mul_u32_u24 v127, 10, v126
    v_sub_u32 v127, v125, v127
    v_mul_u32_u24 v126, 1280, v126
    v_lshlrev_b32 v127, 4, v127
    v_add_u32 v122, v126, v127
    v_add_u32 v125, 192, v1
    v_mul_u32_u24 v126, 6554, v125
    v_lshrrev_b32 v126, 16, v126
    v_mul_u32_u24 v127, 10, v126
    v_sub_u32 v127, v125, v127
    v_mul_u32_u24 v126, 1280, v126
    v_lshlrev_b32 v127, 4, v127
    v_add_u32 v123, v126, v127
    v_add_u32 v125, 256, v1
    v_mul_u32_u24 v126, 6554, v125
    v_lshrrev_b32 v126, 16, v126
    v_mul_u32_u24 v127, 10, v126
    v_sub_u32 v127, v125, v127
    v_mul_u32_u24 v126, 1280, v126
    v_lshlrev_b32 v127, 4, v127
    v_add_u32 v124, v126, v127
    s_add_u32 m0, s78, 0
    s_nop 0
    buffer_load_dwordx4 v120, s[80:83], s34 offen lds
    s_add_u32 m0, s78, 1024
    s_nop 0
    buffer_load_dwordx4 v121, s[80:83], s34 offen lds
    s_add_u32 m0, s78, 2048
    s_nop 0
    buffer_load_dwordx4 v122, s[80:83], s34 offen lds
    s_add_u32 m0, s78, 3072
    s_nop 0
    buffer_load_dwordx4 v123, s[80:83], s34 offen lds
    s_add_u32 m0, s78, 4096
    s_nop 0
    buffer_load_dwordx4 v124, s[80:83], s34 offen lds
K1_nopp_f:
    buffer_load_dwordx2 v[96:97], v7, s[24:27], 0 offen offset:0
    buffer_load_dwordx2 v[98:99], v7, s[24:27], 0 offen offset:32
    buffer_load_dwordx2 v[100:101], v7, s[24:27], 0 offen offset:64
    buffer_load_dwordx2 v[102:103], v7, s[24:27], 0 offen offset:96
    buffer_load_dwordx2 v[104:105], v7, s[24:27], 0 offen offset:128
    buffer_load_dwordx2 v[106:107], v7, s[24:27], 0 offen offset:160
    buffer_load_dwordx2 v[108:109], v7, s[24:27], 0 offen offset:192
    ds_read_b64_tr_b16 v[52:53], v8 offset:16384
    ds_read_b64_tr_b16 v[54:55], v8 offset:18432
    v_mfma_f32_16x16x32_bf16 v[152:155], v[36:39], v[80:83], v[152:155]
    v_mfma_f32_16x16x32_bf16 v[156:159], v[36:39], v[84:87], v[156:159]
    ds_read_b64_tr_b16 v[56:57], v9 offset:16384
    ds_read_b64_tr_b16 v[58:59], v9 offset:18432
    s_waitcnt lgkmcnt(8)
    v_mfma_f32_16x16x32_bf16 v[160:163], v[40:43], v[80:83], v[160:163]
    v_mfma_f32_16x16x32_bf16 v[164:167], v[40:43], v[84:87], v[164:167]
    ds_read_b64_tr_b16 v[60:61], v10 offset:16384
    ds_read_b64_tr_b16 v[62:63], v10 offset:18432
    s_waitcnt lgkmcnt(8)
    v_mfma_f32_16x16x32_bf16 v[168:171], v[44:47], v[80:83], v[168:171]
    v_mfma_f32_16x16x32_bf16 v[172:175], v[44:47], v[84:87], v[172:175]
    ds_read_b64_tr_b16 v[32:33], v11 offset:16384
    ds_read_b64_tr_b16 v[34:35], v11 offset:18432
    s_waitcnt lgkmcnt(8)
    v_mfma_f32_16x16x32_bf16 v[176:179], v[48:51], v[80:83], v[176:179]
    v_mfma_f32_16x16x32_bf16 v[180:183], v[48:51], v[84:87], v[180:183]
    ds_read_b64_tr_b16 v[36:37], v12 offset:16384
    ds_read_b64_tr_b16 v[38:39], v12 offset:18432
    s_waitcnt lgkmcnt(8)
    v_mfma_f32_16x16x32_bf16 v[128:131], v[52:55], v[88:91], v[128:131]
    v_mfma_f32_16x16x32_bf16 v[132:135], v[52:55], v[92:95], v[132:135]
    ds_read_b64_tr_b16 v[40:41], v13 offset:16384
    ds_read_b64_tr_b16 v[42:43], v13 offset:18432
    s_waitcnt lgkmcnt(8)
    v_mfma_f32_16x16x32_bf16 v[136:139], v[56:59], v[88:91], v[136:139]
    v_mfma_f32_16x16x32_bf16 v[140:143], v[56:59], v[92:95], v[140:143]
    ds_read_b64_tr_b16 v[44:45], v14 offset:16384
    ds_read_b64_tr_b16 v[46:47], v14 offset:18432
    s_waitcnt lgkmcnt(8)
    v_mfma_f32_16x16x32_bf16 v[144:147], v[60:63], v[88:91], v[144:147]
    v_mfma_f32_16x16x32_bf16 v[148:151], v[60:63], v[92:95], v[148:151]
    s_waitcnt lgkmcnt(6)
    v_mfma_f32_16x16x32_bf16 v[152:155], v[32:35], v[88:91], v[152:155]
    v_mfma_f32_16x16x32_bf16 v[156:159], v[32:35], v[92:95], v[156:159]
    s_waitcnt lgkmcnt(4)
    v_mfma_f32_16x16x32_bf16 v[160:163], v[36:39], v[88:91], v[160:163]
    v_mfma_f32_16x16x32_bf16 v[164:167], v[36:39], v[92:95], v[164:167]
    s_waitcnt lgkmcnt(2)
    v_mfma_f32_16x16x32_bf16 v[168:171], v[40:43], v[88:91], v[168:171]
    v_mfma_f32_16x16x32_bf16 v[172:175], v[40:43], v[92:95], v[172:175]
    s_waitcnt lgkmcnt(0)
    v_mfma_f32_16x16x32_bf16 v[176:179], v[44:47], v[88:91], v[176:179]
    v_mfma_f32_16x16x32_bf16 v[180:183], v[44:47], v[92:95], v[180:183]
    s_nop 7
    s_nop 1
    s_waitcnt vmcnt(0)
    s_lshl_b32 s33, s28, 3
    s_lshl_b32 s34, s74, 1
    s_add_u32 s33, s33, s34
    s_mul_i32 s33, s33, 54
    s_lshr_b32 s34, s73, 1
    s_add_u32 s33, s33, s34
    s_lshl_b32 s33, s33, 10
    v_lshlrev_b32 v2, 4, v1
    v_add_u32 v2, s33, v2
    v_add_u32 v3, 55296, v2
    s_mov_b32 s40, 0xbdd2d3e8
    s_mov_b32 s41, 0xbdd2d3e8
    v_mov_b32 v4, 0xc0135761
    v_mov_b32 v5, 0xc0135761
    s_movk_i32 s42, 4096
    s_cmp_eq_u32 s75, 0
    s_cbranch_scc0 K1_ffn_r1
    v_lshlrev_b32 v8, 16, v96
    v_and_b32 v9, 0xffff0000, v96
    v_lshlrev_b32 v10, 16, v97
    v_and_b32 v11, 0xffff0000, v97
    v_lshlrev_b32 v12, 16, v98
    v_and_b32 v13, 0xffff0000, v98
    v_lshlrev_b32 v14, 16, v99
    v_and_b32 v15, 0xffff0000, v99
    v_lshlrev_b32 v16, 16, v96
    v_and_b32 v17, 0xffff0000, v96
    v_lshlrev_b32 v18, 16, v97
    v_and_b32 v19, 0xffff0000, v97
    v_lshlrev_b32 v20, 16, v98
    v_and_b32 v21, 0xffff0000, v98
    v_lshlrev_b32 v22, 16, v99
    v_and_b32 v23, 0xffff0000, v99
    v_cvt_pk_bf16_f32 v56, v128, v129
    v_cvt_pk_bf16_f32 v57, v130, v131
    v_cvt_pk_bf16_f32 v58, v136, v137
    v_cvt_pk_bf16_f32 v59, v138, v139
    v_cvt_pk_bf16_f32 v60, v132, v133
    v_cvt_pk_bf16_f32 v61, v134, v135
    v_cvt_pk_bf16_f32 v62, v140, v141
    v_cvt_pk_bf16_f32 v63, v142, v143
    v_lshlrev_b32 v24, 16, v56
    v_and_b32 v25, 0xffff0000, v56
    v_lshlrev_b32 v26, 16, v57
    v_and_b32 v27, 0xffff0000, v57
    v_lshlrev_b32 v28, 16, v58
    v_and_b32 v29, 0xffff0000, v58
    v_lshlrev_b32 v30, 16, v59
    v_and_b32 v31, 0xffff0000, v59
    v_lshlrev_b32 v32, 16, v60
    v_and_b32 v33, 0xffff0000, v60
    v_lshlrev_b32 v34, 16, v61
    v_and_b32 v35, 0xffff0000, v61
    v_lshlrev_b32 v36, 16, v62
    v_and_b32 v37, 0xffff0000, v62
    v_lshlrev_b32 v38, 16, v63
    v_and_b32 v39, 0xffff0000, v63
    v_pk_add_f32 v[24:25], v[24:25], v[8:9]
    v_pk_add_f32 v[26:27], v[26:27], v[10:11]
    v_pk_add_f32 v[28:29], v[28:29], v[12:13]
    v_pk_add_f32 v[30:31], v[30:31], v[14:15]
    v_pk_add_f32 v[32:33], v[32:33], v[16:17]
    v_pk_add_f32 v[34:35], v[34:35], v[18:19]
    v_pk_add_f32 v[36:37], v[36:37], v[20:21]
    v_pk_add_f32 v[38:39], v[38:39], v[22:23]
    v_cvt_pk_bf16_f32 v56, v24, v25
    v_cvt_pk_bf16_f32 v57, v26, v27
    v_cvt_pk_bf16_f32 v58, v28, v29
    v_cvt_pk_bf16_f32 v59, v30, v31
    v_cvt_pk_bf16_f32 v60, v32, v33
    v_cvt_pk_bf16_f32 v61, v34, v35
    v_cvt_pk_bf16_f32 v62, v36, v37
    v_cvt_pk_bf16_f32 v63, v38, v39
    v_lshlrev_b32 v24, 16, v56
    v_and_b32 v25, 0xffff0000, v56
    v_lshlrev_b32 v26, 16, v57
    v_and_b32 v27, 0xffff0000, v57
    v_lshlrev_b32 v28, 16, v58
    v_and_b32 v29, 0xffff0000, v58
    v_lshlrev_b32 v30, 16, v59
    v_and_b32 v31, 0xffff0000, v59
    v_lshlrev_b32 v32, 16, v60
    v_and_b32 v33, 0xffff0000, v60
    v_lshlrev_b32 v34, 16, v61
    v_and_b32 v35, 0xffff0000, v61
    v_lshlrev_b32 v36, 16, v62
    v_and_b32 v37, 0xffff0000, v62
    v_lshlrev_b32 v38, 16, v63
    v_and_b32 v39, 0xffff0000, v63
    v_pk_mul_f32 v[40:41], v[24:25], v[24:25]
    v_pk_mul_f32 v[42:43], v[26:27], v[26:27]
    v_pk_mul_f32 v[44:45], v[28:29], v[28:29]
    v_pk_mul_f32 v[46:47], v[30:31], v[30:31]
    v_pk_mul_f32 v[48:49], v[32:33], v[32:33]
    v_pk_mul_f32 v[50:51], v[34:35], v[34:35]
    v_pk_mul_f32 v[52:53], v[36:37], v[36:37]
    v_pk_mul_f32 v[54:55], v[38:39], v[38:39]
    v_pk_fma_f32 v[40:41], v[40:41], s[40:41], v[4:5]
    v_pk_fma_f32 v[42:43], v[42:43], s[40:41], v[4:5]
    v_pk_fma_f32 v[44:45], v[44:45], s[40:41], v[4:5]
    v_pk_fma_f32 v[46:47], v[46:47], s[40:41], v[4:5]
    v_pk_fma_f32 v[48:49], v[48:49], s[40:41], v[4:5]
    v_pk_fma_f32 v[50:51], v[50:51], s[40:41], v[4:5]
    v_pk_fma_f32 v[52:53], v[52:53], s[40:41], v[4:5]
    v_pk_fma_f32 v[54:55], v[54:55], s[40:41], v[4:5]
    v_pk_mul_f32 v[40:41], v[40:41], v[24:25]
    v_pk_mul_f32 v[42:43], v[42:43], v[26:27]
    v_pk_mul_f32 v[44:45], v[44:45], v[28:29]
    v_pk_mul_f32 v[46:47], v[46:47], v[30:31]
    v_pk_mul_f32 v[48:49], v[48:49], v[32:33]
    v_pk_mul_f32 v[50:51], v[50:51], v[34:35]
    v_pk_mul_f32 v[52:53], v[52:53], v[36:37]
    v_pk_mul_f32 v[54:55], v[54:55], v[38:39]
    v_exp_f32 v40, v40
    v_exp_f32 v41, v41
    v_exp_f32 v42, v42
    v_exp_f32 v43, v43
    v_exp_f32 v44, v44
    v_exp_f32 v45, v45
    v_exp_f32 v46, v46
    v_exp_f32 v47, v47
    v_exp_f32 v48, v48
    v_exp_f32 v49, v49
    v_exp_f32 v50, v50
    v_exp_f32 v51, v51
    v_exp_f32 v52, v52
    v_exp_f32 v53, v53
    v_exp_f32 v54, v54
    v_exp_f32 v55, v55
    v_add_f32 v40, 1.0, v40
    v_add_f32 v41, 1.0, v41
    v_add_f32 v42, 1.0, v42
    v_add_f32 v43, 1.0, v43
    v_add_f32 v44, 1.0, v44
    v_add_f32 v45, 1.0, v45
    v_add_f32 v46, 1.0, v46
    v_add_f32 v47, 1.0, v47
    v_add_f32 v48, 1.0, v48
    v_add_f32 v49, 1.0, v49
    v_add_f32 v50, 1.0, v50
    v_add_f32 v51, 1.0, v51
    v_add_f32 v52, 1.0, v52
    v_add_f32 v53, 1.0, v53
    v_add_f32 v54, 1.0, v54
    v_add_f32 v55, 1.0, v55
    v_rcp_f32 v40, v40
    v_rcp_f32 v41, v41
    v_rcp_f32 v42, v42
    v_rcp_f32 v43, v43
    v_rcp_f32 v44, v44
    v_rcp_f32 v45, v45
    v_rcp_f32 v46, v46
    v_rcp_f32 v47, v47
    v_rcp_f32 v48, v48
    v_rcp_f32 v49, v49
    v_rcp_f32 v50, v50
    v_rcp_f32 v51, v51
    v_rcp_f32 v52, v52
    v_rcp_f32 v53, v53
    v_rcp_f32 v54, v54
    v_rcp_f32 v55, v55
    s_nop 0
    v_pk_mul_f32 v[40:41], v[40:41], v[24:25]
    v_pk_mul_f32 v[42:43], v[42:43], v[26:27]
    v_pk_mul_f32 v[44:45], v[44:45], v[28:29]
    v_pk_mul_f32 v[46:47], v[46:47], v[30:31]
    v_pk_mul_f32 v[48:49], v[48:49], v[32:33]
    v_pk_mul_f32 v[50:51], v[50:51], v[34:35]
    v_pk_mul_f32 v[52:53], v[52:53], v[36:37]
    v_pk_mul_f32 v[54:55], v[54:55], v[38:39]
    v_cvt_pk_bf16_f32 v64, v40, v41
    v_cvt_pk_bf16_f32 v65, v42, v43
    v_cvt_pk_bf16_f32 v66, v44, v45
    v_cvt_pk_bf16_f32 v67, v46, v47
    v_cvt_pk_bf16_f32 v68, v48, v49
    v_cvt_pk_bf16_f32 v69, v50, v51
    v_cvt_pk_bf16_f32 v70, v52, v53
    v_cvt_pk_bf16_f32 v71, v54, v55
    buffer_store_dwordx4 v[64:67], v2, s[20:23], 0 offen offset:0
    buffer_store_dwordx4 v[68:71], v3, s[20:23], 0 offen offset:0
    v_lshlrev_b32 v8, 16, v100
    v_and_b32 v9, 0xffff0000, v100
    v_lshlrev_b32 v10, 16, v101
    v_and_b32 v11, 0xffff0000, v101
    v_lshlrev_b32 v12, 16, v102
    v_and_b32 v13, 0xffff0000, v102
    v_lshlrev_b32 v14, 16, v103
    v_and_b32 v15, 0xffff0000, v103
    v_lshlrev_b32 v16, 16, v100
    v_and_b32 v17, 0xffff0000, v100
    v_lshlrev_b32 v18, 16, v101
    v_and_b32 v19, 0xffff0000, v101
    v_lshlrev_b32 v20, 16, v102
    v_and_b32 v21, 0xffff0000, v102
    v_lshlrev_b32 v22, 16, v103
    v_and_b32 v23, 0xffff0000, v103
    v_cvt_pk_bf16_f32 v56, v144, v145
    v_cvt_pk_bf16_f32 v57, v146, v147
    v_cvt_pk_bf16_f32 v58, v152, v153
    v_cvt_pk_bf16_f32 v59, v154, v155
    v_cvt_pk_bf16_f32 v60, v148, v149
    v_cvt_pk_bf16_f32 v61, v150, v151
    v_cvt_pk_bf16_f32 v62, v156, v157
    v_cvt_pk_bf16_f32 v63, v158, v159
    v_lshlrev_b32 v24, 16, v56
    v_and_b32 v25, 0xffff0000, v56
    v_lshlrev_b32 v26, 16, v57
    v_and_b32 v27, 0xffff0000, v57
    v_lshlrev_b32 v28, 16, v58
    v_and_b32 v29, 0xffff0000, v58
    v_lshlrev_b32 v30, 16, v59
    v_and_b32 v31, 0xffff0000, v59
    v_lshlrev_b32 v32, 16, v60
    v_and_b32 v33, 0xffff0000, v60
    v_lshlrev_b32 v34, 16, v61
    v_and_b32 v35, 0xffff0000, v61
    v_lshlrev_b32 v36, 16, v62
    v_and_b32 v37, 0xffff0000, v62
    v_lshlrev_b32 v38, 16, v63
    v_and_b32 v39, 0xffff0000, v63
    v_pk_add_f32 v[24:25], v[24:25], v[8:9]
    v_pk_add_f32 v[26:27], v[26:27], v[10:11]
    v_pk_add_f32 v[28:29], v[28:29], v[12:13]
    v_pk_add_f32 v[30:31], v[30:31], v[14:15]
    v_pk_add_f32 v[32:33], v[32:33], v[16:17]
    v_pk_add_f32 v[34:35], v[34:35], v[18:19]
    v_pk_add_f32 v[36:37], v[36:37], v[20:21]
    v_pk_add_f32 v[38:39], v[38:39], v[22:23]
    v_cvt_pk_bf16_f32 v56, v24, v25
    v_cvt_pk_bf16_f32 v57, v26, v27
    v_cvt_pk_bf16_f32 v58, v28, v29
    v_cvt_pk_bf16_f32 v59, v30, v31
    v_cvt_pk_bf16_f32 v60, v32, v33
    v_cvt_pk_bf16_f32 v61, v34, v35
    v_cvt_pk_bf16_f32 v62, v36, v37
    v_cvt_pk_bf16_f32 v63, v38, v39
    v_lshlrev_b32 v24, 16, v56
    v_and_b32 v25, 0xffff0000, v56
    v_lshlrev_b32 v26, 16, v57
    v_and_b32 v27, 0xffff0000, v57
    v_lshlrev_b32 v28, 16, v58
    v_and_b32 v29, 0xffff0000, v58
    v_lshlrev_b32 v30, 16, v59
    v_and_b32 v31, 0xffff0000, v59
    v_lshlrev_b32 v32, 16, v60
    v_and_b32 v33, 0xffff0000, v60
    v_lshlrev_b32 v34, 16, v61
    v_and_b32 v35, 0xffff0000, v61
    v_lshlrev_b32 v36, 16, v62
    v_and_b32 v37, 0xffff0000, v62
    v_lshlrev_b32 v38, 16, v63
    v_and_b32 v39, 0xffff0000, v63
    v_pk_mul_f32 v[40:41], v[24:25], v[24:25]
    v_pk_mul_f32 v[42:43], v[26:27], v[26:27]
    v_pk_mul_f32 v[44:45], v[28:29], v[28:29]
    v_pk_mul_f32 v[46:47], v[30:31], v[30:31]
    v_pk_mul_f32 v[48:49], v[32:33], v[32:33]
    v_pk_mul_f32 v[50:51], v[34:35], v[34:35]
    v_pk_mul_f32 v[52:53], v[36:37], v[36:37]
    v_pk_mul_f32 v[54:55], v[38:39], v[38:39]
    v_pk_fma_f32 v[40:41], v[40:41], s[40:41], v[4:5]
    v_pk_fma_f32 v[42:43], v[42:43], s[40:41], v[4:5]
    v_pk_fma_f32 v[44:45], v[44:45], s[40:41], v[4:5]
    v_pk_fma_f32 v[46:47], v[46:47], s[40:41], v[4:5]
    v_pk_fma_f32 v[48:49], v[48:49], s[40:41], v[4:5]
    v_pk_fma_f32 v[50:51], v[50:51], s[40:41], v[4:5]
    v_pk_fma_f32 v[52:53], v[52:53], s[40:41], v[4:5]
    v_pk_fma_f32 v[54:55], v[54:55], s[40:41], v[4:5]
    v_pk_mul_f32 v[40:41], v[40:41], v[24:25]
    v_pk_mul_f32 v[42:43], v[42:43], v[26:27]
    v_pk_mul_f32 v[44:45], v[44:45], v[28:29]
    v_pk_mul_f32 v[46:47], v[46:47], v[30:31]
    v_pk_mul_f32 v[48:49], v[48:49], v[32:33]
    v_pk_mul_f32 v[50:51], v[50:51], v[34:35]
    v_pk_mul_f32 v[52:53], v[52:53], v[36:37]
    v_pk_mul_f32 v[54:55], v[54:55], v[38:39]
    v_exp_f32 v40, v40
    v_exp_f32 v41, v41
    v_exp_f32 v42, v42
    v_exp_f32 v43, v43
    v_exp_f32 v44, v44
    v_exp_f32 v45, v45
    v_exp_f32 v46, v46
    v_exp_f32 v47, v47
    v_exp_f32 v48, v48
    v_exp_f32 v49, v49
    v_exp_f32 v50, v50
    v_exp_f32 v51, v51
    v_exp_f32 v52, v52
    v_exp_f32 v53, v53
    v_exp_f32 v54, v54
    v_exp_f32 v55, v55
    v_add_f32 v40, 1.0, v40
    v_add_f32 v41, 1.0, v41
    v_add_f32 v42, 1.0, v42
    v_add_f32 v43, 1.0, v43
    v_add_f32 v44, 1.0, v44
    v_add_f32 v45, 1.0, v45
    v_add_f32 v46, 1.0, v46
    v_add_f32 v47, 1.0, v47
    v_add_f32 v48, 1.0, v48
    v_add_f32 v49, 1.0, v49
    v_add_f32 v50, 1.0, v50
    v_add_f32 v51, 1.0, v51
    v_add_f32 v52, 1.0, v52
    v_add_f32 v53, 1.0, v53
    v_add_f32 v54, 1.0, v54
    v_add_f32 v55, 1.0, v55
    v_rcp_f32 v40, v40
    v_rcp_f32 v41, v41
    v_rcp_f32 v42, v42
    v_rcp_f32 v43, v43
    v_rcp_f32 v44, v44
    v_rcp_f32 v45, v45
    v_rcp_f32 v46, v46
    v_rcp_f32 v47, v47
    v_rcp_f32 v48, v48
    v_rcp_f32 v49, v49
    v_rcp_f32 v50, v50
    v_rcp_f32 v51, v51
    v_rcp_f32 v52, v52
    v_rcp_f32 v53, v53
    v_rcp_f32 v54, v54
    v_rcp_f32 v55, v55
    s_nop 0
    v_pk_mul_f32 v[40:41], v[40:41], v[24:25]
    v_pk_mul_f32 v[42:43], v[42:43], v[26:27]
    v_pk_mul_f32 v[44:45], v[44:45], v[28:29]
    v_pk_mul_f32 v[46:47], v[46:47], v[30:31]
    v_pk_mul_f32 v[48:49], v[48:49], v[32:33]
    v_pk_mul_f32 v[50:51], v[50:51], v[34:35]
    v_pk_mul_f32 v[52:53], v[52:53], v[36:37]
    v_pk_mul_f32 v[54:55], v[54:55], v[38:39]
    v_cvt_pk_bf16_f32 v72, v40, v41
    v_cvt_pk_bf16_f32 v73, v42, v43
    v_cvt_pk_bf16_f32 v74, v44, v45
    v_cvt_pk_bf16_f32 v75, v46, v47
    v_cvt_pk_bf16_f32 v76, v48, v49
    v_cvt_pk_bf16_f32 v77, v50, v51
    v_cvt_pk_bf16_f32 v78, v52, v53
    v_cvt_pk_bf16_f32 v79, v54, v55
    buffer_store_dwordx4 v[72:75], v2, s[20:23], 0 offen offset:1024
    buffer_store_dwordx4 v[76:79], v3, s[20:23], 0 offen offset:1024
    v_lshlrev_b32 v8, 16, v104
    v_and_b32 v9, 0xffff0000, v104
    v_lshlrev_b32 v10, 16, v105
    v_and_b32 v11, 0xffff0000, v105
    v_lshlrev_b32 v12, 16, v106
    v_and_b32 v13, 0xffff0000, v106
    v_lshlrev_b32 v14, 16, v107
    v_and_b32 v15, 0xffff0000, v107
    v_lshlrev_b32 v16, 16, v104
    v_and_b32 v17, 0xffff0000, v104
    v_lshlrev_b32 v18, 16, v105
    v_and_b32 v19, 0xffff0000, v105
    v_lshlrev_b32 v20, 16, v106
    v_and_b32 v21, 0xffff0000, v106
    v_lshlrev_b32 v22, 16, v107
    v_and_b32 v23, 0xffff0000, v107
    v_cvt_pk_bf16_f32 v56, v160, v161
    v_cvt_pk_bf16_f32 v57, v162, v163
    v_cvt_pk_bf16_f32 v58, v168, v169
    v_cvt_pk_bf16_f32 v59, v170, v171
    v_cvt_pk_bf16_f32 v60, v164, v165
    v_cvt_pk_bf16_f32 v61, v166, v167
    v_cvt_pk_bf16_f32 v62, v172, v173
    v_cvt_pk_bf16_f32 v63, v174, v175
    v_lshlrev_b32 v24, 16, v56
    v_and_b32 v25, 0xffff0000, v56
    v_lshlrev_b32 v26, 16, v57
    v_and_b32 v27, 0xffff0000, v57
    v_lshlrev_b32 v28, 16, v58
    v_and_b32 v29, 0xffff0000, v58
    v_lshlrev_b32 v30, 16, v59
    v_and_b32 v31, 0xffff0000, v59
    v_lshlrev_b32 v32, 16, v60
    v_and_b32 v33, 0xffff0000, v60
    v_lshlrev_b32 v34, 16, v61
    v_and_b32 v35, 0xffff0000, v61
    v_lshlrev_b32 v36, 16, v62
    v_and_b32 v37, 0xffff0000, v62
    v_lshlrev_b32 v38, 16, v63
    v_and_b32 v39, 0xffff0000, v63
    v_pk_add_f32 v[24:25], v[24:25], v[8:9]
    v_pk_add_f32 v[26:27], v[26:27], v[10:11]
    v_pk_add_f32 v[28:29], v[28:29], v[12:13]
    v_pk_add_f32 v[30:31], v[30:31], v[14:15]
    v_pk_add_f32 v[32:33], v[32:33], v[16:17]
    v_pk_add_f32 v[34:35], v[34:35], v[18:19]
    v_pk_add_f32 v[36:37], v[36:37], v[20:21]
    v_pk_add_f32 v[38:39], v[38:39], v[22:23]
    v_cvt_pk_bf16_f32 v56, v24, v25
    v_cvt_pk_bf16_f32 v57, v26, v27
    v_cvt_pk_bf16_f32 v58, v28, v29
    v_cvt_pk_bf16_f32 v59, v30, v31
    v_cvt_pk_bf16_f32 v60, v32, v33
    v_cvt_pk_bf16_f32 v61, v34, v35
    v_cvt_pk_bf16_f32 v62, v36, v37
    v_cvt_pk_bf16_f32 v63, v38, v39
    v_lshlrev_b32 v24, 16, v56
    v_and_b32 v25, 0xffff0000, v56
    v_lshlrev_b32 v26, 16, v57
    v_and_b32 v27, 0xffff0000, v57
    v_lshlrev_b32 v28, 16, v58
    v_and_b32 v29, 0xffff0000, v58
    v_lshlrev_b32 v30, 16, v59
    v_and_b32 v31, 0xffff0000, v59
    v_lshlrev_b32 v32, 16, v60
    v_and_b32 v33, 0xffff0000, v60
    v_lshlrev_b32 v34, 16, v61
    v_and_b32 v35, 0xffff0000, v61
    v_lshlrev_b32 v36, 16, v62
    v_and_b32 v37, 0xffff0000, v62
    v_lshlrev_b32 v38, 16, v63
    v_and_b32 v39, 0xffff0000, v63
    v_pk_mul_f32 v[40:41], v[24:25], v[24:25]
    v_pk_mul_f32 v[42:43], v[26:27], v[26:27]
    v_pk_mul_f32 v[44:45], v[28:29], v[28:29]
    v_pk_mul_f32 v[46:47], v[30:31], v[30:31]
    v_pk_mul_f32 v[48:49], v[32:33], v[32:33]
    v_pk_mul_f32 v[50:51], v[34:35], v[34:35]
    v_pk_mul_f32 v[52:53], v[36:37], v[36:37]
    v_pk_mul_f32 v[54:55], v[38:39], v[38:39]
    v_pk_fma_f32 v[40:41], v[40:41], s[40:41], v[4:5]
    v_pk_fma_f32 v[42:43], v[42:43], s[40:41], v[4:5]
    v_pk_fma_f32 v[44:45], v[44:45], s[40:41], v[4:5]
    v_pk_fma_f32 v[46:47], v[46:47], s[40:41], v[4:5]
    v_pk_fma_f32 v[48:49], v[48:49], s[40:41], v[4:5]
    v_pk_fma_f32 v[50:51], v[50:51], s[40:41], v[4:5]
    v_pk_fma_f32 v[52:53], v[52:53], s[40:41], v[4:5]
    v_pk_fma_f32 v[54:55], v[54:55], s[40:41], v[4:5]
    v_pk_mul_f32 v[40:41], v[40:41], v[24:25]
    v_pk_mul_f32 v[42:43], v[42:43], v[26:27]
    v_pk_mul_f32 v[44:45], v[44:45], v[28:29]
    v_pk_mul_f32 v[46:47], v[46:47], v[30:31]
    v_pk_mul_f32 v[48:49], v[48:49], v[32:33]
    v_pk_mul_f32 v[50:51], v[50:51], v[34:35]
    v_pk_mul_f32 v[52:53], v[52:53], v[36:37]
    v_pk_mul_f32 v[54:55], v[54:55], v[38:39]
    v_exp_f32 v40, v40
    v_exp_f32 v41, v41
    v_exp_f32 v42, v42
    v_exp_f32 v43, v43
    v_exp_f32 v44, v44
    v_exp_f32 v45, v45
    v_exp_f32 v46, v46
    v_exp_f32 v47, v47
    v_exp_f32 v48, v48
    v_exp_f32 v49, v49
    v_exp_f32 v50, v50
    v_exp_f32 v51, v51
    v_exp_f32 v52, v52
    v_exp_f32 v53, v53
    v_exp_f32 v54, v54
    v_exp_f32 v55, v55
    v_add_f32 v40, 1.0, v40
    v_add_f32 v41, 1.0, v41
    v_add_f32 v42, 1.0, v42
    v_add_f32 v43, 1.0, v43
    v_add_f32 v44, 1.0, v44
    v_add_f32 v45, 1.0, v45
    v_add_f32 v46, 1.0, v46
    v_add_f32 v47, 1.0, v47
    v_add_f32 v48, 1.0, v48
    v_add_f32 v49, 1.0, v49
    v_add_f32 v50, 1.0, v50
    v_add_f32 v51, 1.0, v51
    v_add_f32 v52, 1.0, v52
    v_add_f32 v53, 1.0, v53
    v_add_f32 v54, 1.0, v54
    v_add_f32 v55, 1.0, v55
    v_rcp_f32 v40, v40
    v_rcp_f32 v41, v41
    v_rcp_f32 v42, v42
    v_rcp_f32 v43, v43
    v_rcp_f32 v44, v44
    v_rcp_f32 v45, v45
    v_rcp_f32 v46, v46
    v_rcp_f32 v47, v47
    v_rcp_f32 v48, v48
    v_rcp_f32 v49, v49
    v_rcp_f32 v50, v50
    v_rcp_f32 v51, v51
    v_rcp_f32 v52, v52
    v_rcp_f32 v53, v53
    v_rcp_f32 v54, v54
    v_rcp_f32 v55, v55
    s_nop 0
    v_pk_mul_f32 v[40:41], v[40:41], v[24:25]
    v_pk_mul_f32 v[42:43], v[42:43], v[26:27]
    v_pk_mul_f32 v[44:45], v[44:45], v[28:29]
    v_pk_mul_f32 v[46:47], v[46:47], v[30:31]
    v_pk_mul_f32 v[48:49], v[48:49], v[32:33]
    v_pk_mul_f32 v[50:51], v[50:51], v[34:35]
    v_pk_mul_f32 v[52:53], v[52:53], v[36:37]
    v_pk_mul_f32 v[54:55], v[54:55], v[38:39]
    v_cvt_pk_bf16_f32 v64, v40, v41
    v_cvt_pk_bf16_f32 v65, v42, v43
    v_cvt_pk_bf16_f32 v66, v44, v45
    v_cvt_pk_bf16_f32 v67, v46, v47
    v_cvt_pk_bf16_f32 v68, v48, v49
    v_cvt_pk_bf16_f32 v69, v50, v51
    v_cvt_pk_bf16_f32 v70, v52, v53
    v_cvt_pk_bf16_f32 v71, v54, v55
    buffer_store_dwordx4 v[64:67], v2, s[20:23], 0 offen offset:2048
    buffer_store_dwordx4 v[68:71], v3, s[20:23], 0 offen offset:2048
    v_lshlrev_b32 v8, 16, v108
    v_and_b32 v9, 0xffff0000, v108
    v_lshlrev_b32 v10, 16, v109
    v_and_b32 v11, 0xffff0000, v109
    v_lshlrev_b32 v12, 16, v108
    v_and_b32 v13, 0xffff0000, v108
    v_lshlrev_b32 v14, 16, v109
    v_and_b32 v15, 0xffff0000, v109
    v_cvt_pk_bf16_f32 v56, v176, v177
    v_cvt_pk_bf16_f32 v57, v178, v179
    v_cvt_pk_bf16_f32 v58, v180, v181
    v_cvt_pk_bf16_f32 v59, v182, v183
    v_lshlrev_b32 v24, 16, v56
    v_and_b32 v25, 0xffff0000, v56
    v_lshlrev_b32 v26, 16, v57
    v_and_b32 v27, 0xffff0000, v57
    v_lshlrev_b32 v28, 16, v58
    v_and_b32 v29, 0xffff0000, v58
    v_lshlrev_b32 v30, 16, v59
    v_and_b32 v31, 0xffff0000, v59
    v_pk_add_f32 v[24:25], v[24:25], v[8:9]
    v_pk_add_f32 v[26:27], v[26:27], v[10:11]
    v_pk_add_f32 v[28:29], v[28:29], v[12:13]
    v_pk_add_f32 v[30:31], v[30:31], v[14:15]
    v_cvt_pk_bf16_f32 v56, v24, v25
    v_cvt_pk_bf16_f32 v57, v26, v27
    v_cvt_pk_bf16_f32 v58, v28, v29
    v_cvt_pk_bf16_f32 v59, v30, v31
    v_lshlrev_b32 v24, 16, v56
    v_and_b32 v25, 0xffff0000, v56
    v_lshlrev_b32 v26, 16, v57
    v_and_b32 v27, 0xffff0000, v57
    v_lshlrev_b32 v28, 16, v58
    v_and_b32 v29, 0xffff0000, v58
    v_lshlrev_b32 v30, 16, v59
    v_and_b32 v31, 0xffff0000, v59
    v_pk_mul_f32 v[40:41], v[24:25], v[24:25]
    v_pk_mul_f32 v[42:43], v[26:27], v[26:27]
    v_pk_mul_f32 v[44:45], v[28:29], v[28:29]
    v_pk_mul_f32 v[46:47], v[30:31], v[30:31]
    v_pk_fma_f32 v[40:41], v[40:41], s[40:41], v[4:5]
    v_pk_fma_f32 v[42:43], v[42:43], s[40:41], v[4:5]
    v_pk_fma_f32 v[44:45], v[44:45], s[40:41], v[4:5]
    v_pk_fma_f32 v[46:47], v[46:47], s[40:41], v[4:5]
    v_pk_mul_f32 v[40:41], v[40:41], v[24:25]
    v_pk_mul_f32 v[42:43], v[42:43], v[26:27]
    v_pk_mul_f32 v[44:45], v[44:45], v[28:29]
    v_pk_mul_f32 v[46:47], v[46:47], v[30:31]
    v_exp_f32 v40, v40
    v_exp_f32 v41, v41
    v_exp_f32 v42, v42
    v_exp_f32 v43, v43
    v_exp_f32 v44, v44
    v_exp_f32 v45, v45
    v_exp_f32 v46, v46
    v_exp_f32 v47, v47
    v_add_f32 v40, 1.0, v40
    v_add_f32 v41, 1.0, v41
    v_add_f32 v42, 1.0, v42
    v_add_f32 v43, 1.0, v43
    v_add_f32 v44, 1.0, v44
    v_add_f32 v45, 1.0, v45
    v_add_f32 v46, 1.0, v46
    v_add_f32 v47, 1.0, v47
    v_rcp_f32 v40, v40
    v_rcp_f32 v41, v41
    v_rcp_f32 v42, v42
    v_rcp_f32 v43, v43
    v_rcp_f32 v44, v44
    v_rcp_f32 v45, v45
    v_rcp_f32 v46, v46
    v_rcp_f32 v47, v47
    s_nop 0
    v_pk_mul_f32 v[40:41], v[40:41], v[24:25]
    v_pk_mul_f32 v[42:43], v[42:43], v[26:27]
    v_pk_mul_f32 v[44:45], v[44:45], v[28:29]
    v_pk_mul_f32 v[46:47], v[46:47], v[30:31]
    v_cvt_pk_bf16_f32 v80, v40, v41
    v_cvt_pk_bf16_f32 v81, v42, v43
    v_cvt_pk_bf16_f32 v82, v44, v45
    v_cvt_pk_bf16_f32 v83, v46, v47
    buffer_store_dwordx2 v[80:81], v2, s[20:23], 0 offen offset:3072
    buffer_store_dwordx2 v[82:83], v3, s[20:23], 0 offen offset:3072
    s_branch K1_fin
K1_ffn_r1:
    v_lshlrev_b32 v8, 16, v96
    v_and_b32 v9, 0xffff0000, v96
    v_lshlrev_b32 v10, 16, v97
    v_and_b32 v11, 0xffff0000, v97
    v_lshlrev_b32 v12, 16, v96
    v_and_b32 v13, 0xffff0000, v96
    v_lshlrev_b32 v14, 16, v97
    v_and_b32 v15, 0xffff0000, v97
    v_cvt_pk_bf16_f32 v56, v128, v129
    v_cvt_pk_bf16_f32 v57, v130, v131
    v_cvt_pk_bf16_f32 v58, v132, v133
    v_cvt_pk_bf16_f32 v59, v134, v135
    v_lshlrev_b32 v24, 16, v56
    v_and_b32 v25, 0xffff0000, v56
    v_lshlrev_b32 v26, 16, v57
    v_and_b32 v27, 0xffff0000, v57
    v_lshlrev_b32 v28, 16, v58
    v_and_b32 v29, 0xffff0000, v58
    v_lshlrev_b32 v30, 16, v59
    v_and_b32 v31, 0xffff0000, v59
    v_pk_add_f32 v[24:25], v[24:25], v[8:9]
    v_pk_add_f32 v[26:27], v[26:27], v[10:11]
    v_pk_add_f32 v[28:29], v[28:29], v[12:13]
    v_pk_add_f32 v[30:31], v[30:31], v[14:15]
    v_cvt_pk_bf16_f32 v56, v24, v25
    v_cvt_pk_bf16_f32 v57, v26, v27
    v_cvt_pk_bf16_f32 v58, v28, v29
    v_cvt_pk_bf16_f32 v59, v30, v31
    v_lshlrev_b32 v24, 16, v56
    v_and_b32 v25, 0xffff0000, v56
    v_lshlrev_b32 v26, 16, v57
    v_and_b32 v27, 0xffff0000, v57
    v_lshlrev_b32 v28, 16, v58
    v_and_b32 v29, 0xffff0000, v58
    v_lshlrev_b32 v30, 16, v59
    v_and_b32 v31, 0xffff0000, v59
    v_pk_mul_f32 v[40:41], v[24:25], v[24:25]
    v_pk_mul_f32 v[42:43], v[26:27], v[26:27]
    v_pk_mul_f32 v[44:45], v[28:29], v[28:29]
    v_pk_mul_f32 v[46:47], v[30:31], v[30:31]
    v_pk_fma_f32 v[40:41], v[40:41], s[40:41], v[4:5]
    v_pk_fma_f32 v[42:43], v[42:43], s[40:41], v[4:5]
    v_pk_fma_f32 v[44:45], v[44:45], s[40:41], v[4:5]
    v_pk_fma_f32 v[46:47], v[46:47], s[40:41], v[4:5]
    v_pk_mul_f32 v[40:41], v[40:41], v[24:25]
    v_pk_mul_f32 v[42:43], v[42:43], v[26:27]
    v_pk_mul_f32 v[44:45], v[44:45], v[28:29]
    v_pk_mul_f32 v[46:47], v[46:47], v[30:31]
    v_exp_f32 v40, v40
    v_exp_f32 v41, v41
    v_exp_f32 v42, v42
    v_exp_f32 v43, v43
    v_exp_f32 v44, v44
    v_exp_f32 v45, v45
    v_exp_f32 v46, v46
    v_exp_f32 v47, v47
    v_add_f32 v40, 1.0, v40
    v_add_f32 v41, 1.0, v41
    v_add_f32 v42, 1.0, v42
    v_add_f32 v43, 1.0, v43
    v_add_f32 v44, 1.0, v44
    v_add_f32 v45, 1.0, v45
    v_add_f32 v46, 1.0, v46
    v_add_f32 v47, 1.0, v47
    v_rcp_f32 v40, v40
    v_rcp_f32 v41, v41
    v_rcp_f32 v42, v42
    v_rcp_f32 v43, v43
    v_rcp_f32 v44, v44
    v_rcp_f32 v45, v45
    v_rcp_f32 v46, v46
    v_rcp_f32 v47, v47
    s_nop 0
    v_pk_mul_f32 v[40:41], v[40:41], v[24:25]
    v_pk_mul_f32 v[42:43], v[42:43], v[26:27]
    v_pk_mul_f32 v[44:45], v[44:45], v[28:29]
    v_pk_mul_f32 v[46:47], v[46:47], v[30:31]
    v_cvt_pk_bf16_f32 v80, v40, v41
    v_cvt_pk_bf16_f32 v81, v42, v43
    v_cvt_pk_bf16_f32 v82, v44, v45
    v_cvt_pk_bf16_f32 v83, v46, v47
    buffer_store_dwordx2 v[80:81], v2, s[20:23], 0 offen offset:3080
    buffer_store_dwordx2 v[82:83], v3, s[20:23], 0 offen offset:3080
    v_lshlrev_b32 v8, 16, v98
    v_and_b32 v9, 0xffff0000, v98
    v_lshlrev_b32 v10, 16, v99
    v_and_b32 v11, 0xffff0000, v99
    v_lshlrev_b32 v12, 16, v100
    v_and_b32 v13, 0xffff0000, v100
    v_lshlrev_b32 v14, 16, v101
    v_and_b32 v15, 0xffff0000, v101
    v_lshlrev_b32 v16, 16, v98
    v_and_b32 v17, 0xffff0000, v98
    v_lshlrev_b32 v18, 16, v99
    v_and_b32 v19, 0xffff0000, v99
    v_lshlrev_b32 v20, 16, v100
    v_and_b32 v21, 0xffff0000, v100
    v_lshlrev_b32 v22, 16, v101
    v_and_b32 v23, 0xffff0000, v101
    v_cvt_pk_bf16_f32 v56, v136, v137
    v_cvt_pk_bf16_f32 v57, v138, v139
    v_cvt_pk_bf16_f32 v58, v144, v145
    v_cvt_pk_bf16_f32 v59, v146, v147
    v_cvt_pk_bf16_f32 v60, v140, v141
    v_cvt_pk_bf16_f32 v61, v142, v143
    v_cvt_pk_bf16_f32 v62, v148, v149
    v_cvt_pk_bf16_f32 v63, v150, v151
    v_lshlrev_b32 v24, 16, v56
    v_and_b32 v25, 0xffff0000, v56
    v_lshlrev_b32 v26, 16, v57
    v_and_b32 v27, 0xffff0000, v57
    v_lshlrev_b32 v28, 16, v58
    v_and_b32 v29, 0xffff0000, v58
    v_lshlrev_b32 v30, 16, v59
    v_and_b32 v31, 0xffff0000, v59
    v_lshlrev_b32 v32, 16, v60
    v_and_b32 v33, 0xffff0000, v60
    v_lshlrev_b32 v34, 16, v61
    v_and_b32 v35, 0xffff0000, v61
    v_lshlrev_b32 v36, 16, v62
    v_and_b32 v37, 0xffff0000, v62
    v_lshlrev_b32 v38, 16, v63
    v_and_b32 v39, 0xffff0000, v63
    v_pk_add_f32 v[24:25], v[24:25], v[8:9]
    v_pk_add_f32 v[26:27], v[26:27], v[10:11]
    v_pk_add_f32 v[28:29], v[28:29], v[12:13]
    v_pk_add_f32 v[30:31], v[30:31], v[14:15]
    v_pk_add_f32 v[32:33], v[32:33], v[16:17]
    v_pk_add_f32 v[34:35], v[34:35], v[18:19]
    v_pk_add_f32 v[36:37], v[36:37], v[20:21]
    v_pk_add_f32 v[38:39], v[38:39], v[22:23]
    v_cvt_pk_bf16_f32 v56, v24, v25
    v_cvt_pk_bf16_f32 v57, v26, v27
    v_cvt_pk_bf16_f32 v58, v28, v29
    v_cvt_pk_bf16_f32 v59, v30, v31
    v_cvt_pk_bf16_f32 v60, v32, v33
    v_cvt_pk_bf16_f32 v61, v34, v35
    v_cvt_pk_bf16_f32 v62, v36, v37
    v_cvt_pk_bf16_f32 v63, v38, v39
    v_lshlrev_b32 v24, 16, v56
    v_and_b32 v25, 0xffff0000, v56
    v_lshlrev_b32 v26, 16, v57
    v_and_b32 v27, 0xffff0000, v57
    v_lshlrev_b32 v28, 16, v58
    v_and_b32 v29, 0xffff0000, v58
    v_lshlrev_b32 v30, 16, v59
    v_and_b32 v31, 0xffff0000, v59
    v_lshlrev_b32 v32, 16, v60
    v_and_b32 v33, 0xffff0000, v60
    v_lshlrev_b32 v34, 16, v61
    v_and_b32 v35, 0xffff0000, v61
    v_lshlrev_b32 v36, 16, v62
    v_and_b32 v37, 0xffff0000, v62
    v_lshlrev_b32 v38, 16, v63
    v_and_b32 v39, 0xffff0000, v63
    v_pk_mul_f32 v[40:41], v[24:25], v[24:25]
    v_pk_mul_f32 v[42:43], v[26:27], v[26:27]
    v_pk_mul_f32 v[44:45], v[28:29], v[28:29]
    v_pk_mul_f32 v[46:47], v[30:31], v[30:31]
    v_pk_mul_f32 v[48:49], v[32:33], v[32:33]
    v_pk_mul_f32 v[50:51], v[34:35], v[34:35]
    v_pk_mul_f32 v[52:53], v[36:37], v[36:37]
    v_pk_mul_f32 v[54:55], v[38:39], v[38:39]
    v_pk_fma_f32 v[40:41], v[40:41], s[40:41], v[4:5]
    v_pk_fma_f32 v[42:43], v[42:43], s[40:41], v[4:5]
    v_pk_fma_f32 v[44:45], v[44:45], s[40:41], v[4:5]
    v_pk_fma_f32 v[46:47], v[46:47], s[40:41], v[4:5]
    v_pk_fma_f32 v[48:49], v[48:49], s[40:41], v[4:5]
    v_pk_fma_f32 v[50:51], v[50:51], s[40:41], v[4:5]
    v_pk_fma_f32 v[52:53], v[52:53], s[40:41], v[4:5]
    v_pk_fma_f32 v[54:55], v[54:55], s[40:41], v[4:5]
    v_pk_mul_f32 v[40:41], v[40:41], v[24:25]
    v_pk_mul_f32 v[42:43], v[42:43], v[26:27]
    v_pk_mul_f32 v[44:45], v[44:45], v[28:29]
    v_pk_mul_f32 v[46:47], v[46:47], v[30:31]
    v_pk_mul_f32 v[48:49], v[48:49], v[32:33]
    v_pk_mul_f32 v[50:51], v[50:51], v[34:35]
    v_pk_mul_f32 v[52:53], v[52:53], v[36:37]
    v_pk_mul_f32 v[54:55], v[54:55], v[38:39]
    v_exp_f32 v40, v40
    v_exp_f32 v41, v41
    v_exp_f32 v42, v42
    v_exp_f32 v43, v43
    v_exp_f32 v44, v44
    v_exp_f32 v45, v45
    v_exp_f32 v46, v46
    v_exp_f32 v47, v47
    v_exp_f32 v48, v48
    v_exp_f32 v49, v49
    v_exp_f32 v50, v50
    v_exp_f32 v51, v51
    v_exp_f32 v52, v52
    v_exp_f32 v53, v53
    v_exp_f32 v54, v54
    v_exp_f32 v55, v55
    v_add_f32 v40, 1.0, v40
    v_add_f32 v41, 1.0, v41
    v_add_f32 v42, 1.0, v42
    v_add_f32 v43, 1.0, v43
    v_add_f32 v44, 1.0, v44
    v_add_f32 v45, 1.0, v45
    v_add_f32 v46, 1.0, v46
    v_add_f32 v47, 1.0, v47
    v_add_f32 v48, 1.0, v48
    v_add_f32 v49, 1.0, v49
    v_add_f32 v50, 1.0, v50
    v_add_f32 v51, 1.0, v51
    v_add_f32 v52, 1.0, v52
    v_add_f32 v53, 1.0, v53
    v_add_f32 v54, 1.0, v54
    v_add_f32 v55, 1.0, v55
    v_rcp_f32 v40, v40
    v_rcp_f32 v41, v41
    v_rcp_f32 v42, v42
    v_rcp_f32 v43, v43
    v_rcp_f32 v44, v44
    v_rcp_f32 v45, v45
    v_rcp_f32 v46, v46
    v_rcp_f32 v47, v47
    v_rcp_f32 v48, v48
    v_rcp_f32 v49, v49
    v_rcp_f32 v50, v50
    v_rcp_f32 v51, v51
    v_rcp_f32 v52, v52
    v_rcp_f32 v53, v53
    v_rcp_f32 v54, v54
    v_rcp_f32 v55, v55
    s_nop 0
    v_pk_mul_f32 v[40:41], v[40:41], v[24:25]
    v_pk_mul_f32 v[42:43], v[42:43], v[26:27]
    v_pk_mul_f32 v[44:45], v[44:45], v[28:29]
    v_pk_mul_f32 v[46:47], v[46:47], v[30:31]
    v_pk_mul_f32 v[48:49], v[48:49], v[32:33]
    v_pk_mul_f32 v[50:51], v[50:51], v[34:35]
    v_pk_mul_f32 v[52:53], v[52:53], v[36:37]
    v_pk_mul_f32 v[54:55], v[54:55], v[38:39]
    v_cvt_pk_bf16_f32 v64, v40, v41
    v_cvt_pk_bf16_f32 v65, v42, v43
    v_cvt_pk_bf16_f32 v66, v44, v45
    v_cvt_pk_bf16_f32 v67, v46, v47
    v_cvt_pk_bf16_f32 v68, v48, v49
    v_cvt_pk_bf16_f32 v69, v50, v51
    v_cvt_pk_bf16_f32 v70, v52, v53
    v_cvt_pk_bf16_f32 v71, v54, v55
    buffer_store_dwordx4 v[64:67], v2, s[20:23], s42 offen offset:0
    buffer_store_dwordx4 v[68:71], v3, s[20:23], s42 offen offset:0
    v_lshlrev_b32 v8, 16, v102
    v_and_b32 v9, 0xffff0000, v102
    v_lshlrev_b32 v10, 16, v103
    v_and_b32 v11, 0xffff0000, v103
    v_lshlrev_b32 v12, 16, v104
    v_and_b32 v13, 0xffff0000, v104
    v_lshlrev_b32 v14, 16, v105
    v_and_b32 v15, 0xffff0000, v105
    v_lshlrev_b32 v16, 16, v102
    v_and_b32 v17, 0xffff0000, v102
    v_lshlrev_b32 v18, 16, v103
    v_and_b32 v19, 0xffff0000, v103
    v_lshlrev_b32 v20, 16, v104
    v_and_b32 v21, 0xffff0000, v104
    v_lshlrev_b32 v22, 16, v105
    v_and_b32 v23, 0xffff0000, v105
    v_cvt_pk_bf16_f32 v56, v152, v153
    v_cvt_pk_bf16_f32 v57, v154, v155
    v_cvt_pk_bf16_f32 v58, v160, v161
    v_cvt_pk_bf16_f32 v59, v162, v163
    v_cvt_pk_bf16_f32 v60, v156, v157
    v_cvt_pk_bf16_f32 v61, v158, v159
    v_cvt_pk_bf16_f32 v62, v164, v165
    v_cvt_pk_bf16_f32 v63, v166, v167
    v_lshlrev_b32 v24, 16, v56
    v_and_b32 v25, 0xffff0000, v56
    v_lshlrev_b32 v26, 16, v57
    v_and_b32 v27, 0xffff0000, v57
    v_lshlrev_b32 v28, 16, v58
    v_and_b32 v29, 0xffff0000, v58
    v_lshlrev_b32 v30, 16, v59
    v_and_b32 v31, 0xffff0000, v59
    v_lshlrev_b32 v32, 16, v60
    v_and_b32 v33, 0xffff0000, v60
    v_lshlrev_b32 v34, 16, v61
    v_and_b32 v35, 0xffff0000, v61
    v_lshlrev_b32 v36, 16, v62
    v_and_b32 v37, 0xffff0000, v62
    v_lshlrev_b32 v38, 16, v63
    v_and_b32 v39, 0xffff0000, v63
    v_pk_add_f32 v[24:25], v[24:25], v[8:9]
    v_pk_add_f32 v[26:27], v[26:27], v[10:11]
    v_pk_add_f32 v[28:29], v[28:29], v[12:13]
    v_pk_add_f32 v[30:31], v[30:31], v[14:15]
    v_pk_add_f32 v[32:33], v[32:33], v[16:17]
    v_pk_add_f32 v[34:35], v[34:35], v[18:19]
    v_pk_add_f32 v[36:37], v[36:37], v[20:21]
    v_pk_add_f32 v[38:39], v[38:39], v[22:23]
    v_cvt_pk_bf16_f32 v56, v24, v25
    v_cvt_pk_bf16_f32 v57, v26, v27
    v_cvt_pk_bf16_f32 v58, v28, v29
    v_cvt_pk_bf16_f32 v59, v30, v31
    v_cvt_pk_bf16_f32 v60, v32, v33
    v_cvt_pk_bf16_f32 v61, v34, v35
    v_cvt_pk_bf16_f32 v62, v36, v37
    v_cvt_pk_bf16_f32 v63, v38, v39
    v_lshlrev_b32 v24, 16, v56
    v_and_b32 v25, 0xffff0000, v56
    v_lshlrev_b32 v26, 16, v57
    v_and_b32 v27, 0xffff0000, v57
    v_lshlrev_b32 v28, 16, v58
    v_and_b32 v29, 0xffff0000, v58
    v_lshlrev_b32 v30, 16, v59
    v_and_b32 v31, 0xffff0000, v59
    v_lshlrev_b32 v32, 16, v60
    v_and_b32 v33, 0xffff0000, v60
    v_lshlrev_b32 v34, 16, v61
    v_and_b32 v35, 0xffff0000, v61
    v_lshlrev_b32 v36, 16, v62
    v_and_b32 v37, 0xffff0000, v62
    v_lshlrev_b32 v38, 16, v63
    v_and_b32 v39, 0xffff0000, v63
    v_pk_mul_f32 v[40:41], v[24:25], v[24:25]
    v_pk_mul_f32 v[42:43], v[26:27], v[26:27]
    v_pk_mul_f32 v[44:45], v[28:29], v[28:29]
    v_pk_mul_f32 v[46:47], v[30:31], v[30:31]
    v_pk_mul_f32 v[48:49], v[32:33], v[32:33]
    v_pk_mul_f32 v[50:51], v[34:35], v[34:35]
    v_pk_mul_f32 v[52:53], v[36:37], v[36:37]
    v_pk_mul_f32 v[54:55], v[38:39], v[38:39]
    v_pk_fma_f32 v[40:41], v[40:41], s[40:41], v[4:5]
    v_pk_fma_f32 v[42:43], v[42:43], s[40:41], v[4:5]
    v_pk_fma_f32 v[44:45], v[44:45], s[40:41], v[4:5]
    v_pk_fma_f32 v[46:47], v[46:47], s[40:41], v[4:5]
    v_pk_fma_f32 v[48:49], v[48:49], s[40:41], v[4:5]
    v_pk_fma_f32 v[50:51], v[50:51], s[40:41], v[4:5]
    v_pk_fma_f32 v[52:53], v[52:53], s[40:41], v[4:5]
    v_pk_fma_f32 v[54:55], v[54:55], s[40:41], v[4:5]
    v_pk_mul_f32 v[40:41], v[40:41], v[24:25]
    v_pk_mul_f32 v[42:43], v[42:43], v[26:27]
    v_pk_mul_f32 v[44:45], v[44:45], v[28:29]
    v_pk_mul_f32 v[46:47], v[46:47], v[30:31]
    v_pk_mul_f32 v[48:49], v[48:49], v[32:33]
    v_pk_mul_f32 v[50:51], v[50:51], v[34:35]
    v_pk_mul_f32 v[52:53], v[52:53], v[36:37]
    v_pk_mul_f32 v[54:55], v[54:55], v[38:39]
    v_exp_f32 v40, v40
    v_exp_f32 v41, v41
    v_exp_f32 v42, v42
    v_exp_f32 v43, v43
    v_exp_f32 v44, v44
    v_exp_f32 v45, v45
    v_exp_f32 v46, v46
    v_exp_f32 v47, v47
    v_exp_f32 v48, v48
    v_exp_f32 v49, v49
    v_exp_f32 v50, v50
    v_exp_f32 v51, v51
    v_exp_f32 v52, v52
    v_exp_f32 v53, v53
    v_exp_f32 v54, v54
    v_exp_f32 v55, v55
    v_add_f32 v40, 1.0, v40
    v_add_f32 v41, 1.0, v41
    v_add_f32 v42, 1.0, v42
    v_add_f32 v43, 1.0, v43
    v_add_f32 v44, 1.0, v44
    v_add_f32 v45, 1.0, v45
    v_add_f32 v46, 1.0, v46
    v_add_f32 v47, 1.0, v47
    v_add_f32 v48, 1.0, v48
    v_add_f32 v49, 1.0, v49
    v_add_f32 v50, 1.0, v50
    v_add_f32 v51, 1.0, v51
    v_add_f32 v52, 1.0, v52
    v_add_f32 v53, 1.0, v53
    v_add_f32 v54, 1.0, v54
    v_add_f32 v55, 1.0, v55
    v_rcp_f32 v40, v40
    v_rcp_f32 v41, v41
    v_rcp_f32 v42, v42
    v_rcp_f32 v43, v43
    v_rcp_f32 v44, v44
    v_rcp_f32 v45, v45
    v_rcp_f32 v46, v46
    v_rcp_f32 v47, v47
    v_rcp_f32 v48, v48
    v_rcp_f32 v49, v49
    v_rcp_f32 v50, v50
    v_rcp_f32 v51, v51
    v_rcp_f32 v52, v52
    v_rcp_f32 v53, v53
    v_rcp_f32 v54, v54
    v_rcp_f32 v55, v55
    s_nop 0
    v_pk_mul_f32 v[40:41], v[40:41], v[24:25]
    v_pk_mul_f32 v[42:43], v[42:43], v[26:27]
    v_pk_mul_f32 v[44:45], v[44:45], v[28:29]
    v_pk_mul_f32 v[46:47], v[46:47], v[30:31]
    v_pk_mul_f32 v[48:49], v[48:49], v[32:33]
    v_pk_mul_f32 v[50:51], v[50:51], v[34:35]
    v_pk_mul_f32 v[52:53], v[52:53], v[36:37]
    v_pk_mul_f32 v[54:55], v[54:55], v[38:39]
    v_cvt_pk_bf16_f32 v72, v40, v41
    v_cvt_pk_bf16_f32 v73, v42, v43
    v_cvt_pk_bf16_f32 v74, v44, v45
    v_cvt_pk_bf16_f32 v75, v46, v47
    v_cvt_pk_bf16_f32 v76, v48, v49
    v_cvt_pk_bf16_f32 v77, v50, v51
    v_cvt_pk_bf16_f32 v78, v52, v53
    v_cvt_pk_bf16_f32 v79, v54, v55
    buffer_store_dwordx4 v[72:75], v2, s[20:23], s42 offen offset:1024
    buffer_store_dwordx4 v[76:79], v3, s[20:23], s42 offen offset:1024
    s_cmp_eq_u32 s72, 12
    s_cbranch_scc1 K1_fin
    v_lshlrev_b32 v8, 16, v106
    v_and_b32 v9, 0xffff0000, v106
    v_lshlrev_b32 v10, 16, v107
    v_and_b32 v11, 0xffff0000, v107
    v_lshlrev_b32 v12, 16, v108
    v_and_b32 v13, 0xffff0000, v108
    v_lshlrev_b32 v14, 16, v109
    v_and_b32 v15, 0xffff0000, v109
    v_lshlrev_b32 v16, 16, v106
    v_and_b32 v17, 0xffff0000, v106
    v_lshlrev_b32 v18, 16, v107
    v_and_b32 v19, 0xffff0000, v107
    v_lshlrev_b32 v20, 16, v108
    v_and_b32 v21, 0xffff0000, v108
    v_lshlrev_b32 v22, 16, v109
    v_and_b32 v23, 0xffff0000, v109
    v_cvt_pk_bf16_f32 v56, v168, v169
    v_cvt_pk_bf16_f32 v57, v170, v171
    v_cvt_pk_bf16_f32 v58, v176, v177
    v_cvt_pk_bf16_f32 v59, v178, v179
    v_cvt_pk_bf16_f32 v60, v172, v173
    v_cvt_pk_bf16_f32 v61, v174, v175
    v_cvt_pk_bf16_f32 v62, v180, v181
    v_cvt_pk_bf16_f32 v63, v182, v183
    v_lshlrev_b32 v24, 16, v56
    v_and_b32 v25, 0xffff0000, v56
    v_lshlrev_b32 v26, 16, v57
    v_and_b32 v27, 0xffff0000, v57
    v_lshlrev_b32 v28, 16, v58
    v_and_b32 v29, 0xffff0000, v58
    v_lshlrev_b32 v30, 16, v59
    v_and_b32 v31, 0xffff0000, v59
    v_lshlrev_b32 v32, 16, v60
    v_and_b32 v33, 0xffff0000, v60
    v_lshlrev_b32 v34, 16, v61
    v_and_b32 v35, 0xffff0000, v61
    v_lshlrev_b32 v36, 16, v62
    v_and_b32 v37, 0xffff0000, v62
    v_lshlrev_b32 v38, 16, v63
    v_and_b32 v39, 0xffff0000, v63
    v_pk_add_f32 v[24:25], v[24:25], v[8:9]
    v_pk_add_f32 v[26:27], v[26:27], v[10:11]
    v_pk_add_f32 v[28:29], v[28:29], v[12:13]
    v_pk_add_f32 v[30:31], v[30:31], v[14:15]
    v_pk_add_f32 v[32:33], v[32:33], v[16:17]
    v_pk_add_f32 v[34:35], v[34:35], v[18:19]
    v_pk_add_f32 v[36:37], v[36:37], v[20:21]
    v_pk_add_f32 v[38:39], v[38:39], v[22:23]
    v_cvt_pk_bf16_f32 v56, v24, v25
    v_cvt_pk_bf16_f32 v57, v26, v27
    v_cvt_pk_bf16_f32 v58, v28, v29
    v_cvt_pk_bf16_f32 v59, v30, v31
    v_cvt_pk_bf16_f32 v60, v32, v33
    v_cvt_pk_bf16_f32 v61, v34, v35
    v_cvt_pk_bf16_f32 v62, v36, v37
    v_cvt_pk_bf16_f32 v63, v38, v39
    v_lshlrev_b32 v24, 16, v56
    v_and_b32 v25, 0xffff0000, v56
    v_lshlrev_b32 v26, 16, v57
    v_and_b32 v27, 0xffff0000, v57
    v_lshlrev_b32 v28, 16, v58
    v_and_b32 v29, 0xffff0000, v58
    v_lshlrev_b32 v30, 16, v59
    v_and_b32 v31, 0xffff0000, v59
    v_lshlrev_b32 v32, 16, v60
    v_and_b32 v33, 0xffff0000, v60
    v_lshlrev_b32 v34, 16, v61
    v_and_b32 v35, 0xffff0000, v61
    v_lshlrev_b32 v36, 16, v62
    v_and_b32 v37, 0xffff0000, v62
    v_lshlrev_b32 v38, 16, v63
    v_and_b32 v39, 0xffff0000, v63
    v_pk_mul_f32 v[40:41], v[24:25], v[24:25]
    v_pk_mul_f32 v[42:43], v[26:27], v[26:27]
    v_pk_mul_f32 v[44:45], v[28:29], v[28:29]
    v_pk_mul_f32 v[46:47], v[30:31], v[30:31]
    v_pk_mul_f32 v[48:49], v[32:33], v[32:33]
    v_pk_mul_f32 v[50:51], v[34:35], v[34:35]
    v_pk_mul_f32 v[52:53], v[36:37], v[36:37]
    v_pk_mul_f32 v[54:55], v[38:39], v[38:39]
    v_pk_fma_f32 v[40:41], v[40:41], s[40:41], v[4:5]
    v_pk_fma_f32 v[42:43], v[42:43], s[40:41], v[4:5]
    v_pk_fma_f32 v[44:45], v[44:45], s[40:41], v[4:5]
    v_pk_fma_f32 v[46:47], v[46:47], s[40:41], v[4:5]
    v_pk_fma_f32 v[48:49], v[48:49], s[40:41], v[4:5]
    v_pk_fma_f32 v[50:51], v[50:51], s[40:41], v[4:5]
    v_pk_fma_f32 v[52:53], v[52:53], s[40:41], v[4:5]
    v_pk_fma_f32 v[54:55], v[54:55], s[40:41], v[4:5]
    v_pk_mul_f32 v[40:41], v[40:41], v[24:25]
    v_pk_mul_f32 v[42:43], v[42:43], v[26:27]
    v_pk_mul_f32 v[44:45], v[44:45], v[28:29]
    v_pk_mul_f32 v[46:47], v[46:47], v[30:31]
    v_pk_mul_f32 v[48:49], v[48:49], v[32:33]
    v_pk_mul_f32 v[50:51], v[50:51], v[34:35]
    v_pk_mul_f32 v[52:53], v[52:53], v[36:37]
    v_pk_mul_f32 v[54:55], v[54:55], v[38:39]
    v_exp_f32 v40, v40
    v_exp_f32 v41, v41
    v_exp_f32 v42, v42
    v_exp_f32 v43, v43
    v_exp_f32 v44, v44
    v_exp_f32 v45, v45
    v_exp_f32 v46, v46
    v_exp_f32 v47, v47
    v_exp_f32 v48, v48
    v_exp_f32 v49, v49
    v_exp_f32 v50, v50
    v_exp_f32 v51, v51
    v_exp_f32 v52, v52
    v_exp_f32 v53, v53
    v_exp_f32 v54, v54
    v_exp_f32 v55, v55
    v_add_f32 v40, 1.0, v40
    v_add_f32 v41, 1.0, v41
    v_add_f32 v42, 1.0, v42
    v_add_f32 v43, 1.0, v43
    v_add_f32 v44, 1.0, v44
    v_add_f32 v45, 1.0, v45
    v_add_f32 v46, 1.0, v46
    v_add_f32 v47, 1.0, v47
    v_add_f32 v48, 1.0, v48
    v_add_f32 v49, 1.0, v49
    v_add_f32 v50, 1.0, v50
    v_add_f32 v51, 1.0, v51
    v_add_f32 v52, 1.0, v52
    v_add_f32 v53, 1.0, v53
    v_add_f32 v54, 1.0, v54
    v_add_f32 v55, 1.0, v55
    v_rcp_f32 v40, v40
    v_rcp_f32 v41, v41
    v_rcp_f32 v42, v42
    v_rcp_f32 v43, v43
    v_rcp_f32 v44, v44
    v_rcp_f32 v45, v45
    v_rcp_f32 v46, v46
    v_rcp_f32 v47, v47
    v_rcp_f32 v48, v48
    v_rcp_f32 v49, v49
    v_rcp_f32 v50, v50
    v_rcp_f32 v51, v51
    v_rcp_f32 v52, v52
    v_rcp_f32 v53, v53
    v_rcp_f32 v54, v54
    v_rcp_f32 v55, v55
    s_nop 0
    v_pk_mul_f32 v[40:41], v[40:41], v[24:25]
    v_pk_mul_f32 v[42:43], v[42:43], v[26:27]
    v_pk_mul_f32 v[44:45], v[44:45], v[28:29]
    v_pk_mul_f32 v[46:47], v[46:47], v[30:31]
    v_pk_mul_f32 v[48:49], v[48:49], v[32:33]
    v_pk_mul_f32 v[50:51], v[50:51], v[34:35]
    v_pk_mul_f32 v[52:53], v[52:53], v[36:37]
    v_pk_mul_f32 v[54:55], v[54:55], v[38:39]
    v_cvt_pk_bf16_f32 v64, v40, v41
    v_cvt_pk_bf16_f32 v65, v42, v43
    v_cvt_pk_bf16_f32 v66, v44, v45
    v_cvt_pk_bf16_f32 v67, v46, v47
    v_cvt_pk_bf16_f32 v68, v48, v49
    v_cvt_pk_bf16_f32 v69, v50, v51
    v_cvt_pk_bf16_f32 v70, v52, v53
    v_cvt_pk_bf16_f32 v71, v54, v55
    buffer_store_dwordx4 v[64:67], v2, s[20:23], s42 offen offset:2048
    buffer_store_dwordx4 v[68:71], v3, s[20:23], s42 offen offset:2048
K1_fin:
    s_cmp_ge_u32 s88, 592
    s_cbranch_scc1 K1_fin2
    v_lshrrev_b32 v16, 4, v1
    v_and_b32 v17, 15, v1
    v_lshrrev_b32 v18, 2, v17
    v_and_b32 v17, 3, v17
    v_lshlrev_b32 v19, 2, v16
    v_add_u32 v19, v19, v18
    v_mul_u32_u24 v19, 160, v19
    v_lshlrev_b32 v17, 3, v17
    v_add_u32 v19, v19, v17
    v_add_u32 v13, s78, v19
    v_lshlrev_b32 v14, 4, v1
    s_waitcnt vmcnt(0)
    ds_read_b64_tr_b16 v[32:33], v13 offset:0
    ds_read_b64_tr_b16 v[34:35], v13 offset:2560
    ds_read_b64_tr_b16 v[36:37], v13 offset:32
    ds_read_b64_tr_b16 v[38:39], v13 offset:2592
    ds_read_b64_tr_b16 v[40:41], v13 offset:64
    ds_read_b64_tr_b16 v[42:43], v13 offset:2624
    ds_read_b64_tr_b16 v[44:45], v13 offset:96
    ds_read_b64_tr_b16 v[46:47], v13 offset:2656
    ds_read_b64_tr_b16 v[48:49], v13 offset:128
    ds_read_b64_tr_b16 v[50:51], v13 offset:2688
    s_waitcnt lgkmcnt(0)
    buffer_store_dwordx4 v[32:35], v14, s[84:87], s89 offen offset:0
    buffer_store_dwordx4 v[36:39], v14, s[84:87], s89 offen offset:1024
    buffer_store_dwordx4 v[40:43], v14, s[84:87], s89 offen offset:2048
    buffer_store_dwordx4 v[44:47], v14, s[84:87], s89 offen offset:3072
    s_add_u32 s89, s89, 4096
    buffer_store_dwordx4 v[48:51], v14, s[84:87], s89 offen
K1_fin2:
K1_done:
    s_endpgm
.globl km_kernel
.p2align 8
.type km_kernel,@function
km_kernel:
    s_cmp_ge_u32 s2, 256
    s_cbranch_scc1 KM_done
    s_load_dwordx2 s[4:5], s[0:1], 56
    s_load_dwordx2 s[6:7], s[0:1], 80
    s_load_dwordx2 s[8:9], s[0:1], 72
    s_load_dwordx2 s[10:11], s[0:1], 88
    v_lshrrev_b32 v2, 6, v0
    v_and_b32 v1, 63, v0
    s_nop 0
    v_readfirstlane_b32 s30, v2
    s_mov_b32 s39, 0x358637bd
    s_and_b32 s33, s2, 7
    s_lshr_b32 s34, s2, 3
    s_and_b32 s29, s33, 1
    s_lshl_b32 s29, s29, 2
    s_and_b32 s35, s34, 3
    s_or_b32 s29, s29, s35
    s_lshr_b32 s28, s33, 1
    s_lshl_b32 s28, s28, 3
    s_lshr_b32 s35, s34, 2
    s_or_b32 s28, s28, s35
    s_waitcnt lgkmcnt(0)
    s_add_u32 s12, s10, 2621440
    s_addc_u32 s13, s11, 0
    s_mov_b32 s14, 7077888
    s_mov_b32 s15, 0x00020000
    s_add_u32 s16, s10, 16777216
    s_addc_u32 s17, s11, 0
    s_mov_b32 s18, 2211840
    s_mov_b32 s19, 0x00020000
    s_add_u32 s20, s10, 12058624
    s_addc_u32 s21, s11, 0
    s_mov_b32 s22, 147456
    s_mov_b32 s23, 0x00020000
    s_mov_b32 s24, s4
    s_mov_b32 s25, s5
    s_mov_b32 s26, 1280
    s_mov_b32 s27, 0x00020000
    s_add_u32 s44, s10, 15204352
    s_addc_u32 s45, s11, 0
    s_mov_b32 s46, 65536
    s_mov_b32 s47, 0x00020000
    s_mov_b32 s48, s8
    s_mov_b32 s49, s9
    s_mov_b32 s50, 2621440
    s_mov_b32 s51, 0x00020000
    s_mov_b32 s52, s10
    s_mov_b32 s53, s11
    s_mov_b32 s54, 2621440
    s_mov_b32 s55, 0x00020000
    s_add_u32 s56, s10, 19398656
    s_addc_u32 s57, s11, 0
    s_mov_b32 s58, 819200
    s_mov_b32 s59, 0x00020000
    s_add_u32 s60, s10, 9699328
    s_addc_u32 s61, s11, 0
    s_mov_b32 s62, 2359296
    s_mov_b32 s63, 0x00020000
    s_mov_b32 s64, s6
    s_mov_b32 s65, s7
    s_mov_b32 s66, 256
    s_mov_b32 s67, 0x00020000
    v_lshlrev_b32 v2, 4, v1
    s_lshl_b32 s70, s2, 1
    s_add_u32 s70, s70, s30
    s_sub_u32 s70, s70, 2
    s_cmp_lt_u32 s30, 2
    s_cselect_b32 s70, 0xffff, s70
    s_cmp_ge_u32 s70, 208
    s_cbranch_scc1 KM_notask0
    s_cmp_ge_u32 s70, 104
    s_cselect_b32 s71, 1, 0
    s_cselect_b32 s3, 104, 0
    s_sub_u32 s3, s70, s3
    s_mul_i32 s72, s3, 5042
    s_lshr_b32 s72, s72, 16
    s_mul_i32 s73, s72, 13
    s_sub_u32 s73, s3, s73
    s_lshl_b32 s74, s73, 2
    s_mov_b32 s76, 0x22211100
    s_mov_b32 s77, 0x44333
    s_lshr_b64 s[76:77], s[76:77], s74
    s_and_b32 s75, s76, 15
    s_mov_b32 s76, 0x32121010
    s_mov_b32 s77, 0x43432
    s_lshr_b64 s[76:77], s[76:77], s74
    s_and_b32 s74, s76, 15
    s_add_u32 s76, s75, 13
    s_cmp_eq_u32 s71, 1
    s_cselect_b32 s76, s76, s73
    s_mul_i32 s77, s72, 18
    s_add_u32 s76, s76, s77
    s_lshl_b32 s76, s76, 10
    v_add_u32 v3, s76, v2
    s_mov_b32 s76, 0
    buffer_load_dwordx4 v[124:127], v3, s[60:63], s76 offen
    s_add_u32 s76, s76, 147456
    buffer_load_dwordx4 v[128:131], v3, s[60:63], s76 offen
    s_add_u32 s76, s76, 147456
    buffer_load_dwordx4 v[132:135], v3, s[60:63], s76 offen
    s_add_u32 s76, s76, 147456
    buffer_load_dwordx4 v[136:139], v3, s[60:63], s76 offen
    s_add_u32 s76, s76, 147456
    buffer_load_dwordx4 v[140:143], v3, s[60:63], s76 offen
    s_add_u32 s76, s76, 147456
    buffer_load_dwordx4 v[144:147], v3, s[60:63], s76 offen
    s_add_u32 s76, s76, 147456
    buffer_load_dwordx4 v[148:151], v3, s[60:63], s76 offen
    s_add_u32 s76, s76, 147456
    buffer_load_dwordx4 v[152:155], v3, s[60:63], s76 offen
    s_add_u32 s76, s76, 147456
    buffer_load_dwordx4 v[156:159], v3, s[60:63], s76 offen
    s_add_u32 s76, s76, 147456
    buffer_load_dwordx4 v[160:163], v3, s[60:63], s76 offen
    s_add_u32 s76, s76, 147456
    buffer_load_dwordx4 v[164:167], v3, s[60:63], s76 offen
    s_add_u32 s76, s76, 147456
    buffer_load_dwordx4 v[168:171], v3, s[60:63], s76 offen
    s_add_u32 s76, s76, 147456
    buffer_load_dwordx4 v[172:175], v3, s[60:63], s76 offen
    s_add_u32 s76, s76, 147456
    buffer_load_dwordx4 v[176:179], v3, s[60:63], s76 offen
    s_add_u32 s76, s76, 147456
    buffer_load_dwordx4 v[180:183], v3, s[60:63], s76 offen
    s_add_u32 s76, s76, 147456
    buffer_load_dwordx4 v[184:187], v3, s[60:63], s76 offen
    s_add_u32 s76, s76, 147456
KM_notask0:
    s_mul_i32 s31, s30, 14
    s_cmp_eq_u32 s30, 3
    s_cselect_b32 s31, 41, s31
    s_lshl_b32 s33, s28, 2
    s_mul_i32 s33, s33, 54
    s_add_u32 s33, s33, s31
    s_lshl_b32 s33, s33, 10
    v_add_u32 v4, s33, v2
    v_add_u32 v5, 55296, v4
    v_add_u32 v6, 110592, v4
    v_add_u32 v7, 165888, v4
    s_mul_i32 s33, s29, 54
    s_add_u32 s33, s33, s31
    s_mul_i32 s33, s33, 5120
    v_add_u32 v8, s33, v2
    v_add_u32 v9, 4096, v8
    s_mov_b32 s34, 0
    s_mov_b32 s35, 0
    buffer_load_dwordx4 v[32:35], v8, s[16:19], s35 offen offset:0
    buffer_load_dwordx4 v[36:39], v8, s[16:19], s35 offen offset:1024
    buffer_load_dwordx4 v[40:43], v8, s[16:19], s35 offen offset:2048
    buffer_load_dwordx4 v[44:47], v8, s[16:19], s35 offen offset:3072
    buffer_load_dwordx4 v[48:51], v9, s[16:19], s35 offen
    buffer_load_dwordx4 v[16:19], v4, s[12:15], s34 offen
    buffer_load_dwordx4 v[20:23], v5, s[12:15], s34 offen
    buffer_load_dwordx4 v[24:27], v6, s[12:15], s34 offen
    buffer_load_dwordx4 v[28:31], v7, s[12:15], s34 offen
    s_mov_b32 s34, 1024
    s_mov_b32 s35, 5120
    buffer_load_dwordx4 v[68:71], v8, s[16:19], s35 offen offset:0
    buffer_load_dwordx4 v[72:75], v8, s[16:19], s35 offen offset:1024
    buffer_load_dwordx4 v[76:79], v8, s[16:19], s35 offen offset:2048
    buffer_load_dwordx4 v[80:83], v8, s[16:19], s35 offen offset:3072
    buffer_load_dwordx4 v[84:87], v9, s[16:19], s35 offen
    buffer_load_dwordx4 v[52:55], v4, s[12:15], s34 offen
    buffer_load_dwordx4 v[56:59], v5, s[12:15], s34 offen
    buffer_load_dwordx4 v[60:63], v6, s[12:15], s34 offen
    buffer_load_dwordx4 v[64:67], v7, s[12:15], s34 offen
    s_mov_b32 s34, 2048
    s_mov_b32 s35, 10240
    buffer_load_dwordx4 v[104:107], v8, s[16:19], s35 offen offset:0
    buffer_load_dwordx4 v[108:111], v8, s[16:19], s35 offen offset:1024
    buffer_load_dwordx4 v[112:115], v8, s[16:19], s35 offen offset:2048
    buffer_load_dwordx4 v[116:119], v8, s[16:19], s35 offen offset:3072
    buffer_load_dwordx4 v[120:123], v9, s[16:19], s35 offen
    buffer_load_dwordx4 v[88:91], v4, s[12:15], s34 offen
    buffer_load_dwordx4 v[92:95], v5, s[12:15], s34 offen
    buffer_load_dwordx4 v[96:99], v6, s[12:15], s34 offen
    buffer_load_dwordx4 v[100:103], v7, s[12:15], s34 offen
    s_mul_i32 s33, s28, 80
    s_mul_i32 s34, s30, 5
    s_add_u32 s33, s33, s34
    s_lshl_b32 s33, s33, 10
    v_add_u32 v10, s33, v2
    v_add_u32 v11, 20480, v10
    v_add_u32 v12, 40960, v10
    v_add_u32 v13, 61440, v10
    s_mul_i32 s33, s29, 20
    s_add_u32 s33, s33, s34
    s_mul_i32 s33, s33, 5120
    v_add_u32 v14, s33, v2
    v_add_u32 v15, 4096, v14
    s_movk_i32 s40, 4096
    s_waitcnt vmcnt(18)
    v_mfma_f32_16x16x32_bf16 a[160:163], v[32:35], v[16:19], 0
    v_mfma_f32_16x16x32_bf16 a[180:183], v[32:35], v[20:23], 0
    v_mfma_f32_16x16x32_bf16 a[200:203], v[32:35], v[24:27], 0
    v_mfma_f32_16x16x32_bf16 a[220:223], v[32:35], v[28:31], 0
    v_mfma_f32_16x16x32_bf16 a[164:167], v[36:39], v[16:19], 0
    v_mfma_f32_16x16x32_bf16 a[184:187], v[36:39], v[20:23], 0
    v_mfma_f32_16x16x32_bf16 a[204:207], v[36:39], v[24:27], 0
    v_mfma_f32_16x16x32_bf16 a[224:227], v[36:39], v[28:31], 0
    v_mfma_f32_16x16x32_bf16 a[168:171], v[40:43], v[16:19], 0
    v_mfma_f32_16x16x32_bf16 a[188:191], v[40:43], v[20:23], 0
    v_mfma_f32_16x16x32_bf16 a[208:211], v[40:43], v[24:27], 0
    v_mfma_f32_16x16x32_bf16 a[228:231], v[40:43], v[28:31], 0
    v_mfma_f32_16x16x32_bf16 a[172:175], v[44:47], v[16:19], 0
    v_mfma_f32_16x16x32_bf16 a[192:195], v[44:47], v[20:23], 0
    v_mfma_f32_16x16x32_bf16 a[212:215], v[44:47], v[24:27], 0
    v_mfma_f32_16x16x32_bf16 a[232:235], v[44:47], v[28:31], 0
    v_mfma_f32_16x16x32_bf16 a[176:179], v[48:51], v[16:19], 0
    v_mfma_f32_16x16x32_bf16 a[196:199], v[48:51], v[20:23], 0
    v_mfma_f32_16x16x32_bf16 a[216:219], v[48:51], v[24:27], 0
    v_mfma_f32_16x16x32_bf16 a[236:239], v[48:51], v[28:31], 0
    s_cmp_ge_u32 s70, 212
    s_cbranch_scc1 KM_notask1
    s_cmp_ge_u32 s70, 208
    s_cbranch_scc1 KM_zero
    v_pk_add_f32 v[124:125], v[124:125], v[156:157]
    v_pk_add_f32 v[126:127], v[126:127], v[158:159]
    v_pk_add_f32 v[128:129], v[128:129], v[160:161]
    v_pk_add_f32 v[130:131], v[130:131], v[162:163]
    v_pk_add_f32 v[132:133], v[132:133], v[164:165]
    v_pk_add_f32 v[134:135], v[134:135], v[166:167]
    v_pk_add_f32 v[136:137], v[136:137], v[168:169]
    v_pk_add_f32 v[138:139], v[138:139], v[170:171]
    v_pk_add_f32 v[140:141], v[140:141], v[172:173]
    v_pk_add_f32 v[142:143], v[142:143], v[174:175]
    v_pk_add_f32 v[144:145], v[144:145], v[176:177]
    v_pk_add_f32 v[146:147], v[146:147], v[178:179]
    v_pk_add_f32 v[148:149], v[148:149], v[180:181]
    v_pk_add_f32 v[150:151], v[150:151], v[182:183]
    v_pk_add_f32 v[152:153], v[152:153], v[184:185]
    v_pk_add_f32 v[154:155], v[154:155], v[186:187]
    v_pk_add_f32 v[124:125], v[124:125], v[140:141]
    v_pk_add_f32 v[126:127], v[126:127], v[142:143]
    v_pk_add_f32 v[128:129], v[128:129], v[144:145]
    v_pk_add_f32 v[130:131], v[130:131], v[146:147]
    v_pk_add_f32 v[132:133], v[132:133], v[148:149]
    v_pk_add_f32 v[134:135], v[134:135], v[150:151]
    v_pk_add_f32 v[136:137], v[136:137], v[152:153]
    v_pk_add_f32 v[138:139], v[138:139], v[154:155]
    v_pk_add_f32 v[124:125], v[124:125], v[132:133]
    v_pk_add_f32 v[126:127], v[126:127], v[134:135]
    v_pk_add_f32 v[128:129], v[128:129], v[136:137]
    v_pk_add_f32 v[130:131], v[130:131], v[138:139]
    v_pk_add_f32 v[124:125], v[124:125], v[128:129]
    v_pk_add_f32 v[126:127], v[126:127], v[130:131]
    v_lshrrev_b32 v228, 4, v1
    v_lshlrev_b32 v228, 2, v228
    s_lshl_b32 s76, s75, 4
    v_add_u32 v228, s76, v228
    v_and_b32 v229, 15, v1
    s_lshl_b32 s76, s74, 4
    v_add_u32 v229, s76, v229
    v_mul_u32_u24 v228, 205, v228
    v_lshrrev_b32 v228, 12, v228
    v_mul_u32_u24 v229, 205, v229
    v_lshrrev_b32 v229, 12, v229
    v_cmp_eq_u32 s[78:79], v228, v229
    s_lshr_b32 s76, s72, 1
    s_and_b32 s77, s72, 1
    s_mul_i32 s77, s77, 5
    s_add_u32 s75, s77, s75
    s_add_u32 s74, s77, s74
    s_lshr_b32 s77, s75, 1
    s_and_b32 s75, s75, 1
    s_sub_u32 s73, s74, 1
    s_ashr_i32 s73, s73, 1
    s_lshl_b32 s74, s74, 1
    s_sub_u32 s74, s74, 1
    s_add_u32 s74, s74, s77
    s_sub_u32 s74, s74, s73
    s_mul_i32 s76, s76, 18
    s_add_u32 s74, s74, s76
    s_lshl_b32 s74, s74, 10
    s_lshl_b32 s75, s75, 3
    s_add_u32 s74, s74, s75
    s_mul_i32 s75, s71, 73728
    s_add_u32 s74, s74, s75
    v_cvt_pk_bf16_f32 v228, v124, v125
    v_cvt_pk_bf16_f32 v229, v126, v127
    v_add_u32 v230, s74, v2
    s_nop 0
    v_cndmask_b32 v228, 0, v228, s[78:79]
    v_cndmask_b32 v229, 0, v229, s[78:79]
    buffer_store_dwordx2 v[228:229], v230, s[20:23], 0 offen sc0 sc1
    s_branch KM_signal
KM_zero:
    s_sub_u32 s76, s70, 208
    s_mul_i32 s76, s76, 18432
    v_add_u32 v230, s76, v2
    v_mov_b32 v228, 0
    v_mov_b32 v229, 0
    s_mov_b32 s76, 73728
    v_add_u32 v231, 2056, v230
    buffer_store_dwordx2 v[228:229], v231, s[20:23], 0 offen sc0 sc1
    buffer_store_dwordx2 v[228:229], v231, s[20:23], s76 offen sc0 sc1
    v_add_u32 v231, 3072, v230
    buffer_store_dwordx2 v[228:229], v231, s[20:23], 0 offen sc0 sc1
    buffer_store_dwordx2 v[228:229], v231, s[20:23], s76 offen sc0 sc1
    v_add_u32 v231, 6152, v230
    buffer_store_dwordx2 v[228:229], v231, s[20:23], 0 offen sc0 sc1
    buffer_store_dwordx2 v[228:229], v231, s[20:23], s76 offen sc0 sc1
    v_add_u32 v231, 7168, v230
    buffer_store_dwordx2 v[228:229], v231, s[20:23], 0 offen sc0 sc1
    buffer_store_dwordx2 v[228:229], v231, s[20:23], s76 offen sc0 sc1
    v_add_u32 v231, 8200, v230
    buffer_store_dwordx2 v[228:229], v231, s[20:23], 0 offen sc0 sc1
    buffer_store_dwordx2 v[228:229], v231, s[20:23], s76 offen sc0 sc1
    v_add_u32 v231, 9216, v230
    buffer_store_dwordx2 v[228:229], v231, s[20:23], 0 offen sc0 sc1
    buffer_store_dwordx2 v[228:229], v231, s[20:23], s76 offen sc0 sc1
    v_add_u32 v231, 10248, v230
    buffer_store_dwordx2 v[228:229], v231, s[20:23], 0 offen sc0 sc1
    buffer_store_dwordx2 v[228:229], v231, s[20:23], s76 offen sc0 sc1
    v_add_u32 v231, 11264, v230
    buffer_store_dwordx2 v[228:229], v231, s[20:23], 0 offen sc0 sc1
    buffer_store_dwordx2 v[228:229], v231, s[20:23], s76 offen sc0 sc1
    v_add_u32 v231, 14344, v230
    buffer_store_dwordx2 v[228:229], v231, s[20:23], 0 offen sc0 sc1
    buffer_store_dwordx2 v[228:229], v231, s[20:23], s76 offen sc0 sc1
    v_add_u32 v231, 15360, v230
    buffer_store_dwordx2 v[228:229], v231, s[20:23], 0 offen sc0 sc1
    buffer_store_dwordx2 v[228:229], v231, s[20:23], s76 offen sc0 sc1
KM_signal:
KM_notask1:
    s_mov_b32 s34, 3072
    s_mov_b32 s35, 15360
    buffer_load_dwordx4 v[32:35], v8, s[16:19], s35 offen offset:0
    buffer_load_dwordx4 v[36:39], v8, s[16:19], s35 offen offset:1024
    buffer_load_dwordx4 v[40:43], v8, s[16:19], s35 offen offset:2048
    buffer_load_dwordx4 v[44:47], v8, s[16:19], s35 offen offset:3072
    buffer_load_dwordx4 v[48:51], v9, s[16:19], s35 offen
    buffer_load_dwordx4 v[16:19], v4, s[12:15], s34 offen
    buffer_load_dwordx4 v[20:23], v5, s[12:15], s34 offen
    buffer_load_dwordx4 v[24:27], v6, s[12:15], s34 offen
    buffer_load_dwordx4 v[28:31], v7, s[12:15], s34 offen
    s_waitcnt vmcnt(18)
    v_mfma_f32_16x16x32_bf16 a[160:163], v[68:71], v[52:55], a[160:163]
    v_mfma_f32_16x16x32_bf16 a[180:183], v[68:71], v[56:59], a[180:183]
    v_mfma_f32_16x16x32_bf16 a[200:203], v[68:71], v[60:63], a[200:203]
    v_mfma_f32_16x16x32_bf16 a[220:223], v[68:71], v[64:67], a[220:223]
    v_mfma_f32_16x16x32_bf16 a[164:167], v[72:75], v[52:55], a[164:167]
    v_mfma_f32_16x16x32_bf16 a[184:187], v[72:75], v[56:59], a[184:187]
    v_mfma_f32_16x16x32_bf16 a[204:207], v[72:75], v[60:63], a[204:207]
    v_mfma_f32_16x16x32_bf16 a[224:227], v[72:75], v[64:67], a[224:227]
    v_mfma_f32_16x16x32_bf16 a[168:171], v[76:79], v[52:55], a[168:171]
    v_mfma_f32_16x16x32_bf16 a[188:191], v[76:79], v[56:59], a[188:191]
    v_mfma_f32_16x16x32_bf16 a[208:211], v[76:79], v[60:63], a[208:211]
    v_mfma_f32_16x16x32_bf16 a[228:231], v[76:79], v[64:67], a[228:231]
    v_mfma_f32_16x16x32_bf16 a[172:175], v[80:83], v[52:55], a[172:175]
    v_mfma_f32_16x16x32_bf16 a[192:195], v[80:83], v[56:59], a[192:195]
    v_mfma_f32_16x16x32_bf16 a[212:215], v[80:83], v[60:63], a[212:215]
    v_mfma_f32_16x16x32_bf16 a[232:235], v[80:83], v[64:67], a[232:235]
    v_mfma_f32_16x16x32_bf16 a[176:179], v[84:87], v[52:55], a[176:179]
    v_mfma_f32_16x16x32_bf16 a[196:199], v[84:87], v[56:59], a[196:199]
    v_mfma_f32_16x16x32_bf16 a[216:219], v[84:87], v[60:63], a[216:219]
    v_mfma_f32_16x16x32_bf16 a[236:239], v[84:87], v[64:67], a[236:239]
    s_mov_b32 s34, 4096
    s_mov_b32 s35, 20480
    buffer_load_dwordx4 v[68:71], v8, s[16:19], s35 offen offset:0
    buffer_load_dwordx4 v[72:75], v8, s[16:19], s35 offen offset:1024
    buffer_load_dwordx4 v[76:79], v8, s[16:19], s35 offen offset:2048
    buffer_load_dwordx4 v[80:83], v8, s[16:19], s35 offen offset:3072
    buffer_load_dwordx4 v[84:87], v9, s[16:19], s35 offen
    buffer_load_dwordx4 v[52:55], v4, s[12:15], s34 offen
    buffer_load_dwordx4 v[56:59], v5, s[12:15], s34 offen
    buffer_load_dwordx4 v[60:63], v6, s[12:15], s34 offen
    buffer_load_dwordx4 v[64:67], v7, s[12:15], s34 offen
    s_waitcnt vmcnt(18)
    v_mfma_f32_16x16x32_bf16 a[160:163], v[104:107], v[88:91], a[160:163]
    v_mfma_f32_16x16x32_bf16 a[180:183], v[104:107], v[92:95], a[180:183]
    v_mfma_f32_16x16x32_bf16 a[200:203], v[104:107], v[96:99], a[200:203]
    v_mfma_f32_16x16x32_bf16 a[220:223], v[104:107], v[100:103], a[220:223]
    v_mfma_f32_16x16x32_bf16 a[164:167], v[108:111], v[88:91], a[164:167]
    v_mfma_f32_16x16x32_bf16 a[184:187], v[108:111], v[92:95], a[184:187]
    v_mfma_f32_16x16x32_bf16 a[204:207], v[108:111], v[96:99], a[204:207]
    v_mfma_f32_16x16x32_bf16 a[224:227], v[108:111], v[100:103], a[224:227]
    v_mfma_f32_16x16x32_bf16 a[168:171], v[112:115], v[88:91], a[168:171]
    v_mfma_f32_16x16x32_bf16 a[188:191], v[112:115], v[92:95], a[188:191]
    v_mfma_f32_16x16x32_bf16 a[208:211], v[112:115], v[96:99], a[208:211]
    v_mfma_f32_16x16x32_bf16 a[228:231], v[112:115], v[100:103], a[228:231]
    v_mfma_f32_16x16x32_bf16 a[172:175], v[116:119], v[88:91], a[172:175]
    v_mfma_f32_16x16x32_bf16 a[192:195], v[116:119], v[92:95], a[192:195]
    v_mfma_f32_16x16x32_bf16 a[212:215], v[116:119], v[96:99], a[212:215]
    v_mfma_f32_16x16x32_bf16 a[232:235], v[116:119], v[100:103], a[232:235]
    v_mfma_f32_16x16x32_bf16 a[176:179], v[120:123], v[88:91], a[176:179]
    v_mfma_f32_16x16x32_bf16 a[196:199], v[120:123], v[92:95], a[196:199]
    v_mfma_f32_16x16x32_bf16 a[216:219], v[120:123], v[96:99], a[216:219]
    v_mfma_f32_16x16x32_bf16 a[236:239], v[120:123], v[100:103], a[236:239]
    s_mov_b32 s34, 5120
    s_mov_b32 s35, 25600
    buffer_load_dwordx4 v[104:107], v8, s[16:19], s35 offen offset:0
    buffer_load_dwordx4 v[108:111], v8, s[16:19], s35 offen offset:1024
    buffer_load_dwordx4 v[112:115], v8, s[16:19], s35 offen offset:2048
    buffer_load_dwordx4 v[116:119], v8, s[16:19], s35 offen offset:3072
    buffer_load_dwordx4 v[120:123], v9, s[16:19], s35 offen
    buffer_load_dwordx4 v[88:91], v4, s[12:15], s34 offen
    buffer_load_dwordx4 v[92:95], v5, s[12:15], s34 offen
    buffer_load_dwordx4 v[96:99], v6, s[12:15], s34 offen
    buffer_load_dwordx4 v[100:103], v7, s[12:15], s34 offen
    s_waitcnt vmcnt(18)
    s_cmp_ge_u32 s70, 212
    s_cbranch_scc1 KM_nosig
    v_mov_b32 v228, 1
    v_mov_b32 v229, 0
    s_mov_b64 exec, 1
    buffer_atomic_add v228, v229, s[64:67], 0 offen sc1
    s_mov_b64 exec, -1
KM_nosig:
    v_mfma_f32_16x16x32_bf16 a[160:163], v[32:35], v[16:19], a[160:163]
    v_mfma_f32_16x16x32_bf16 a[180:183], v[32:35], v[20:23], a[180:183]
    v_mfma_f32_16x16x32_bf16 a[200:203], v[32:35], v[24:27], a[200:203]
    v_mfma_f32_16x16x32_bf16 a[220:223], v[32:35], v[28:31], a[220:223]
    v_mfma_f32_16x16x32_bf16 a[164:167], v[36:39], v[16:19], a[164:167]
    v_mfma_f32_16x16x32_bf16 a[184:187], v[36:39], v[20:23], a[184:187]
    v_mfma_f32_16x16x32_bf16 a[204:207], v[36:39], v[24:27], a[204:207]
    v_mfma_f32_16x16x32_bf16 a[224:227], v[36:39], v[28:31], a[224:227]
    v_mfma_f32_16x16x32_bf16 a[168:171], v[40:43], v[16:19], a[168:171]
    v_mfma_f32_16x16x32_bf16 a[188:191], v[40:43], v[20:23], a[188:191]
    v_mfma_f32_16x16x32_bf16 a[208:211], v[40:43], v[24:27], a[208:211]
    v_mfma_f32_16x16x32_bf16 a[228:231], v[40:43], v[28:31], a[228:231]
    v_mfma_f32_16x16x32_bf16 a[172:175], v[44:47], v[16:19], a[172:175]
    v_mfma_f32_16x16x32_bf16 a[192:195], v[44:47], v[20:23], a[192:195]
    v_mfma_f32_16x16x32_bf16 a[212:215], v[44:47], v[24:27], a[212:215]
    v_mfma_f32_16x16x32_bf16 a[232:235], v[44:47], v[28:31], a[232:235]
    v_mfma_f32_16x16x32_bf16 a[176:179], v[48:51], v[16:19], a[176:179]
    v_mfma_f32_16x16x32_bf16 a[196:199], v[48:51], v[20:23], a[196:199]
    v_mfma_f32_16x16x32_bf16 a[216:219], v[48:51], v[24:27], a[216:219]
    v_mfma_f32_16x16x32_bf16 a[236:239], v[48:51], v[28:31], a[236:239]
    s_mov_b32 s34, 6144
    s_mov_b32 s35, 30720
    buffer_load_dwordx4 v[32:35], v8, s[16:19], s35 offen offset:0
    buffer_load_dwordx4 v[36:39], v8, s[16:19], s35 offen offset:1024
    buffer_load_dwordx4 v[40:43], v8, s[16:19], s35 offen offset:2048
    buffer_load_dwordx4 v[44:47], v8, s[16:19], s35 offen offset:3072
    buffer_load_dwordx4 v[48:51], v9, s[16:19], s35 offen
    buffer_load_dwordx4 v[16:19], v4, s[12:15], s34 offen
    buffer_load_dwordx4 v[20:23], v5, s[12:15], s34 offen
    buffer_load_dwordx4 v[24:27], v6, s[12:15], s34 offen
    buffer_load_dwordx4 v[28:31], v7, s[12:15], s34 offen
    s_waitcnt vmcnt(18)
    v_mfma_f32_16x16x32_bf16 a[160:163], v[68:71], v[52:55], a[160:163]
    v_mfma_f32_16x16x32_bf16 a[180:183], v[68:71], v[56:59], a[180:183]
    v_mfma_f32_16x16x32_bf16 a[200:203], v[68:71], v[60:63], a[200:203]
    v_mfma_f32_16x16x32_bf16 a[220:223], v[68:71], v[64:67], a[220:223]
    v_mfma_f32_16x16x32_bf16 a[164:167], v[72:75], v[52:55], a[164:167]
    v_mfma_f32_16x16x32_bf16 a[184:187], v[72:75], v[56:59], a[184:187]
    v_mfma_f32_16x16x32_bf16 a[204:207], v[72:75], v[60:63], a[204:207]
    v_mfma_f32_16x16x32_bf16 a[224:227], v[72:75], v[64:67], a[224:227]
    v_mfma_f32_16x16x32_bf16 a[168:171], v[76:79], v[52:55], a[168:171]
    v_mfma_f32_16x16x32_bf16 a[188:191], v[76:79], v[56:59], a[188:191]
    v_mfma_f32_16x16x32_bf16 a[208:211], v[76:79], v[60:63], a[208:211]
    v_mfma_f32_16x16x32_bf16 a[228:231], v[76:79], v[64:67], a[228:231]
    v_mfma_f32_16x16x32_bf16 a[172:175], v[80:83], v[52:55], a[172:175]
    v_mfma_f32_16x16x32_bf16 a[192:195], v[80:83], v[56:59], a[192:195]
    v_mfma_f32_16x16x32_bf16 a[212:215], v[80:83], v[60:63], a[212:215]
    v_mfma_f32_16x16x32_bf16 a[232:235], v[80:83], v[64:67], a[232:235]
    v_mfma_f32_16x16x32_bf16 a[176:179], v[84:87], v[52:55], a[176:179]
    v_mfma_f32_16x16x32_bf16 a[196:199], v[84:87], v[56:59], a[196:199]
    v_mfma_f32_16x16x32_bf16 a[216:219], v[84:87], v[60:63], a[216:219]
    v_mfma_f32_16x16x32_bf16 a[236:239], v[84:87], v[64:67], a[236:239]
    s_mov_b32 s34, 7168
    s_mov_b32 s35, 35840
    buffer_load_dwordx4 v[68:71], v8, s[16:19], s35 offen offset:0
    buffer_load_dwordx4 v[72:75], v8, s[16:19], s35 offen offset:1024
    buffer_load_dwordx4 v[76:79], v8, s[16:19], s35 offen offset:2048
    buffer_load_dwordx4 v[80:83], v8, s[16:19], s35 offen offset:3072
    buffer_load_dwordx4 v[84:87], v9, s[16:19], s35 offen
    buffer_load_dwordx4 v[52:55], v4, s[12:15], s34 offen
    buffer_load_dwordx4 v[56:59], v5, s[12:15], s34 offen
    buffer_load_dwordx4 v[60:63], v6, s[12:15], s34 offen
    buffer_load_dwordx4 v[64:67], v7, s[12:15], s34 offen
    buffer_load_dwordx4 a[80:83], v10, s[52:55], 0 offen offset:0
    buffer_load_dwordx4 a[100:103], v11, s[52:55], 0 offen offset:0
    buffer_load_dwordx4 a[120:123], v12, s[52:55], 0 offen offset:0
    buffer_load_dwordx4 a[140:143], v13, s[52:55], 0 offen offset:0
    s_waitcnt vmcnt(22)
    v_mfma_f32_16x16x32_bf16 a[160:163], v[104:107], v[88:91], a[160:163]
    v_mfma_f32_16x16x32_bf16 a[180:183], v[104:107], v[92:95], a[180:183]
    v_mfma_f32_16x16x32_bf16 a[200:203], v[104:107], v[96:99], a[200:203]
    v_mfma_f32_16x16x32_bf16 a[220:223], v[104:107], v[100:103], a[220:223]
    v_mfma_f32_16x16x32_bf16 a[164:167], v[108:111], v[88:91], a[164:167]
    v_mfma_f32_16x16x32_bf16 a[184:187], v[108:111], v[92:95], a[184:187]
    v_mfma_f32_16x16x32_bf16 a[204:207], v[108:111], v[96:99], a[204:207]
    v_mfma_f32_16x16x32_bf16 a[224:227], v[108:111], v[100:103], a[224:227]
    v_mfma_f32_16x16x32_bf16 a[168:171], v[112:115], v[88:91], a[168:171]
    v_mfma_f32_16x16x32_bf16 a[188:191], v[112:115], v[92:95], a[188:191]
    v_mfma_f32_16x16x32_bf16 a[208:211], v[112:115], v[96:99], a[208:211]
    v_mfma_f32_16x16x32_bf16 a[228:231], v[112:115], v[100:103], a[228:231]
    v_mfma_f32_16x16x32_bf16 a[172:175], v[116:119], v[88:91], a[172:175]
    v_mfma_f32_16x16x32_bf16 a[192:195], v[116:119], v[92:95], a[192:195]
    v_mfma_f32_16x16x32_bf16 a[212:215], v[116:119], v[96:99], a[212:215]
    v_mfma_f32_16x16x32_bf16 a[232:235], v[116:119], v[100:103], a[232:235]
    v_mfma_f32_16x16x32_bf16 a[176:179], v[120:123], v[88:91], a[176:179]
    v_mfma_f32_16x16x32_bf16 a[196:199], v[120:123], v[92:95], a[196:199]
    v_mfma_f32_16x16x32_bf16 a[216:219], v[120:123], v[96:99], a[216:219]
    v_mfma_f32_16x16x32_bf16 a[236:239], v[120:123], v[100:103], a[236:239]
    s_mov_b32 s34, 8192
    s_mov_b32 s35, 40960
    buffer_load_dwordx4 v[104:107], v8, s[16:19], s35 offen offset:0
    buffer_load_dwordx4 v[108:111], v8, s[16:19], s35 offen offset:1024
    buffer_load_dwordx4 v[112:115], v8, s[16:19], s35 offen offset:2048
    buffer_load_dwordx4 v[116:119], v8, s[16:19], s35 offen offset:3072
    buffer_load_dwordx4 v[120:123], v9, s[16:19], s35 offen
    buffer_load_dwordx4 v[88:91], v4, s[12:15], s34 offen
    buffer_load_dwordx4 v[92:95], v5, s[12:15], s34 offen
    buffer_load_dwordx4 v[96:99], v6, s[12:15], s34 offen
    buffer_load_dwordx4 v[100:103], v7, s[12:15], s34 offen
    buffer_load_dwordx4 a[84:87], v10, s[52:55], 0 offen offset:1024
    buffer_load_dwordx4 a[104:107], v11, s[52:55], 0 offen offset:1024
    buffer_load_dwordx4 a[124:127], v12, s[52:55], 0 offen offset:1024
    buffer_load_dwordx4 a[144:147], v13, s[52:55], 0 offen offset:1024
    s_waitcnt vmcnt(26)
    v_mfma_f32_16x16x32_bf16 a[160:163], v[32:35], v[16:19], a[160:163]
    v_mfma_f32_16x16x32_bf16 a[180:183], v[32:35], v[20:23], a[180:183]
    v_mfma_f32_16x16x32_bf16 a[200:203], v[32:35], v[24:27], a[200:203]
    v_mfma_f32_16x16x32_bf16 a[220:223], v[32:35], v[28:31], a[220:223]
    v_mfma_f32_16x16x32_bf16 a[164:167], v[36:39], v[16:19], a[164:167]
    v_mfma_f32_16x16x32_bf16 a[184:187], v[36:39], v[20:23], a[184:187]
    v_mfma_f32_16x16x32_bf16 a[204:207], v[36:39], v[24:27], a[204:207]
    v_mfma_f32_16x16x32_bf16 a[224:227], v[36:39], v[28:31], a[224:227]
    v_mfma_f32_16x16x32_bf16 a[168:171], v[40:43], v[16:19], a[168:171]
    v_mfma_f32_16x16x32_bf16 a[188:191], v[40:43], v[20:23], a[188:191]
    v_mfma_f32_16x16x32_bf16 a[208:211], v[40:43], v[24:27], a[208:211]
    v_mfma_f32_16x16x32_bf16 a[228:231], v[40:43], v[28:31], a[228:231]
    v_mfma_f32_16x16x32_bf16 a[172:175], v[44:47], v[16:19], a[172:175]
    v_mfma_f32_16x16x32_bf16 a[192:195], v[44:47], v[20:23], a[192:195]
    v_mfma_f32_16x16x32_bf16 a[212:215], v[44:47], v[24:27], a[212:215]
    v_mfma_f32_16x16x32_bf16 a[232:235], v[44:47], v[28:31], a[232:235]
    v_mfma_f32_16x16x32_bf16 a[176:179], v[48:51], v[16:19], a[176:179]
    v_mfma_f32_16x16x32_bf16 a[196:199], v[48:51], v[20:23], a[196:199]
    v_mfma_f32_16x16x32_bf16 a[216:219], v[48:51], v[24:27], a[216:219]
    v_mfma_f32_16x16x32_bf16 a[236:239], v[48:51], v[28:31], a[236:239]
    s_mov_b32 s34, 9216
    s_mov_b32 s35, 46080
    buffer_load_dwordx4 v[32:35], v8, s[16:19], s35 offen offset:0
    buffer_load_dwordx4 v[36:39], v8, s[16:19], s35 offen offset:1024
    buffer_load_dwordx4 v[40:43], v8, s[16:19], s35 offen offset:2048
    buffer_load_dwordx4 v[44:47], v8, s[16:19], s35 offen offset:3072
    buffer_load_dwordx4 v[48:51], v9, s[16:19], s35 offen
    buffer_load_dwordx4 v[16:19], v4, s[12:15], s34 offen
    buffer_load_dwordx4 v[20:23], v5, s[12:15], s34 offen
    buffer_load_dwordx4 v[24:27], v6, s[12:15], s34 offen
    buffer_load_dwordx4 v[28:31], v7, s[12:15], s34 offen
    buffer_load_dwordx4 a[88:91], v10, s[52:55], 0 offen offset:2048
    buffer_load_dwordx4 a[108:111], v11, s[52:55], 0 offen offset:2048
    buffer_load_dwordx4 a[128:131], v12, s[52:55], 0 offen offset:2048
    buffer_load_dwordx4 a[148:151], v13, s[52:55], 0 offen offset:2048
    s_waitcnt vmcnt(30)
    v_mfma_f32_16x16x32_bf16 a[160:163], v[68:71], v[52:55], a[160:163]
    v_mfma_f32_16x16x32_bf16 a[180:183], v[68:71], v[56:59], a[180:183]
    v_mfma_f32_16x16x32_bf16 a[200:203], v[68:71], v[60:63], a[200:203]
    v_mfma_f32_16x16x32_bf16 a[220:223], v[68:71], v[64:67], a[220:223]
    v_mfma_f32_16x16x32_bf16 a[164:167], v[72:75], v[52:55], a[164:167]
    v_mfma_f32_16x16x32_bf16 a[184:187], v[72:75], v[56:59], a[184:187]
    v_mfma_f32_16x16x32_bf16 a[204:207], v[72:75], v[60:63], a[204:207]
    v_mfma_f32_16x16x32_bf16 a[224:227], v[72:75], v[64:67], a[224:227]
    v_mfma_f32_16x16x32_bf16 a[168:171], v[76:79], v[52:55], a[168:171]
    v_mfma_f32_16x16x32_bf16 a[188:191], v[76:79], v[56:59], a[188:191]
    v_mfma_f32_16x16x32_bf16 a[208:211], v[76:79], v[60:63], a[208:211]
    v_mfma_f32_16x16x32_bf16 a[228:231], v[76:79], v[64:67], a[228:231]
    v_mfma_f32_16x16x32_bf16 a[172:175], v[80:83], v[52:55], a[172:175]
    v_mfma_f32_16x16x32_bf16 a[192:195], v[80:83], v[56:59], a[192:195]
    v_mfma_f32_16x16x32_bf16 a[212:215], v[80:83], v[60:63], a[212:215]
    v_mfma_f32_16x16x32_bf16 a[232:235], v[80:83], v[64:67], a[232:235]
    v_mfma_f32_16x16x32_bf16 a[176:179], v[84:87], v[52:55], a[176:179]
    v_mfma_f32_16x16x32_bf16 a[196:199], v[84:87], v[56:59], a[196:199]
    v_mfma_f32_16x16x32_bf16 a[216:219], v[84:87], v[60:63], a[216:219]
    v_mfma_f32_16x16x32_bf16 a[236:239], v[84:87], v[64:67], a[236:239]
    s_mov_b32 s34, 10240
    s_mov_b32 s35, 51200
    buffer_load_dwordx4 v[68:71], v8, s[16:19], s35 offen offset:0
    buffer_load_dwordx4 v[72:75], v8, s[16:19], s35 offen offset:1024
    buffer_load_dwordx4 v[76:79], v8, s[16:19], s35 offen offset:2048
    buffer_load_dwordx4 v[80:83], v8, s[16:19], s35 offen offset:3072
    buffer_load_dwordx4 v[84:87], v9, s[16:19], s35 offen
    buffer_load_dwordx4 v[52:55], v4, s[12:15], s34 offen
    buffer_load_dwordx4 v[56:59], v5, s[12:15], s34 offen
    buffer_load_dwordx4 v[60:63], v6, s[12:15], s34 offen
    buffer_load_dwordx4 v[64:67], v7, s[12:15], s34 offen
    buffer_load_dwordx4 a[92:95], v10, s[52:55], 0 offen offset:3072
    buffer_load_dwordx4 a[112:115], v11, s[52:55], 0 offen offset:3072
    buffer_load_dwordx4 a[132:135], v12, s[52:55], 0 offen offset:3072
    buffer_load_dwordx4 a[152:155], v13, s[52:55], 0 offen offset:3072
    s_waitcnt vmcnt(30)
    v_mfma_f32_16x16x32_bf16 a[160:163], v[104:107], v[88:91], a[160:163]
    v_mfma_f32_16x16x32_bf16 a[180:183], v[104:107], v[92:95], a[180:183]
    v_mfma_f32_16x16x32_bf16 a[200:203], v[104:107], v[96:99], a[200:203]
    v_mfma_f32_16x16x32_bf16 a[220:223], v[104:107], v[100:103], a[220:223]
    v_mfma_f32_16x16x32_bf16 a[164:167], v[108:111], v[88:91], a[164:167]
    v_mfma_f32_16x16x32_bf16 a[184:187], v[108:111], v[92:95], a[184:187]
    v_mfma_f32_16x16x32_bf16 a[204:207], v[108:111], v[96:99], a[204:207]
    v_mfma_f32_16x16x32_bf16 a[224:227], v[108:111], v[100:103], a[224:227]
    v_mfma_f32_16x16x32_bf16 a[168:171], v[112:115], v[88:91], a[168:171]
    v_mfma_f32_16x16x32_bf16 a[188:191], v[112:115], v[92:95], a[188:191]
    v_mfma_f32_16x16x32_bf16 a[208:211], v[112:115], v[96:99], a[208:211]
    v_mfma_f32_16x16x32_bf16 a[228:231], v[112:115], v[100:103], a[228:231]
    v_mfma_f32_16x16x32_bf16 a[172:175], v[116:119], v[88:91], a[172:175]
    v_mfma_f32_16x16x32_bf16 a[192:195], v[116:119], v[92:95], a[192:195]
    v_mfma_f32_16x16x32_bf16 a[212:215], v[116:119], v[96:99], a[212:215]
    v_mfma_f32_16x16x32_bf16 a[232:235], v[116:119], v[100:103], a[232:235]
    v_mfma_f32_16x16x32_bf16 a[176:179], v[120:123], v[88:91], a[176:179]
    v_mfma_f32_16x16x32_bf16 a[196:199], v[120:123], v[92:95], a[196:199]
    v_mfma_f32_16x16x32_bf16 a[216:219], v[120:123], v[96:99], a[216:219]
    v_mfma_f32_16x16x32_bf16 a[236:239], v[120:123], v[100:103], a[236:239]
    s_mov_b32 s34, 11264
    s_mov_b32 s35, 56320
    buffer_load_dwordx4 v[104:107], v8, s[16:19], s35 offen offset:0
    buffer_load_dwordx4 v[108:111], v8, s[16:19], s35 offen offset:1024
    buffer_load_dwordx4 v[112:115], v8, s[16:19], s35 offen offset:2048
    buffer_load_dwordx4 v[116:119], v8, s[16:19], s35 offen offset:3072
    buffer_load_dwordx4 v[120:123], v9, s[16:19], s35 offen
    buffer_load_dwordx4 v[88:91], v4, s[12:15], s34 offen
    buffer_load_dwordx4 v[92:95], v5, s[12:15], s34 offen
    buffer_load_dwordx4 v[96:99], v6, s[12:15], s34 offen
    buffer_load_dwordx4 v[100:103], v7, s[12:15], s34 offen
    buffer_load_dwordx4 a[96:99], v10, s[52:55], s40 offen
    buffer_load_dwordx4 a[116:119], v11, s[52:55], s40 offen
    buffer_load_dwordx4 a[136:139], v12, s[52:55], s40 offen
    buffer_load_dwordx4 a[156:159], v13, s[52:55], s40 offen
    s_waitcnt vmcnt(30)
    v_mfma_f32_16x16x32_bf16 a[160:163], v[32:35], v[16:19], a[160:163]
    v_mfma_f32_16x16x32_bf16 a[180:183], v[32:35], v[20:23], a[180:183]
    v_mfma_f32_16x16x32_bf16 a[200:203], v[32:35], v[24:27], a[200:203]
    v_mfma_f32_16x16x32_bf16 a[220:223], v[32:35], v[28:31], a[220:223]
    v_mfma_f32_16x16x32_bf16 a[164:167], v[36:39], v[16:19], a[164:167]
    v_mfma_f32_16x16x32_bf16 a[184:187], v[36:39], v[20:23], a[184:187]
    v_mfma_f32_16x16x32_bf16 a[204:207], v[36:39], v[24:27], a[204:207]
    v_mfma_f32_16x16x32_bf16 a[224:227], v[36:39], v[28:31], a[224:227]
    v_mfma_f32_16x16x32_bf16 a[168:171], v[40:43], v[16:19], a[168:171]
    v_mfma_f32_16x16x32_bf16 a[188:191], v[40:43], v[20:23], a[188:191]
    v_mfma_f32_16x16x32_bf16 a[208:211], v[40:43], v[24:27], a[208:211]
    v_mfma_f32_16x16x32_bf16 a[228:231], v[40:43], v[28:31], a[228:231]
    v_mfma_f32_16x16x32_bf16 a[172:175], v[44:47], v[16:19], a[172:175]
    v_mfma_f32_16x16x32_bf16 a[192:195], v[44:47], v[20:23], a[192:195]
    v_mfma_f32_16x16x32_bf16 a[212:215], v[44:47], v[24:27], a[212:215]
    v_mfma_f32_16x16x32_bf16 a[232:235], v[44:47], v[28:31], a[232:235]
    v_mfma_f32_16x16x32_bf16 a[176:179], v[48:51], v[16:19], a[176:179]
    v_mfma_f32_16x16x32_bf16 a[196:199], v[48:51], v[20:23], a[196:199]
    v_mfma_f32_16x16x32_bf16 a[216:219], v[48:51], v[24:27], a[216:219]
    v_mfma_f32_16x16x32_bf16 a[236:239], v[48:51], v[28:31], a[236:239]
    s_mov_b32 s34, 12288
    s_mov_b32 s35, 61440
    buffer_load_dwordx4 v[32:35], v8, s[16:19], s35 offen offset:0
    buffer_load_dwordx4 v[36:39], v8, s[16:19], s35 offen offset:1024
    buffer_load_dwordx4 v[40:43], v8, s[16:19], s35 offen offset:2048
    buffer_load_dwordx4 v[44:47], v8, s[16:19], s35 offen offset:3072
    buffer_load_dwordx4 v[48:51], v9, s[16:19], s35 offen
    buffer_load_dwordx4 v[16:19], v4, s[12:15], s34 offen
    buffer_load_dwordx4 v[20:23], v5, s[12:15], s34 offen
    buffer_load_dwordx4 v[24:27], v6, s[12:15], s34 offen
    buffer_load_dwordx4 v[28:31], v7, s[12:15], s34 offen
    s_mov_b32 s35, 0
    buffer_load_dwordx4 v[188:191], v14, s[56:59], s35 offen offset:0
    buffer_load_dwordx4 v[192:195], v14, s[56:59], s35 offen offset:1024
    buffer_load_dwordx4 v[196:199], v14, s[56:59], s35 offen offset:2048
    buffer_load_dwordx4 v[200:203], v14, s[56:59], s35 offen offset:3072
    buffer_load_dwordx4 v[204:207], v15, s[56:59], s35 offen
    s_waitcnt vmcnt(31)
    v_mfma_f32_16x16x32_bf16 a[160:163], v[68:71], v[52:55], a[160:163]
    v_mfma_f32_16x16x32_bf16 a[180:183], v[68:71], v[56:59], a[180:183]
    v_mfma_f32_16x16x32_bf16 a[200:203], v[68:71], v[60:63], a[200:203]
    v_mfma_f32_16x16x32_bf16 a[220:223], v[68:71], v[64:67], a[220:223]
    v_mfma_f32_16x16x32_bf16 a[164:167], v[72:75], v[52:55], a[164:167]
    v_mfma_f32_16x16x32_bf16 a[184:187], v[72:75], v[56:59], a[184:187]
    v_mfma_f32_16x16x32_bf16 a[204:207], v[72:75], v[60:63], a[204:207]
    v_mfma_f32_16x16x32_bf16 a[224:227], v[72:75], v[64:67], a[224:227]
    v_mfma_f32_16x16x32_bf16 a[168:171], v[76:79], v[52:55], a[168:171]
    v_mfma_f32_16x16x32_bf16 a[188:191], v[76:79], v[56:59], a[188:191]
    v_mfma_f32_16x16x32_bf16 a[208:211], v[76:79], v[60:63], a[208:211]
    v_mfma_f32_16x16x32_bf16 a[228:231], v[76:79], v[64:67], a[228:231]
    v_mfma_f32_16x16x32_bf16 a[172:175], v[80:83], v[52:55], a[172:175]
    v_mfma_f32_16x16x32_bf16 a[192:195], v[80:83], v[56:59], a[192:195]
    v_mfma_f32_16x16x32_bf16 a[212:215], v[80:83], v[60:63], a[212:215]
    v_mfma_f32_16x16x32_bf16 a[232:235], v[80:83], v[64:67], a[232:235]
    v_mfma_f32_16x16x32_bf16 a[176:179], v[84:87], v[52:55], a[176:179]
    v_mfma_f32_16x16x32_bf16 a[196:199], v[84:87], v[56:59], a[196:199]
    v_mfma_f32_16x16x32_bf16 a[216:219], v[84:87], v[60:63], a[216:219]
    v_mfma_f32_16x16x32_bf16 a[236:239], v[84:87], v[64:67], a[236:239]
    s_mov_b32 s34, 13312
    s_mov_b32 s35, 66560
    buffer_load_dwordx4 v[68:71], v8, s[16:19], s35 offen offset:0
    buffer_load_dwordx4 v[72:75], v8, s[16:19], s35 offen offset:1024
    buffer_load_dwordx4 v[76:79], v8, s[16:19], s35 offen offset:2048
    buffer_load_dwordx4 v[80:83], v8, s[16:19], s35 offen offset:3072
    buffer_load_dwordx4 v[84:87], v9, s[16:19], s35 offen
    buffer_load_dwordx4 v[52:55], v4, s[12:15], s34 offen
    buffer_load_dwordx4 v[56:59], v5, s[12:15], s34 offen
    buffer_load_dwordx4 v[60:63], v6, s[12:15], s34 offen
    buffer_load_dwordx4 v[64:67], v7, s[12:15], s34 offen
    s_mov_b32 s35, 5120
    buffer_load_dwordx4 v[208:211], v14, s[56:59], s35 offen offset:0
    buffer_load_dwordx4 v[212:215], v14, s[56:59], s35 offen offset:1024
    buffer_load_dwordx4 v[216:219], v14, s[56:59], s35 offen offset:2048
    buffer_load_dwordx4 v[220:223], v14, s[56:59], s35 offen offset:3072
    buffer_load_dwordx4 v[224:227], v15, s[56:59], s35 offen
    s_waitcnt vmcnt(32)
    v_mfma_f32_16x16x32_bf16 a[160:163], v[104:107], v[88:91], a[160:163]
    v_mfma_f32_16x16x32_bf16 a[180:183], v[104:107], v[92:95], a[180:183]
    v_mfma_f32_16x16x32_bf16 a[200:203], v[104:107], v[96:99], a[200:203]
    v_mfma_f32_16x16x32_bf16 a[220:223], v[104:107], v[100:103], a[220:223]
    v_mfma_f32_16x16x32_bf16 a[164:167], v[108:111], v[88:91], a[164:167]
    v_mfma_f32_16x16x32_bf16 a[184:187], v[108:111], v[92:95], a[184:187]
    v_mfma_f32_16x16x32_bf16 a[204:207], v[108:111], v[96:99], a[204:207]
    v_mfma_f32_16x16x32_bf16 a[224:227], v[108:111], v[100:103], a[224:227]
    v_mfma_f32_16x16x32_bf16 a[168:171], v[112:115], v[88:91], a[168:171]
    v_mfma_f32_16x16x32_bf16 a[188:191], v[112:115], v[92:95], a[188:191]
    v_mfma_f32_16x16x32_bf16 a[208:211], v[112:115], v[96:99], a[208:211]
    v_mfma_f32_16x16x32_bf16 a[228:231], v[112:115], v[100:103], a[228:231]
    v_mfma_f32_16x16x32_bf16 a[172:175], v[116:119], v[88:91], a[172:175]
    v_mfma_f32_16x16x32_bf16 a[192:195], v[116:119], v[92:95], a[192:195]
    v_mfma_f32_16x16x32_bf16 a[212:215], v[116:119], v[96:99], a[212:215]
    v_mfma_f32_16x16x32_bf16 a[232:235], v[116:119], v[100:103], a[232:235]
    v_mfma_f32_16x16x32_bf16 a[176:179], v[120:123], v[88:91], a[176:179]
    v_mfma_f32_16x16x32_bf16 a[196:199], v[120:123], v[92:95], a[196:199]
    v_mfma_f32_16x16x32_bf16 a[216:219], v[120:123], v[96:99], a[216:219]
    v_mfma_f32_16x16x32_bf16 a[236:239], v[120:123], v[100:103], a[236:239]
    s_waitcnt vmcnt(19)
    v_mfma_f32_16x16x32_bf16 a[160:163], v[32:35], v[16:19], a[160:163]
    v_mfma_f32_16x16x32_bf16 a[180:183], v[32:35], v[20:23], a[180:183]
    v_mfma_f32_16x16x32_bf16 a[200:203], v[32:35], v[24:27], a[200:203]
    v_mfma_f32_16x16x32_bf16 a[220:223], v[32:35], v[28:31], a[220:223]
    v_mfma_f32_16x16x32_bf16 a[164:167], v[36:39], v[16:19], a[164:167]
    v_mfma_f32_16x16x32_bf16 a[184:187], v[36:39], v[20:23], a[184:187]
    v_mfma_f32_16x16x32_bf16 a[204:207], v[36:39], v[24:27], a[204:207]
    v_mfma_f32_16x16x32_bf16 a[224:227], v[36:39], v[28:31], a[224:227]
    v_mfma_f32_16x16x32_bf16 a[168:171], v[40:43], v[16:19], a[168:171]
    v_mfma_f32_16x16x32_bf16 a[188:191], v[40:43], v[20:23], a[188:191]
    v_mfma_f32_16x16x32_bf16 a[208:211], v[40:43], v[24:27], a[208:211]
    v_mfma_f32_16x16x32_bf16 a[228:231], v[40:43], v[28:31], a[228:231]
    v_mfma_f32_16x16x32_bf16 a[172:175], v[44:47], v[16:19], a[172:175]
    v_mfma_f32_16x16x32_bf16 a[192:195], v[44:47], v[20:23], a[192:195]
    v_mfma_f32_16x16x32_bf16 a[212:215], v[44:47], v[24:27], a[212:215]
    v_mfma_f32_16x16x32_bf16 a[232:235], v[44:47], v[28:31], a[232:235]
    v_mfma_f32_16x16x32_bf16 a[176:179], v[48:51], v[16:19], a[176:179]
    v_mfma_f32_16x16x32_bf16 a[196:199], v[48:51], v[20:23], a[196:199]
    v_mfma_f32_16x16x32_bf16 a[216:219], v[48:51], v[24:27], a[216:219]
    v_mfma_f32_16x16x32_bf16 a[236:239], v[48:51], v[28:31], a[236:239]
    s_waitcnt vmcnt(5)
    s_waitcnt vmcnt(0)
    s_mov_b32 s76, 0
    v_mov_b32 v228, 0
    v_mov_b32 v229, 0
    s_mov_b64 exec, 1
KM_poll:
    buffer_load_dword v228, v229, s[64:67], 0 offen sc1
    s_waitcnt vmcnt(0)
    v_readfirstlane_b32 s77, v228
    s_add_u32 s76, s76, 1
    s_cmp_ge_u32 s77, 212
    s_cbranch_scc1 KM_polled
    s_cmp_lt_u32 s76, 256
    s_cbranch_scc1 KM_poll
KM_poll2:
    v_mov_b32 v228, 0
    buffer_atomic_add v228, v229, s[64:67], 0 offen sc0 sc1
    s_waitcnt vmcnt(0)
    v_readfirstlane_b32 s77, v228
    s_add_u32 s76, s76, 1
    s_cmp_ge_u32 s77, 212
    s_cbranch_scc1 KM_polled
    s_cmp_lt_u32 s76, 200000
    s_cbranch_scc1 KM_poll2
KM_polled:
    s_mov_b64 exec, -1
    s_mul_i32 s33, s30, 18432
    v_add_u32 v3, s33, v2
    s_mov_b32 s34, 0
    s_mov_b32 s35, 73728
    buffer_load_dwordx4 v[124:127], v3, s[20:23], s34 offen sc1
    buffer_load_dwordx4 v[140:143], v3, s[20:23], s35 offen sc1
    s_mov_b32 s34, 1024
    s_mov_b32 s35, 74752
    buffer_load_dwordx4 v[128:131], v3, s[20:23], s34 offen sc1
    buffer_load_dwordx4 v[144:147], v3, s[20:23], s35 offen sc1
    s_mov_b32 s34, 2048
    s_mov_b32 s35, 75776
    buffer_load_dwordx4 v[132:135], v3, s[20:23], s34 offen sc1
    buffer_load_dwordx4 v[148:151], v3, s[20:23], s35 offen sc1
    s_mov_b32 s34, 3072
    s_mov_b32 s35, 76800
    buffer_load_dwordx4 v[156:159], v3, s[20:23], s34 offen sc1
    buffer_load_dwordx4 v[172:175], v3, s[20:23], s35 offen sc1
    s_mov_b32 s34, 4096
    s_mov_b32 s35, 77824
    buffer_load_dwordx4 v[160:163], v3, s[20:23], s34 offen sc1
    buffer_load_dwordx4 v[176:179], v3, s[20:23], s35 offen sc1
    s_mov_b32 s34, 5120
    s_mov_b32 s35, 78848
    buffer_load_dwordx4 v[164:167], v3, s[20:23], s34 offen sc1
    buffer_load_dwordx4 v[180:183], v3, s[20:23], s35 offen sc1
    s_mov_b32 s34, 6144
    s_mov_b32 s35, 79872
    buffer_load_dwordx4 v[168:171], v3, s[20:23], s34 offen sc1
    buffer_load_dwordx4 v[184:187], v3, s[20:23], s35 offen sc1
    s_cmp_ge_u32 s30, 2
    s_cbranch_scc1 KM_skip
    v_mfma_f32_16x16x32_bf16 a[160:163], v[68:71], v[52:55], a[160:163]
    v_mfma_f32_16x16x32_bf16 a[180:183], v[68:71], v[56:59], a[180:183]
    v_mfma_f32_16x16x32_bf16 a[200:203], v[68:71], v[60:63], a[200:203]
    v_mfma_f32_16x16x32_bf16 a[220:223], v[68:71], v[64:67], a[220:223]
    v_mfma_f32_16x16x32_bf16 a[164:167], v[72:75], v[52:55], a[164:167]
    v_mfma_f32_16x16x32_bf16 a[184:187], v[72:75], v[56:59], a[184:187]
    v_mfma_f32_16x16x32_bf16 a[204:207], v[72:75], v[60:63], a[204:207]
    v_mfma_f32_16x16x32_bf16 a[224:227], v[72:75], v[64:67], a[224:227]
    v_mfma_f32_16x16x32_bf16 a[168:171], v[76:79], v[52:55], a[168:171]
    v_mfma_f32_16x16x32_bf16 a[188:191], v[76:79], v[56:59], a[188:191]
    v_mfma_f32_16x16x32_bf16 a[208:211], v[76:79], v[60:63], a[208:211]
    v_mfma_f32_16x16x32_bf16 a[228:231], v[76:79], v[64:67], a[228:231]
    v_mfma_f32_16x16x32_bf16 a[172:175], v[80:83], v[52:55], a[172:175]
    v_mfma_f32_16x16x32_bf16 a[192:195], v[80:83], v[56:59], a[192:195]
    v_mfma_f32_16x16x32_bf16 a[212:215], v[80:83], v[60:63], a[212:215]
    v_mfma_f32_16x16x32_bf16 a[232:235], v[80:83], v[64:67], a[232:235]
    v_mfma_f32_16x16x32_bf16 a[176:179], v[84:87], v[52:55], a[176:179]
    v_mfma_f32_16x16x32_bf16 a[196:199], v[84:87], v[56:59], a[196:199]
    v_mfma_f32_16x16x32_bf16 a[216:219], v[84:87], v[60:63], a[216:219]
    v_mfma_f32_16x16x32_bf16 a[236:239], v[84:87], v[64:67], a[236:239]
KM_skip:
    v_lshrrev_b32 v228, 4, v1
    v_lshlrev_b32 v229, 3, v228
    s_mul_i32 s34, s29, 160
    v_add_u32 v229, s34, v229
    buffer_load_dwordx2 v[112:113], v229, s[24:27], 0 offen offset:0
    buffer_load_dwordx2 v[114:115], v229, s[24:27], 0 offen offset:32
    buffer_load_dwordx2 v[116:117], v229, s[24:27], 0 offen offset:64
    buffer_load_dwordx2 v[118:119], v229, s[24:27], 0 offen offset:96
    buffer_load_dwordx2 v[120:121], v229, s[24:27], 0 offen offset:128
    s_nop 7
    s_nop 1
    s_mul_i32 s33, s30, 20480
    v_lshlrev_b32 v2, 4, v1
    v_add_u32 v3, s33, v2
    ds_write_b128 v3, a[160:163] offset:0
    ds_write_b128 v3, a[164:167] offset:1024
    ds_write_b128 v3, a[168:171] offset:2048
    ds_write_b128 v3, a[172:175] offset:3072
    ds_write_b128 v3, a[176:179] offset:4096
    ds_write_b128 v3, a[180:183] offset:5120
    ds_write_b128 v3, a[184:187] offset:6144
    ds_write_b128 v3, a[188:191] offset:7168
    ds_write_b128 v3, a[192:195] offset:8192
    ds_write_b128 v3, a[196:199] offset:9216
    ds_write_b128 v3, a[200:203] offset:10240
    ds_write_b128 v3, a[204:207] offset:11264
    ds_write_b128 v3, a[208:211] offset:12288
    ds_write_b128 v3, a[212:215] offset:13312
    ds_write_b128 v3, a[216:219] offset:14336
    ds_write_b128 v3, a[220:223] offset:15360
    ds_write_b128 v3, a[224:227] offset:16384
    ds_write_b128 v3, a[228:231] offset:17408
    ds_write_b128 v3, a[232:235] offset:18432
    ds_write_b128 v3, a[236:239] offset:19456
    s_waitcnt lgkmcnt(0)
    s_barrier
    s_mul_i32 s33, s30, 5120
    v_add_u32 v3, s33, v2
    v_add_u32 v4, 40960, v3
    ds_read_b128 v[32:35], v3 offset:0
    ds_read_b128 v[36:39], v3 offset:1024
    ds_read_b128 v[40:43], v3 offset:2048
    ds_read_b128 v[44:47], v3 offset:3072
    ds_read_b128 v[48:51], v3 offset:4096
    ds_read_b128 v[52:55], v3 offset:20480
    ds_read_b128 v[56:59], v3 offset:21504
    ds_read_b128 v[60:63], v3 offset:22528
    ds_read_b128 v[64:67], v3 offset:23552
    ds_read_b128 v[68:71], v3 offset:24576
    s_waitcnt lgkmcnt(0)
    ds_read_b128 v[72:75], v4 offset:0
    ds_read_b128 v[76:79], v4 offset:1024
    ds_read_b128 v[80:83], v4 offset:2048
    ds_read_b128 v[84:87], v4 offset:3072
    ds_read_b128 v[88:91], v4 offset:4096
    ds_read_b128 v[92:95], v4 offset:20480
    ds_read_b128 v[96:99], v4 offset:21504
    ds_read_b128 v[100:103], v4 offset:22528
    ds_read_b128 v[104:107], v4 offset:23552
    ds_read_b128 v[108:111], v4 offset:24576
    s_waitcnt lgkmcnt(0)
    v_pk_add_f32 v[32:33], v[32:33], v[52:53]
    v_pk_add_f32 v[72:73], v[72:73], v[92:93]
    v_pk_add_f32 v[34:35], v[34:35], v[54:55]
    v_pk_add_f32 v[74:75], v[74:75], v[94:95]
    v_pk_add_f32 v[36:37], v[36:37], v[56:57]
    v_pk_add_f32 v[76:77], v[76:77], v[96:97]
    v_pk_add_f32 v[38:39], v[38:39], v[58:59]
    v_pk_add_f32 v[78:79], v[78:79], v[98:99]
    v_pk_add_f32 v[40:41], v[40:41], v[60:61]
    v_pk_add_f32 v[80:81], v[80:81], v[100:101]
    v_pk_add_f32 v[42:43], v[42:43], v[62:63]
    v_pk_add_f32 v[82:83], v[82:83], v[102:103]
    v_pk_add_f32 v[44:45], v[44:45], v[64:65]
    v_pk_add_f32 v[84:85], v[84:85], v[104:105]
    v_pk_add_f32 v[46:47], v[46:47], v[66:67]
    v_pk_add_f32 v[86:87], v[86:87], v[106:107]
    v_pk_add_f32 v[48:49], v[48:49], v[68:69]
    v_pk_add_f32 v[88:89], v[88:89], v[108:109]
    v_pk_add_f32 v[50:51], v[50:51], v[70:71]
    v_pk_add_f32 v[90:91], v[90:91], v[110:111]
    v_pk_add_f32 v[8:9], v[32:33], v[72:73]
    v_pk_add_f32 v[10:11], v[34:35], v[74:75]
    v_pk_add_f32 v[12:13], v[36:37], v[76:77]
    v_pk_add_f32 v[14:15], v[38:39], v[78:79]
    v_pk_add_f32 v[16:17], v[40:41], v[80:81]
    v_pk_add_f32 v[18:19], v[42:43], v[82:83]
    v_pk_add_f32 v[20:21], v[44:45], v[84:85]
    v_pk_add_f32 v[22:23], v[46:47], v[86:87]
    v_pk_add_f32 v[24:25], v[48:49], v[88:89]
    v_pk_add_f32 v[26:27], v[50:51], v[90:91]
    s_waitcnt vmcnt(0)
    v_cvt_pk_bf16_f32 v32, v8, v9
    v_cvt_pk_bf16_f32 v33, v10, v11
    v_cvt_pk_bf16_f32 v34, v12, v13
    v_cvt_pk_bf16_f32 v35, v14, v15
    v_cvt_pk_bf16_f32 v36, v16, v17
    v_cvt_pk_bf16_f32 v37, v18, v19
    v_cvt_pk_bf16_f32 v38, v20, v21
    v_cvt_pk_bf16_f32 v39, v22, v23
    v_cvt_pk_bf16_f32 v40, v24, v25
    v_cvt_pk_bf16_f32 v41, v26, v27
    v_lshlrev_b32 v8, 16, v32
    v_and_b32 v9, 0xffff0000, v32
    v_lshlrev_b32 v10, 16, v33
    v_and_b32 v11, 0xffff0000, v33
    v_lshlrev_b32 v44, 16, v112
    v_and_b32 v45, 0xffff0000, v112
    v_lshlrev_b32 v46, 16, v113
    v_and_b32 v47, 0xffff0000, v113
    v_lshlrev_b32 v12, 16, v34
    v_and_b32 v13, 0xffff0000, v34
    v_lshlrev_b32 v14, 16, v35
    v_and_b32 v15, 0xffff0000, v35
    v_lshlrev_b32 v48, 16, v114
    v_and_b32 v49, 0xffff0000, v114
    v_lshlrev_b32 v50, 16, v115
    v_and_b32 v51, 0xffff0000, v115
    v_lshlrev_b32 v16, 16, v36
    v_and_b32 v17, 0xffff0000, v36
    v_lshlrev_b32 v18, 16, v37
    v_and_b32 v19, 0xffff0000, v37
    v_lshlrev_b32 v52, 16, v116
    v_and_b32 v53, 0xffff0000, v116
    v_lshlrev_b32 v54, 16, v117
    v_and_b32 v55, 0xffff0000, v117
    v_lshlrev_b32 v20, 16, v38
    v_and_b32 v21, 0xffff0000, v38
    v_lshlrev_b32 v22, 16, v39
    v_and_b32 v23, 0xffff0000, v39
    v_lshlrev_b32 v56, 16, v118
    v_and_b32 v57, 0xffff0000, v118
    v_lshlrev_b32 v58, 16, v119
    v_and_b32 v59, 0xffff0000, v119
    v_lshlrev_b32 v24, 16, v40
    v_and_b32 v25, 0xffff0000, v40
    v_lshlrev_b32 v26, 16, v41
    v_and_b32 v27, 0xffff0000, v41
    v_lshlrev_b32 v60, 16, v120
    v_and_b32 v61, 0xffff0000, v120
    v_lshlrev_b32 v62, 16, v121
    v_and_b32 v63, 0xffff0000, v121
    v_pk_add_f32 v[8:9], v[8:9], v[44:45]
    v_pk_add_f32 v[10:11], v[10:11], v[46:47]
    v_pk_add_f32 v[12:13], v[12:13], v[48:49]
    v_pk_add_f32 v[14:15], v[14:15], v[50:51]
    v_pk_add_f32 v[16:17], v[16:17], v[52:53]
    v_pk_add_f32 v[18:19], v[18:19], v[54:55]
    v_pk_add_f32 v[20:21], v[20:21], v[56:57]
    v_pk_add_f32 v[22:23], v[22:23], v[58:59]
    v_pk_add_f32 v[24:25], v[24:25], v[60:61]
    v_pk_add_f32 v[26:27], v[26:27], v[62:63]
    v_cvt_pk_bf16_f32 v228, v8, v9
    v_cvt_pk_bf16_f32 v229, v10, v11
    v_cvt_pk_bf16_f32 v230, v12, v13
    v_cvt_pk_bf16_f32 v231, v14, v15
    v_cvt_pk_bf16_f32 v232, v16, v17
    v_cvt_pk_bf16_f32 v233, v18, v19
    v_cvt_pk_bf16_f32 v234, v20, v21
    v_cvt_pk_bf16_f32 v235, v22, v23
    v_cvt_pk_bf16_f32 v236, v24, v25
    v_cvt_pk_bf16_f32 v237, v26, v27
    v_lshlrev_b32 v2, 4, v1
    s_mul_i32 s33, s30, 18432
    v_add_u32 v3, s33, v2
    s_mul_i32 s33, s29, 20
    s_mul_i32 s34, s30, 5
    s_add_u32 s33, s33, s34
    s_mul_i32 s33, s33, 5120
    v_add_u32 v14, s33, v2
    v_add_u32 v15, 4096, v14
    s_mov_b32 s34, 7168
    s_mov_b32 s35, 80896
    buffer_load_dwordx4 a[160:163], v3, s[20:23], s34 offen sc1
    buffer_load_dwordx4 a[176:179], v3, s[20:23], s35 offen sc1
    s_mov_b32 s34, 8192
    s_mov_b32 s35, 81920
    buffer_load_dwordx4 a[164:167], v3, s[20:23], s34 offen sc1
    buffer_load_dwordx4 a[180:183], v3, s[20:23], s35 offen sc1
    s_mov_b32 s34, 9216
    s_mov_b32 s35, 82944
    buffer_load_dwordx4 a[168:171], v3, s[20:23], s34 offen sc1
    buffer_load_dwordx4 a[184:187], v3, s[20:23], s35 offen sc1
    s_mov_b32 s34, 10240
    s_mov_b32 s35, 83968
    buffer_load_dwordx4 a[172:175], v3, s[20:23], s34 offen sc1
    buffer_load_dwordx4 a[188:191], v3, s[20:23], s35 offen sc1
    s_mov_b32 s34, 11264
    s_mov_b32 s35, 84992
    buffer_load_dwordx4 a[192:195], v3, s[20:23], s34 offen sc1
    buffer_load_dwordx4 a[208:211], v3, s[20:23], s35 offen sc1
    s_mov_b32 s34, 12288
    s_mov_b32 s35, 86016
    buffer_load_dwordx4 a[196:199], v3, s[20:23], s34 offen sc1
    buffer_load_dwordx4 a[212:215], v3, s[20:23], s35 offen sc1
    s_mov_b32 s34, 13312
    s_mov_b32 s35, 87040
    buffer_load_dwordx4 a[200:203], v3, s[20:23], s34 offen sc1
    buffer_load_dwordx4 a[216:219], v3, s[20:23], s35 offen sc1
    s_mov_b32 s34, 14336
    s_mov_b32 s35, 88064
    buffer_load_dwordx4 a[204:207], v3, s[20:23], s34 offen sc1
    buffer_load_dwordx4 a[220:223], v3, s[20:23], s35 offen sc1
    s_nop 1
    v_mfma_f32_16x16x32_bf16 v[16:19], v[124:127], a[80:83], 0
    v_mfma_f32_16x16x32_bf16 v[20:23], v[124:127], a[100:103], 0
    v_mfma_f32_16x16x32_bf16 v[24:27], v[124:127], a[120:123], 0
    v_mfma_f32_16x16x32_bf16 v[28:31], v[124:127], a[140:143], 0
    v_mfma_f32_16x16x32_bf16 v[32:35], v[140:143], a[80:83], 0
    v_mfma_f32_16x16x32_bf16 v[36:39], v[140:143], a[100:103], 0
    v_mfma_f32_16x16x32_bf16 v[40:43], v[140:143], a[120:123], 0
    v_mfma_f32_16x16x32_bf16 v[44:47], v[140:143], a[140:143], 0
    s_nop 1
    v_mfma_f32_16x16x32_bf16 v[48:51], v[128:131], a[80:83], 0
    v_mfma_f32_16x16x32_bf16 v[52:55], v[128:131], a[100:103], 0
    s_nop 7
    v_cvt_pk_bf16_f32 v240, v32, v32
    v_cvt_pk_bf16_f32 v242, v36, v36
    v_cvt_pk_bf16_f32 v244, v40, v40
    v_cvt_pk_bf16_f32 v246, v44, v44
    v_mfma_f32_16x16x32_bf16 v[56:59], v[128:131], a[120:123], 0
    v_cvt_pk_bf16_f32 v248, v16, v17
    v_cvt_pk_bf16_f32 v249, v18, v19
    v_cvt_pk_bf16_f32 v250, v20, v21
    v_cvt_pk_bf16_f32 v251, v22, v23
    v_cvt_pk_bf16_f32 v252, v24, v25
    v_mfma_f32_16x16x32_bf16 v[60:63], v[128:131], a[140:143], 0
    v_cvt_pk_bf16_f32 v253, v26, v27
    v_cvt_pk_bf16_f32 v254, v28, v29
    v_cvt_pk_bf16_f32 v255, v30, v31
    v_lshlrev_b32 v240, 16, v240
    v_lshlrev_b32 v242, 16, v242
    v_mfma_f32_16x16x32_bf16 v[64:67], v[144:147], a[80:83], 0
    v_lshlrev_b32 v244, 16, v244
    v_lshlrev_b32 v246, 16, v246
    v_add_f32 v240, s39, v240
    v_add_f32 v242, s39, v242
    v_add_f32 v244, s39, v244
    v_mfma_f32_16x16x32_bf16 v[68:71], v[144:147], a[100:103], 0
    v_add_f32 v246, s39, v246
    v_lshlrev_b32 v16, 16, v248
    v_and_b32 v17, 0xffff0000, v248
    v_lshlrev_b32 v18, 16, v249
    v_and_b32 v19, 0xffff0000, v249
    v_mfma_f32_16x16x32_bf16 v[72:75], v[144:147], a[120:123], 0
    v_lshlrev_b32 v20, 16, v250
    v_and_b32 v21, 0xffff0000, v250
    v_lshlrev_b32 v22, 16, v251
    v_and_b32 v23, 0xffff0000, v251
    v_lshlrev_b32 v24, 16, v252
    v_mfma_f32_16x16x32_bf16 v[76:79], v[144:147], a[140:143], 0
    v_and_b32 v25, 0xffff0000, v252
    v_lshlrev_b32 v26, 16, v253
    v_and_b32 v27, 0xffff0000, v253
    v_lshlrev_b32 v28, 16, v254
    v_mfma_f32_16x16x32_bf16 v[48:51], v[132:135], a[84:87], v[48:51]
    v_and_b32 v29, 0xffff0000, v254
    v_lshlrev_b32 v30, 16, v255
    v_and_b32 v31, 0xffff0000, v255
    v_cvt_pk_bf16_f32 v240, v240, v240
    v_mfma_f32_16x16x32_bf16 v[52:55], v[132:135], a[104:107], v[52:55]
    v_cvt_pk_bf16_f32 v242, v242, v242
    v_cvt_pk_bf16_f32 v244, v244, v244
    v_cvt_pk_bf16_f32 v246, v246, v246
    v_lshlrev_b32 v240, 16, v240
    v_mfma_f32_16x16x32_bf16 v[56:59], v[132:135], a[124:127], v[56:59]
    v_lshlrev_b32 v242, 16, v242
    v_lshlrev_b32 v244, 16, v244
    v_lshlrev_b32 v246, 16, v246
    v_rcp_f32 v240, v240
    v_mfma_f32_16x16x32_bf16 v[60:63], v[132:135], a[144:147], v[60:63]
    v_rcp_f32 v242, v242
    v_rcp_f32 v244, v244
    v_rcp_f32 v246, v246
    s_nop 0
    v_mfma_f32_16x16x32_bf16 v[64:67], v[148:151], a[84:87], v[64:67]
    v_pk_mul_f32 v[16:17], v[16:17], v[240:241] op_sel_hi:[1,0]
    v_pk_mul_f32 v[18:19], v[18:19], v[240:241] op_sel_hi:[1,0]
    v_pk_mul_f32 v[20:21], v[20:21], v[242:243] op_sel_hi:[1,0]
    v_pk_mul_f32 v[22:23], v[22:23], v[242:243] op_sel_hi:[1,0]
    v_mfma_f32_16x16x32_bf16 v[68:71], v[148:151], a[104:107], v[68:71]
    v_pk_mul_f32 v[24:25], v[24:25], v[244:245] op_sel_hi:[1,0]
    v_pk_mul_f32 v[26:27], v[26:27], v[244:245] op_sel_hi:[1,0]
    v_pk_mul_f32 v[28:29], v[28:29], v[246:247] op_sel_hi:[1,0]
    v_pk_mul_f32 v[30:31], v[30:31], v[246:247] op_sel_hi:[1,0]
    v_mfma_f32_16x16x32_bf16 v[72:75], v[148:151], a[124:127], v[72:75]
    v_cvt_pk_bf16_f32 v80, v16, v17
    v_cvt_pk_bf16_f32 v81, v18, v19
    v_cvt_pk_bf16_f32 v84, v20, v21
    v_cvt_pk_bf16_f32 v85, v22, v23
    v_mfma_f32_16x16x32_bf16 v[76:79], v[148:151], a[144:147], v[76:79]
    v_cvt_pk_bf16_f32 v88, v24, v25
    v_cvt_pk_bf16_f32 v89, v26, v27
    v_cvt_pk_bf16_f32 v92, v28, v29
    v_cvt_pk_bf16_f32 v93, v30, v31
    s_mov_b32 s34, 15360
    s_mov_b32 s35, 89088
    buffer_load_dwordx4 v[124:127], v3, s[20:23], s34 offen sc1
    buffer_load_dwordx4 v[140:143], v3, s[20:23], s35 offen sc1
    s_mov_b32 s34, 16384
    s_mov_b32 s35, 90112
    buffer_load_dwordx4 v[128:131], v3, s[20:23], s34 offen sc1
    buffer_load_dwordx4 v[144:147], v3, s[20:23], s35 offen sc1
    s_mov_b32 s34, 17408
    s_mov_b32 s35, 91136
    buffer_load_dwordx4 v[132:135], v3, s[20:23], s34 offen sc1
    buffer_load_dwordx4 v[148:151], v3, s[20:23], s35 offen sc1
    s_nop 1
    v_mfma_f32_16x16x32_bf16 v[16:19], v[156:159], a[80:83], 0
    v_mfma_f32_16x16x32_bf16 v[20:23], v[156:159], a[100:103], 0
    s_nop 7
    v_cvt_pk_bf16_f32 v240, v64, v64
    v_cvt_pk_bf16_f32 v242, v68, v68
    v_cvt_pk_bf16_f32 v244, v72, v72
    v_cvt_pk_bf16_f32 v246, v76, v76
    v_mfma_f32_16x16x32_bf16 v[24:27], v[156:159], a[120:123], 0
    v_cvt_pk_bf16_f32 v248, v48, v49
    v_cvt_pk_bf16_f32 v249, v50, v51
    v_cvt_pk_bf16_f32 v250, v52, v53
    v_cvt_pk_bf16_f32 v251, v54, v55
    v_cvt_pk_bf16_f32 v252, v56, v57
    v_mfma_f32_16x16x32_bf16 v[28:31], v[156:159], a[140:143], 0
    v_cvt_pk_bf16_f32 v253, v58, v59
    v_cvt_pk_bf16_f32 v254, v60, v61
    v_cvt_pk_bf16_f32 v255, v62, v63
    v_lshlrev_b32 v240, 16, v240
    v_lshlrev_b32 v242, 16, v242
    v_mfma_f32_16x16x32_bf16 v[32:35], v[172:175], a[80:83], 0
    v_lshlrev_b32 v244, 16, v244
    v_lshlrev_b32 v246, 16, v246
    v_add_f32 v240, s39, v240
    v_add_f32 v242, s39, v242
    v_add_f32 v244, s39, v244
    v_mfma_f32_16x16x32_bf16 v[36:39], v[172:175], a[100:103], 0
    v_add_f32 v246, s39, v246
    v_lshlrev_b32 v48, 16, v248
    v_and_b32 v49, 0xffff0000, v248
    v_lshlrev_b32 v50, 16, v249
    v_and_b32 v51, 0xffff0000, v249
    v_mfma_f32_16x16x32_bf16 v[40:43], v[172:175], a[120:123], 0
    v_lshlrev_b32 v52, 16, v250
    v_and_b32 v53, 0xffff0000, v250
    v_lshlrev_b32 v54, 16, v251
    v_and_b32 v55, 0xffff0000, v251
    v_lshlrev_b32 v56, 16, v252
    v_mfma_f32_16x16x32_bf16 v[44:47], v[172:175], a[140:143], 0
    v_and_b32 v57, 0xffff0000, v252
    v_lshlrev_b32 v58, 16, v253
    v_and_b32 v59, 0xffff0000, v253
    v_lshlrev_b32 v60, 16, v254
    v_mfma_f32_16x16x32_bf16 v[16:19], v[160:163], a[84:87], v[16:19]
    v_and_b32 v61, 0xffff0000, v254
    v_lshlrev_b32 v62, 16, v255
    v_and_b32 v63, 0xffff0000, v255
    v_cvt_pk_bf16_f32 v240, v240, v240
    v_mfma_f32_16x16x32_bf16 v[20:23], v[160:163], a[104:107], v[20:23]
    v_cvt_pk_bf16_f32 v242, v242, v242
    v_cvt_pk_bf16_f32 v244, v244, v244
    v_cvt_pk_bf16_f32 v246, v246, v246
    v_lshlrev_b32 v240, 16, v240
    v_mfma_f32_16x16x32_bf16 v[24:27], v[160:163], a[124:127], v[24:27]
    v_lshlrev_b32 v242, 16, v242
    v_lshlrev_b32 v244, 16, v244
    v_lshlrev_b32 v246, 16, v246
    v_rcp_f32 v240, v240
    v_mfma_f32_16x16x32_bf16 v[28:31], v[160:163], a[144:147], v[28:31]
    v_rcp_f32 v242, v242
    v_rcp_f32 v244, v244
    v_rcp_f32 v246, v246
    s_nop 0
    v_mfma_f32_16x16x32_bf16 v[32:35], v[176:179], a[84:87], v[32:35]
    v_pk_mul_f32 v[48:49], v[48:49], v[240:241] op_sel_hi:[1,0]
    v_pk_mul_f32 v[50:51], v[50:51], v[240:241] op_sel_hi:[1,0]
    v_pk_mul_f32 v[52:53], v[52:53], v[242:243] op_sel_hi:[1,0]
    v_pk_mul_f32 v[54:55], v[54:55], v[242:243] op_sel_hi:[1,0]
    v_mfma_f32_16x16x32_bf16 v[36:39], v[176:179], a[104:107], v[36:39]
    v_pk_mul_f32 v[56:57], v[56:57], v[244:245] op_sel_hi:[1,0]
    v_pk_mul_f32 v[58:59], v[58:59], v[244:245] op_sel_hi:[1,0]
    v_pk_mul_f32 v[60:61], v[60:61], v[246:247] op_sel_hi:[1,0]
    v_pk_mul_f32 v[62:63], v[62:63], v[246:247] op_sel_hi:[1,0]
    v_mfma_f32_16x16x32_bf16 v[40:43], v[176:179], a[124:127], v[40:43]
    v_cvt_pk_bf16_f32 v82, v48, v49
    v_cvt_pk_bf16_f32 v83, v50, v51
    v_cvt_pk_bf16_f32 v86, v52, v53
    v_cvt_pk_bf16_f32 v87, v54, v55
    v_mfma_f32_16x16x32_bf16 v[44:47], v[176:179], a[144:147], v[44:47]
    v_cvt_pk_bf16_f32 v90, v56, v57
    v_cvt_pk_bf16_f32 v91, v58, v59
    v_cvt_pk_bf16_f32 v94, v60, v61
    v_cvt_pk_bf16_f32 v95, v62, v63
    s_nop 1
    v_mfma_f32_16x16x32_bf16 a[0:3], v[188:191], v[80:83], 0
    v_mfma_f32_16x16x32_bf16 a[20:23], v[188:191], v[84:87], 0
    s_nop 7
    v_cvt_pk_bf16_f32 v240, v32, v32
    v_cvt_pk_bf16_f32 v242, v36, v36
    v_mfma_f32_16x16x32_bf16 a[40:43], v[188:191], v[88:91], 0
    v_cvt_pk_bf16_f32 v244, v40, v40
    v_cvt_pk_bf16_f32 v246, v44, v44
    v_cvt_pk_bf16_f32 v248, v16, v17
    v_mfma_f32_16x16x32_bf16 a[60:63], v[188:191], v[92:95], 0
    v_cvt_pk_bf16_f32 v249, v18, v19
    v_cvt_pk_bf16_f32 v250, v20, v21
    v_cvt_pk_bf16_f32 v251, v22, v23
    v_mfma_f32_16x16x32_bf16 a[4:7], v[192:195], v[80:83], 0
    v_cvt_pk_bf16_f32 v252, v24, v25
    v_cvt_pk_bf16_f32 v253, v26, v27
    v_cvt_pk_bf16_f32 v254, v28, v29
    v_mfma_f32_16x16x32_bf16 a[24:27], v[192:195], v[84:87], 0
    v_cvt_pk_bf16_f32 v255, v30, v31
    v_lshlrev_b32 v240, 16, v240
    v_lshlrev_b32 v242, 16, v242
    v_mfma_f32_16x16x32_bf16 a[44:47], v[192:195], v[88:91], 0
    v_lshlrev_b32 v244, 16, v244
    v_lshlrev_b32 v246, 16, v246
    v_add_f32 v240, s39, v240
    v_mfma_f32_16x16x32_bf16 a[64:67], v[192:195], v[92:95], 0
    v_add_f32 v242, s39, v242
    v_add_f32 v244, s39, v244
    v_add_f32 v246, s39, v246
    v_mfma_f32_16x16x32_bf16 a[8:11], v[196:199], v[80:83], 0
    v_lshlrev_b32 v16, 16, v248
    v_and_b32 v17, 0xffff0000, v248
    v_lshlrev_b32 v18, 16, v249
    v_mfma_f32_16x16x32_bf16 a[28:31], v[196:199], v[84:87], 0
    v_and_b32 v19, 0xffff0000, v249
    v_lshlrev_b32 v20, 16, v250
    v_and_b32 v21, 0xffff0000, v250
    v_mfma_f32_16x16x32_bf16 v[48:51], v[164:167], a[84:87], 0
    v_lshlrev_b32 v22, 16, v251
    v_and_b32 v23, 0xffff0000, v251
    v_lshlrev_b32 v24, 16, v252
    v_mfma_f32_16x16x32_bf16 v[52:55], v[164:167], a[104:107], 0
    v_and_b32 v25, 0xffff0000, v252
    v_lshlrev_b32 v26, 16, v253
    v_and_b32 v27, 0xffff0000, v253
    v_mfma_f32_16x16x32_bf16 v[56:59], v[164:167], a[124:127], 0
    v_lshlrev_b32 v28, 16, v254
    v_and_b32 v29, 0xffff0000, v254
    v_lshlrev_b32 v30, 16, v255
    v_mfma_f32_16x16x32_bf16 v[60:63], v[164:167], a[144:147], 0
    v_and_b32 v31, 0xffff0000, v255
    v_cvt_pk_bf16_f32 v240, v240, v240
    v_cvt_pk_bf16_f32 v242, v242, v242
    v_mfma_f32_16x16x32_bf16 v[64:67], v[180:183], a[84:87], 0
    v_cvt_pk_bf16_f32 v244, v244, v244
    v_cvt_pk_bf16_f32 v246, v246, v246
    v_lshlrev_b32 v240, 16, v240
    v_mfma_f32_16x16x32_bf16 v[68:71], v[180:183], a[104:107], 0
    v_lshlrev_b32 v242, 16, v242
    v_lshlrev_b32 v244, 16, v244
    v_lshlrev_b32 v246, 16, v246
    v_mfma_f32_16x16x32_bf16 v[72:75], v[180:183], a[124:127], 0
    v_rcp_f32 v240, v240
    v_rcp_f32 v242, v242
    v_rcp_f32 v244, v244
    v_mfma_f32_16x16x32_bf16 v[76:79], v[180:183], a[144:147], 0
    v_rcp_f32 v246, v246
    s_nop 0
    v_mfma_f32_16x16x32_bf16 v[48:51], v[168:171], a[88:91], v[48:51]
    v_pk_mul_f32 v[16:17], v[16:17], v[240:241] op_sel_hi:[1,0]
    v_pk_mul_f32 v[18:19], v[18:19], v[240:241] op_sel_hi:[1,0]
    v_mfma_f32_16x16x32_bf16 v[52:55], v[168:171], a[108:111], v[52:55]
    v_pk_mul_f32 v[20:21], v[20:21], v[242:243] op_sel_hi:[1,0]
    v_pk_mul_f32 v[22:23], v[22:23], v[242:243] op_sel_hi:[1,0]
    v_mfma_f32_16x16x32_bf16 v[56:59], v[168:171], a[128:131], v[56:59]
    v_pk_mul_f32 v[24:25], v[24:25], v[244:245] op_sel_hi:[1,0]
    v_pk_mul_f32 v[26:27], v[26:27], v[244:245] op_sel_hi:[1,0]
    v_mfma_f32_16x16x32_bf16 v[60:63], v[168:171], a[148:151], v[60:63]
    v_pk_mul_f32 v[28:29], v[28:29], v[246:247] op_sel_hi:[1,0]
    v_pk_mul_f32 v[30:31], v[30:31], v[246:247] op_sel_hi:[1,0]
    v_mfma_f32_16x16x32_bf16 v[64:67], v[184:187], a[88:91], v[64:67]
    v_cvt_pk_bf16_f32 v96, v16, v17
    v_cvt_pk_bf16_f32 v97, v18, v19
    v_mfma_f32_16x16x32_bf16 v[68:71], v[184:187], a[108:111], v[68:71]
    v_cvt_pk_bf16_f32 v100, v20, v21
    v_cvt_pk_bf16_f32 v101, v22, v23
    v_mfma_f32_16x16x32_bf16 v[72:75], v[184:187], a[128:131], v[72:75]
    v_cvt_pk_bf16_f32 v104, v24, v25
    v_cvt_pk_bf16_f32 v105, v26, v27
    v_mfma_f32_16x16x32_bf16 v[76:79], v[184:187], a[148:151], v[76:79]
    v_cvt_pk_bf16_f32 v108, v28, v29
    v_cvt_pk_bf16_f32 v109, v30, v31
    s_waitcnt vmcnt(14)
    s_nop 1
    v_mfma_f32_16x16x32_bf16 a[48:51], v[196:199], v[88:91], 0
    v_mfma_f32_16x16x32_bf16 a[68:71], v[196:199], v[92:95], 0
    s_nop 7
    v_cvt_pk_bf16_f32 v240, v64, v64
    v_cvt_pk_bf16_f32 v242, v68, v68
    v_mfma_f32_16x16x32_bf16 a[12:15], v[200:203], v[80:83], 0
    v_cvt_pk_bf16_f32 v244, v72, v72
    v_cvt_pk_bf16_f32 v246, v76, v76
    v_cvt_pk_bf16_f32 v248, v48, v49
    v_mfma_f32_16x16x32_bf16 a[32:35], v[200:203], v[84:87], 0
    v_cvt_pk_bf16_f32 v249, v50, v51
    v_cvt_pk_bf16_f32 v250, v52, v53
    v_cvt_pk_bf16_f32 v251, v54, v55
    v_mfma_f32_16x16x32_bf16 a[52:55], v[200:203], v[88:91], 0
    v_cvt_pk_bf16_f32 v252, v56, v57
    v_cvt_pk_bf16_f32 v253, v58, v59
    v_cvt_pk_bf16_f32 v254, v60, v61
    v_mfma_f32_16x16x32_bf16 a[72:75], v[200:203], v[92:95], 0
    v_cvt_pk_bf16_f32 v255, v62, v63
    v_lshlrev_b32 v240, 16, v240
    v_lshlrev_b32 v242, 16, v242
    v_mfma_f32_16x16x32_bf16 a[16:19], v[204:207], v[80:83], 0
    v_lshlrev_b32 v244, 16, v244
    v_lshlrev_b32 v246, 16, v246
    v_add_f32 v240, s39, v240
    v_mfma_f32_16x16x32_bf16 a[36:39], v[204:207], v[84:87], 0
    v_add_f32 v242, s39, v242
    v_add_f32 v244, s39, v244
    v_add_f32 v246, s39, v246
    v_mfma_f32_16x16x32_bf16 a[56:59], v[204:207], v[88:91], 0
    v_lshlrev_b32 v48, 16, v248
    v_and_b32 v49, 0xffff0000, v248
    v_lshlrev_b32 v50, 16, v249
    v_mfma_f32_16x16x32_bf16 a[76:79], v[204:207], v[92:95], 0
    v_and_b32 v51, 0xffff0000, v249
    v_lshlrev_b32 v52, 16, v250
    v_and_b32 v53, 0xffff0000, v250
    v_mfma_f32_16x16x32_bf16 v[16:19], a[160:163], a[84:87], 0
    v_lshlrev_b32 v54, 16, v251
    v_and_b32 v55, 0xffff0000, v251
    v_lshlrev_b32 v56, 16, v252
    v_mfma_f32_16x16x32_bf16 v[20:23], a[160:163], a[104:107], 0
    v_and_b32 v57, 0xffff0000, v252
    v_lshlrev_b32 v58, 16, v253
    v_and_b32 v59, 0xffff0000, v253
    v_mfma_f32_16x16x32_bf16 v[24:27], a[160:163], a[124:127], 0
    v_lshlrev_b32 v60, 16, v254
    v_and_b32 v61, 0xffff0000, v254
    v_lshlrev_b32 v62, 16, v255
    v_mfma_f32_16x16x32_bf16 v[28:31], a[160:163], a[144:147], 0
    v_and_b32 v63, 0xffff0000, v255
    v_cvt_pk_bf16_f32 v240, v240, v240
    v_cvt_pk_bf16_f32 v242, v242, v242
    v_mfma_f32_16x16x32_bf16 v[32:35], a[176:179], a[84:87], 0
    v_cvt_pk_bf16_f32 v244, v244, v244
    v_cvt_pk_bf16_f32 v246, v246, v246
    v_lshlrev_b32 v240, 16, v240
    v_mfma_f32_16x16x32_bf16 v[36:39], a[176:179], a[104:107], 0
    v_lshlrev_b32 v242, 16, v242
    v_lshlrev_b32 v244, 16, v244
    v_lshlrev_b32 v246, 16, v246
    v_mfma_f32_16x16x32_bf16 v[40:43], a[176:179], a[124:127], 0
    v_rcp_f32 v240, v240
    v_rcp_f32 v242, v242
    v_rcp_f32 v244, v244
    v_mfma_f32_16x16x32_bf16 v[44:47], a[176:179], a[144:147], 0
    v_rcp_f32 v246, v246
    s_nop 0
    v_mfma_f32_16x16x32_bf16 v[16:19], a[164:167], a[88:91], v[16:19]
    v_pk_mul_f32 v[48:49], v[48:49], v[240:241] op_sel_hi:[1,0]
    v_pk_mul_f32 v[50:51], v[50:51], v[240:241] op_sel_hi:[1,0]
    v_mfma_f32_16x16x32_bf16 v[20:23], a[164:167], a[108:111], v[20:23]
    v_pk_mul_f32 v[52:53], v[52:53], v[242:243] op_sel_hi:[1,0]
    v_pk_mul_f32 v[54:55], v[54:55], v[242:243] op_sel_hi:[1,0]
    v_mfma_f32_16x16x32_bf16 v[24:27], a[164:167], a[128:131], v[24:27]
    v_pk_mul_f32 v[56:57], v[56:57], v[244:245] op_sel_hi:[1,0]
    v_pk_mul_f32 v[58:59], v[58:59], v[244:245] op_sel_hi:[1,0]
    v_mfma_f32_16x16x32_bf16 v[28:31], a[164:167], a[148:151], v[28:31]
    v_pk_mul_f32 v[60:61], v[60:61], v[246:247] op_sel_hi:[1,0]
    v_pk_mul_f32 v[62:63], v[62:63], v[246:247] op_sel_hi:[1,0]
    v_mfma_f32_16x16x32_bf16 v[32:35], a[180:183], a[88:91], v[32:35]
    v_cvt_pk_bf16_f32 v98, v48, v49
    v_cvt_pk_bf16_f32 v99, v50, v51
    v_mfma_f32_16x16x32_bf16 v[36:39], a[180:183], a[108:111], v[36:39]
    v_cvt_pk_bf16_f32 v102, v52, v53
    v_cvt_pk_bf16_f32 v103, v54, v55
    v_mfma_f32_16x16x32_bf16 v[40:43], a[180:183], a[128:131], v[40:43]
    v_cvt_pk_bf16_f32 v106, v56, v57
    v_cvt_pk_bf16_f32 v107, v58, v59
    v_mfma_f32_16x16x32_bf16 v[44:47], a[180:183], a[148:151], v[44:47]
    v_cvt_pk_bf16_f32 v110, v60, v61
    v_cvt_pk_bf16_f32 v111, v62, v63
    s_mov_b32 s35, 10240
    buffer_load_dwordx4 v[188:191], v14, s[56:59], s35 offen offset:0
    buffer_load_dwordx4 v[192:195], v14, s[56:59], s35 offen offset:1024
    buffer_load_dwordx4 v[196:199], v14, s[56:59], s35 offen offset:2048
    buffer_load_dwordx4 v[200:203], v14, s[56:59], s35 offen offset:3072
    buffer_load_dwordx4 v[204:207], v15, s[56:59], s35 offen
    s_nop 1
    v_mfma_f32_16x16x32_bf16 a[0:3], v[208:211], v[96:99], a[0:3]
    v_mfma_f32_16x16x32_bf16 a[20:23], v[208:211], v[100:103], a[20:23]
    s_nop 7
    v_cvt_pk_bf16_f32 v240, v32, v32
    v_cvt_pk_bf16_f32 v242, v36, v36
    v_mfma_f32_16x16x32_bf16 a[40:43], v[208:211], v[104:107], a[40:43]
    v_cvt_pk_bf16_f32 v244, v40, v40
    v_cvt_pk_bf16_f32 v246, v44, v44
    v_cvt_pk_bf16_f32 v248, v16, v17
    v_mfma_f32_16x16x32_bf16 a[60:63], v[208:211], v[108:111], a[60:63]
    v_cvt_pk_bf16_f32 v249, v18, v19
    v_cvt_pk_bf16_f32 v250, v20, v21
    v_cvt_pk_bf16_f32 v251, v22, v23
    v_mfma_f32_16x16x32_bf16 a[4:7], v[212:215], v[96:99], a[4:7]
    v_cvt_pk_bf16_f32 v252, v24, v25
    v_cvt_pk_bf16_f32 v253, v26, v27
    v_cvt_pk_bf16_f32 v254, v28, v29
    v_mfma_f32_16x16x32_bf16 a[24:27], v[212:215], v[100:103], a[24:27]
    v_cvt_pk_bf16_f32 v255, v30, v31
    v_lshlrev_b32 v240, 16, v240
    v_lshlrev_b32 v242, 16, v242
    v_mfma_f32_16x16x32_bf16 a[44:47], v[212:215], v[104:107], a[44:47]
    v_lshlrev_b32 v244, 16, v244
    v_lshlrev_b32 v246, 16, v246
    v_add_f32 v240, s39, v240
    v_mfma_f32_16x16x32_bf16 a[64:67], v[212:215], v[108:111], a[64:67]
    v_add_f32 v242, s39, v242
    v_add_f32 v244, s39, v244
    v_add_f32 v246, s39, v246
    v_mfma_f32_16x16x32_bf16 a[8:11], v[216:219], v[96:99], a[8:11]
    v_lshlrev_b32 v16, 16, v248
    v_and_b32 v17, 0xffff0000, v248
    v_lshlrev_b32 v18, 16, v249
    v_mfma_f32_16x16x32_bf16 a[28:31], v[216:219], v[100:103], a[28:31]
    v_and_b32 v19, 0xffff0000, v249
    v_lshlrev_b32 v20, 16, v250
    v_and_b32 v21, 0xffff0000, v250
    v_mfma_f32_16x16x32_bf16 v[48:51], a[168:171], a[88:91], 0
    v_lshlrev_b32 v22, 16, v251
    v_and_b32 v23, 0xffff0000, v251
    v_lshlrev_b32 v24, 16, v252
    v_mfma_f32_16x16x32_bf16 v[52:55], a[168:171], a[108:111], 0
    v_and_b32 v25, 0xffff0000, v252
    v_lshlrev_b32 v26, 16, v253
    v_and_b32 v27, 0xffff0000, v253
    v_mfma_f32_16x16x32_bf16 v[56:59], a[168:171], a[128:131], 0
    v_lshlrev_b32 v28, 16, v254
    v_and_b32 v29, 0xffff0000, v254
    v_lshlrev_b32 v30, 16, v255
    v_mfma_f32_16x16x32_bf16 v[60:63], a[168:171], a[148:151], 0
    v_and_b32 v31, 0xffff0000, v255
    v_cvt_pk_bf16_f32 v240, v240, v240
    v_cvt_pk_bf16_f32 v242, v242, v242
    v_mfma_f32_16x16x32_bf16 v[64:67], a[184:187], a[88:91], 0
    v_cvt_pk_bf16_f32 v244, v244, v244
    v_cvt_pk_bf16_f32 v246, v246, v246
    v_lshlrev_b32 v240, 16, v240
    v_mfma_f32_16x16x32_bf16 v[68:71], a[184:187], a[108:111], 0
    v_lshlrev_b32 v242, 16, v242
    v_lshlrev_b32 v244, 16, v244
    v_lshlrev_b32 v246, 16, v246
    v_mfma_f32_16x16x32_bf16 v[72:75], a[184:187], a[128:131], 0
    v_rcp_f32 v240, v240
    v_rcp_f32 v242, v242
    v_rcp_f32 v244, v244
    v_mfma_f32_16x16x32_bf16 v[76:79], a[184:187], a[148:151], 0
    v_rcp_f32 v246, v246
    s_nop 0
    v_mfma_f32_16x16x32_bf16 v[48:51], a[172:175], a[92:95], v[48:51]
    v_pk_mul_f32 v[16:17], v[16:17], v[240:241] op_sel_hi:[1,0]
    v_pk_mul_f32 v[18:19], v[18:19], v[240:241] op_sel_hi:[1,0]
    v_mfma_f32_16x16x32_bf16 v[52:55], a[172:175], a[112:115], v[52:55]
    v_pk_mul_f32 v[20:21], v[20:21], v[242:243] op_sel_hi:[1,0]
    v_pk_mul_f32 v[22:23], v[22:23], v[242:243] op_sel_hi:[1,0]
    v_mfma_f32_16x16x32_bf16 v[56:59], a[172:175], a[132:135], v[56:59]
    v_pk_mul_f32 v[24:25], v[24:25], v[244:245] op_sel_hi:[1,0]
    v_pk_mul_f32 v[26:27], v[26:27], v[244:245] op_sel_hi:[1,0]
    v_mfma_f32_16x16x32_bf16 v[60:63], a[172:175], a[152:155], v[60:63]
    v_pk_mul_f32 v[28:29], v[28:29], v[246:247] op_sel_hi:[1,0]
    v_pk_mul_f32 v[30:31], v[30:31], v[246:247] op_sel_hi:[1,0]
    v_mfma_f32_16x16x32_bf16 v[64:67], a[188:191], a[92:95], v[64:67]
    v_cvt_pk_bf16_f32 v80, v16, v17
    v_cvt_pk_bf16_f32 v81, v18, v19
    v_mfma_f32_16x16x32_bf16 v[68:71], a[188:191], a[112:115], v[68:71]
    v_cvt_pk_bf16_f32 v84, v20, v21
    v_cvt_pk_bf16_f32 v85, v22, v23
    v_mfma_f32_16x16x32_bf16 v[72:75], a[188:191], a[132:135], v[72:75]
    v_cvt_pk_bf16_f32 v88, v24, v25
    v_cvt_pk_bf16_f32 v89, v26, v27
    v_mfma_f32_16x16x32_bf16 v[76:79], a[188:191], a[152:155], v[76:79]
    v_cvt_pk_bf16_f32 v92, v28, v29
    v_cvt_pk_bf16_f32 v93, v30, v31
    s_waitcnt vmcnt(11)
    s_nop 1
    v_mfma_f32_16x16x32_bf16 a[48:51], v[216:219], v[104:107], a[48:51]
    v_mfma_f32_16x16x32_bf16 a[68:71], v[216:219], v[108:111], a[68:71]
    s_nop 7
    v_cvt_pk_bf16_f32 v240, v64, v64
    v_cvt_pk_bf16_f32 v242, v68, v68
    v_mfma_f32_16x16x32_bf16 a[12:15], v[220:223], v[96:99], a[12:15]
    v_cvt_pk_bf16_f32 v244, v72, v72
    v_cvt_pk_bf16_f32 v246, v76, v76
    v_cvt_pk_bf16_f32 v248, v48, v49
    v_mfma_f32_16x16x32_bf16 a[32:35], v[220:223], v[100:103], a[32:35]
    v_cvt_pk_bf16_f32 v249, v50, v51
    v_cvt_pk_bf16_f32 v250, v52, v53
    v_cvt_pk_bf16_f32 v251, v54, v55
    v_mfma_f32_16x16x32_bf16 a[52:55], v[220:223], v[104:107], a[52:55]
    v_cvt_pk_bf16_f32 v252, v56, v57
    v_cvt_pk_bf16_f32 v253, v58, v59
    v_cvt_pk_bf16_f32 v254, v60, v61
    v_mfma_f32_16x16x32_bf16 a[72:75], v[220:223], v[108:111], a[72:75]
    v_cvt_pk_bf16_f32 v255, v62, v63
    v_lshlrev_b32 v240, 16, v240
    v_lshlrev_b32 v242, 16, v242
    v_mfma_f32_16x16x32_bf16 a[16:19], v[224:227], v[96:99], a[16:19]
    v_lshlrev_b32 v244, 16, v244
    v_lshlrev_b32 v246, 16, v246
    v_add_f32 v240, s39, v240
    v_mfma_f32_16x16x32_bf16 a[36:39], v[224:227], v[100:103], a[36:39]
    v_add_f32 v242, s39, v242
    v_add_f32 v244, s39, v244
    v_add_f32 v246, s39, v246
    v_mfma_f32_16x16x32_bf16 a[56:59], v[224:227], v[104:107], a[56:59]
    v_lshlrev_b32 v48, 16, v248
    v_and_b32 v49, 0xffff0000, v248
    v_lshlrev_b32 v50, 16, v249
    v_mfma_f32_16x16x32_bf16 a[76:79], v[224:227], v[108:111], a[76:79]
    v_and_b32 v51, 0xffff0000, v249
    v_lshlrev_b32 v52, 16, v250
    v_and_b32 v53, 0xffff0000, v250
    v_mfma_f32_16x16x32_bf16 v[16:19], a[192:195], a[88:91], 0
    v_lshlrev_b32 v54, 16, v251
    v_and_b32 v55, 0xffff0000, v251
    v_lshlrev_b32 v56, 16, v252
    v_mfma_f32_16x16x32_bf16 v[20:23], a[192:195], a[108:111], 0
    v_and_b32 v57, 0xffff0000, v252
    v_lshlrev_b32 v58, 16, v253
    v_and_b32 v59, 0xffff0000, v253
    v_mfma_f32_16x16x32_bf16 v[24:27], a[192:195], a[128:131], 0
    v_lshlrev_b32 v60, 16, v254
    v_and_b32 v61, 0xffff0000, v254
    v_lshlrev_b32 v62, 16, v255
    v_mfma_f32_16x16x32_bf16 v[28:31], a[192:195], a[148:151], 0
    v_and_b32 v63, 0xffff0000, v255
    v_cvt_pk_bf16_f32 v240, v240, v240
    v_cvt_pk_bf16_f32 v242, v242, v242
    v_mfma_f32_16x16x32_bf16 v[32:35], a[208:211], a[88:91], 0
    v_cvt_pk_bf16_f32 v244, v244, v244
    v_cvt_pk_bf16_f32 v246, v246, v246
    v_lshlrev_b32 v240, 16, v240
    v_mfma_f32_16x16x32_bf16 v[36:39], a[208:211], a[108:111], 0
    v_lshlrev_b32 v242, 16, v242
    v_lshlrev_b32 v244, 16, v244
    v_lshlrev_b32 v246, 16, v246
    v_mfma_f32_16x16x32_bf16 v[40:43], a[208:211], a[128:131], 0
    v_rcp_f32 v240, v240
    v_rcp_f32 v242, v242
    v_rcp_f32 v244, v244
    v_mfma_f32_16x16x32_bf16 v[44:47], a[208:211], a[148:151], 0
    v_rcp_f32 v246, v246
    s_nop 0
    v_mfma_f32_16x16x32_bf16 v[16:19], a[196:199], a[92:95], v[16:19]
    v_pk_mul_f32 v[48:49], v[48:49], v[240:241] op_sel_hi:[1,0]
    v_pk_mul_f32 v[50:51], v[50:51], v[240:241] op_sel_hi:[1,0]
    v_mfma_f32_16x16x32_bf16 v[20:23], a[196:199], a[112:115], v[20:23]
    v_pk_mul_f32 v[52:53], v[52:53], v[242:243] op_sel_hi:[1,0]
    v_pk_mul_f32 v[54:55], v[54:55], v[242:243] op_sel_hi:[1,0]
    v_mfma_f32_16x16x32_bf16 v[24:27], a[196:199], a[132:135], v[24:27]
    v_pk_mul_f32 v[56:57], v[56:57], v[244:245] op_sel_hi:[1,0]
    v_pk_mul_f32 v[58:59], v[58:59], v[244:245] op_sel_hi:[1,0]
    v_mfma_f32_16x16x32_bf16 v[28:31], a[196:199], a[152:155], v[28:31]
    v_pk_mul_f32 v[60:61], v[60:61], v[246:247] op_sel_hi:[1,0]
    v_pk_mul_f32 v[62:63], v[62:63], v[246:247] op_sel_hi:[1,0]
    v_mfma_f32_16x16x32_bf16 v[32:35], a[212:215], a[92:95], v[32:35]
    v_cvt_pk_bf16_f32 v82, v48, v49
    v_cvt_pk_bf16_f32 v83, v50, v51
    v_mfma_f32_16x16x32_bf16 v[36:39], a[212:215], a[112:115], v[36:39]
    v_cvt_pk_bf16_f32 v86, v52, v53
    v_cvt_pk_bf16_f32 v87, v54, v55
    v_mfma_f32_16x16x32_bf16 v[40:43], a[212:215], a[132:135], v[40:43]
    v_cvt_pk_bf16_f32 v90, v56, v57
    v_cvt_pk_bf16_f32 v91, v58, v59
    v_mfma_f32_16x16x32_bf16 v[44:47], a[212:215], a[152:155], v[44:47]
    v_cvt_pk_bf16_f32 v94, v60, v61
    v_cvt_pk_bf16_f32 v95, v62, v63
    s_mov_b32 s35, 15360
    buffer_load_dwordx4 v[208:211], v14, s[56:59], s35 offen offset:0
    buffer_load_dwordx4 v[212:215], v14, s[56:59], s35 offen offset:1024
    buffer_load_dwordx4 v[216:219], v14, s[56:59], s35 offen offset:2048
    buffer_load_dwordx4 v[220:223], v14, s[56:59], s35 offen offset:3072
    buffer_load_dwordx4 v[224:227], v15, s[56:59], s35 offen
    s_waitcnt vmcnt(5)
    s_nop 1
    v_mfma_f32_16x16x32_bf16 a[0:3], v[188:191], v[80:83], a[0:3]
    v_mfma_f32_16x16x32_bf16 a[20:23], v[188:191], v[84:87], a[20:23]
    s_nop 7
    v_cvt_pk_bf16_f32 v240, v32, v32
    v_cvt_pk_bf16_f32 v242, v36, v36
    v_mfma_f32_16x16x32_bf16 a[40:43], v[188:191], v[88:91], a[40:43]
    v_cvt_pk_bf16_f32 v244, v40, v40
    v_cvt_pk_bf16_f32 v246, v44, v44
    v_cvt_pk_bf16_f32 v248, v16, v17
    v_mfma_f32_16x16x32_bf16 a[60:63], v[188:191], v[92:95], a[60:63]
    v_cvt_pk_bf16_f32 v249, v18, v19
    v_cvt_pk_bf16_f32 v250, v20, v21
    v_cvt_pk_bf16_f32 v251, v22, v23
    v_mfma_f32_16x16x32_bf16 a[4:7], v[192:195], v[80:83], a[4:7]
    v_cvt_pk_bf16_f32 v252, v24, v25
    v_cvt_pk_bf16_f32 v253, v26, v27
    v_cvt_pk_bf16_f32 v254, v28, v29
    v_mfma_f32_16x16x32_bf16 a[24:27], v[192:195], v[84:87], a[24:27]
    v_cvt_pk_bf16_f32 v255, v30, v31
    v_lshlrev_b32 v240, 16, v240
    v_lshlrev_b32 v242, 16, v242
    v_mfma_f32_16x16x32_bf16 a[44:47], v[192:195], v[88:91], a[44:47]
    v_lshlrev_b32 v244, 16, v244
    v_lshlrev_b32 v246, 16, v246
    v_add_f32 v240, s39, v240
    v_mfma_f32_16x16x32_bf16 a[64:67], v[192:195], v[92:95], a[64:67]
    v_add_f32 v242, s39, v242
    v_add_f32 v244, s39, v244
    v_add_f32 v246, s39, v246
    v_mfma_f32_16x16x32_bf16 a[8:11], v[196:199], v[80:83], a[8:11]
    v_lshlrev_b32 v16, 16, v248
    v_and_b32 v17, 0xffff0000, v248
    v_lshlrev_b32 v18, 16, v249
    v_mfma_f32_16x16x32_bf16 a[28:31], v[196:199], v[84:87], a[28:31]
    v_and_b32 v19, 0xffff0000, v249
    v_lshlrev_b32 v20, 16, v250
    v_and_b32 v21, 0xffff0000, v250
    v_mfma_f32_16x16x32_bf16 v[48:51], a[200:203], a[92:95], 0
    v_lshlrev_b32 v22, 16, v251
    v_and_b32 v23, 0xffff0000, v251
    v_lshlrev_b32 v24, 16, v252
    v_mfma_f32_16x16x32_bf16 v[52:55], a[200:203], a[112:115], 0
    v_and_b32 v25, 0xffff0000, v252
    v_lshlrev_b32 v26, 16, v253
    v_and_b32 v27, 0xffff0000, v253
    v_mfma_f32_16x16x32_bf16 v[56:59], a[200:203], a[132:135], 0
    v_lshlrev_b32 v28, 16, v254
    v_and_b32 v29, 0xffff0000, v254
    v_lshlrev_b32 v30, 16, v255
    v_mfma_f32_16x16x32_bf16 v[60:63], a[200:203], a[152:155], 0
    v_and_b32 v31, 0xffff0000, v255
    v_cvt_pk_bf16_f32 v240, v240, v240
    v_cvt_pk_bf16_f32 v242, v242, v242
    v_mfma_f32_16x16x32_bf16 v[64:67], a[216:219], a[92:95], 0
    v_cvt_pk_bf16_f32 v244, v244, v244
    v_cvt_pk_bf16_f32 v246, v246, v246
    v_lshlrev_b32 v240, 16, v240
    v_mfma_f32_16x16x32_bf16 v[68:71], a[216:219], a[112:115], 0
    v_lshlrev_b32 v242, 16, v242
    v_lshlrev_b32 v244, 16, v244
    v_lshlrev_b32 v246, 16, v246
    v_mfma_f32_16x16x32_bf16 v[72:75], a[216:219], a[132:135], 0
    v_rcp_f32 v240, v240
    v_rcp_f32 v242, v242
    v_rcp_f32 v244, v244
    v_mfma_f32_16x16x32_bf16 v[76:79], a[216:219], a[152:155], 0
    v_rcp_f32 v246, v246
    s_nop 0
    v_mfma_f32_16x16x32_bf16 v[48:51], a[204:207], a[96:99], v[48:51]
    v_pk_mul_f32 v[16:17], v[16:17], v[240:241] op_sel_hi:[1,0]
    v_pk_mul_f32 v[18:19], v[18:19], v[240:241] op_sel_hi:[1,0]
    v_mfma_f32_16x16x32_bf16 v[52:55], a[204:207], a[116:119], v[52:55]
    v_pk_mul_f32 v[20:21], v[20:21], v[242:243] op_sel_hi:[1,0]
    v_pk_mul_f32 v[22:23], v[22:23], v[242:243] op_sel_hi:[1,0]
    v_mfma_f32_16x16x32_bf16 v[56:59], a[204:207], a[136:139], v[56:59]
    v_pk_mul_f32 v[24:25], v[24:25], v[244:245] op_sel_hi:[1,0]
    v_pk_mul_f32 v[26:27], v[26:27], v[244:245] op_sel_hi:[1,0]
    v_mfma_f32_16x16x32_bf16 v[60:63], a[204:207], a[156:159], v[60:63]
    v_pk_mul_f32 v[28:29], v[28:29], v[246:247] op_sel_hi:[1,0]
    v_pk_mul_f32 v[30:31], v[30:31], v[246:247] op_sel_hi:[1,0]
    v_mfma_f32_16x16x32_bf16 v[64:67], a[220:223], a[96:99], v[64:67]
    v_cvt_pk_bf16_f32 v96, v16, v17
    v_cvt_pk_bf16_f32 v97, v18, v19
    v_mfma_f32_16x16x32_bf16 v[68:71], a[220:223], a[116:119], v[68:71]
    v_cvt_pk_bf16_f32 v100, v20, v21
    v_cvt_pk_bf16_f32 v101, v22, v23
    v_mfma_f32_16x16x32_bf16 v[72:75], a[220:223], a[136:139], v[72:75]
    v_cvt_pk_bf16_f32 v104, v24, v25
    v_cvt_pk_bf16_f32 v105, v26, v27
    v_mfma_f32_16x16x32_bf16 v[76:79], a[220:223], a[156:159], v[76:79]
    v_cvt_pk_bf16_f32 v108, v28, v29
    v_cvt_pk_bf16_f32 v109, v30, v31
    s_nop 1
    v_mfma_f32_16x16x32_bf16 a[48:51], v[196:199], v[88:91], a[48:51]
    v_mfma_f32_16x16x32_bf16 a[68:71], v[196:199], v[92:95], a[68:71]
    s_nop 7
    v_cvt_pk_bf16_f32 v240, v64, v64
    v_cvt_pk_bf16_f32 v242, v68, v68
    v_mfma_f32_16x16x32_bf16 a[12:15], v[200:203], v[80:83], a[12:15]
    v_cvt_pk_bf16_f32 v244, v72, v72
    v_cvt_pk_bf16_f32 v246, v76, v76
    v_cvt_pk_bf16_f32 v248, v48, v49
    v_mfma_f32_16x16x32_bf16 a[32:35], v[200:203], v[84:87], a[32:35]
    v_cvt_pk_bf16_f32 v249, v50, v51
    v_cvt_pk_bf16_f32 v250, v52, v53
    v_cvt_pk_bf16_f32 v251, v54, v55
    v_mfma_f32_16x16x32_bf16 a[52:55], v[200:203], v[88:91], a[52:55]
    v_cvt_pk_bf16_f32 v252, v56, v57
    v_cvt_pk_bf16_f32 v253, v58, v59
    v_cvt_pk_bf16_f32 v254, v60, v61
    v_mfma_f32_16x16x32_bf16 a[72:75], v[200:203], v[92:95], a[72:75]
    v_cvt_pk_bf16_f32 v255, v62, v63
    v_lshlrev_b32 v240, 16, v240
    v_lshlrev_b32 v242, 16, v242
    v_mfma_f32_16x16x32_bf16 a[16:19], v[204:207], v[80:83], a[16:19]
    v_lshlrev_b32 v244, 16, v244
    v_lshlrev_b32 v246, 16, v246
    v_add_f32 v240, s39, v240
    v_mfma_f32_16x16x32_bf16 a[36:39], v[204:207], v[84:87], a[36:39]
    v_add_f32 v242, s39, v242
    v_add_f32 v244, s39, v244
    v_add_f32 v246, s39, v246
    v_mfma_f32_16x16x32_bf16 a[56:59], v[204:207], v[88:91], a[56:59]
    v_lshlrev_b32 v48, 16, v248
    v_and_b32 v49, 0xffff0000, v248
    v_lshlrev_b32 v50, 16, v249
    v_mfma_f32_16x16x32_bf16 a[76:79], v[204:207], v[92:95], a[76:79]
    v_and_b32 v51, 0xffff0000, v249
    v_lshlrev_b32 v52, 16, v250
    v_and_b32 v53, 0xffff0000, v250
    v_mfma_f32_16x16x32_bf16 v[16:19], v[124:127], a[92:95], 0
    v_lshlrev_b32 v54, 16, v251
    v_and_b32 v55, 0xffff0000, v251
    v_lshlrev_b32 v56, 16, v252
    v_mfma_f32_16x16x32_bf16 v[20:23], v[124:127], a[112:115], 0
    v_and_b32 v57, 0xffff0000, v252
    v_lshlrev_b32 v58, 16, v253
    v_and_b32 v59, 0xffff0000, v253
    v_mfma_f32_16x16x32_bf16 v[24:27], v[124:127], a[132:135], 0
    v_lshlrev_b32 v60, 16, v254
    v_and_b32 v61, 0xffff0000, v254
    v_lshlrev_b32 v62, 16, v255
    v_mfma_f32_16x16x32_bf16 v[28:31], v[124:127], a[152:155], 0
    v_and_b32 v63, 0xffff0000, v255
    v_cvt_pk_bf16_f32 v240, v240, v240
    v_cvt_pk_bf16_f32 v242, v242, v242
    v_mfma_f32_16x16x32_bf16 v[32:35], v[140:143], a[92:95], 0
    v_cvt_pk_bf16_f32 v244, v244, v244
    v_cvt_pk_bf16_f32 v246, v246, v246
    v_lshlrev_b32 v240, 16, v240
    v_mfma_f32_16x16x32_bf16 v[36:39], v[140:143], a[112:115], 0
    v_lshlrev_b32 v242, 16, v242
    v_lshlrev_b32 v244, 16, v244
    v_lshlrev_b32 v246, 16, v246
    v_mfma_f32_16x16x32_bf16 v[40:43], v[140:143], a[132:135], 0
    v_rcp_f32 v240, v240
    v_rcp_f32 v242, v242
    v_rcp_f32 v244, v244
    v_mfma_f32_16x16x32_bf16 v[44:47], v[140:143], a[152:155], 0
    v_rcp_f32 v246, v246
    s_nop 0
    v_mfma_f32_16x16x32_bf16 v[16:19], v[128:131], a[96:99], v[16:19]
    v_pk_mul_f32 v[48:49], v[48:49], v[240:241] op_sel_hi:[1,0]
    v_pk_mul_f32 v[50:51], v[50:51], v[240:241] op_sel_hi:[1,0]
    v_mfma_f32_16x16x32_bf16 v[20:23], v[128:131], a[116:119], v[20:23]
    v_pk_mul_f32 v[52:53], v[52:53], v[242:243] op_sel_hi:[1,0]
    v_pk_mul_f32 v[54:55], v[54:55], v[242:243] op_sel_hi:[1,0]
    v_mfma_f32_16x16x32_bf16 v[24:27], v[128:131], a[136:139], v[24:27]
    v_pk_mul_f32 v[56:57], v[56:57], v[244:245] op_sel_hi:[1,0]
    v_pk_mul_f32 v[58:59], v[58:59], v[244:245] op_sel_hi:[1,0]
    v_mfma_f32_16x16x32_bf16 v[28:31], v[128:131], a[156:159], v[28:31]
    v_pk_mul_f32 v[60:61], v[60:61], v[246:247] op_sel_hi:[1,0]
    v_pk_mul_f32 v[62:63], v[62:63], v[246:247] op_sel_hi:[1,0]
    v_mfma_f32_16x16x32_bf16 v[32:35], v[144:147], a[96:99], v[32:35]
    v_cvt_pk_bf16_f32 v98, v48, v49
    v_cvt_pk_bf16_f32 v99, v50, v51
    v_mfma_f32_16x16x32_bf16 v[36:39], v[144:147], a[116:119], v[36:39]
    v_cvt_pk_bf16_f32 v102, v52, v53
    v_cvt_pk_bf16_f32 v103, v54, v55
    v_mfma_f32_16x16x32_bf16 v[40:43], v[144:147], a[136:139], v[40:43]
    v_cvt_pk_bf16_f32 v106, v56, v57
    v_cvt_pk_bf16_f32 v107, v58, v59
    v_mfma_f32_16x16x32_bf16 v[44:47], v[144:147], a[156:159], v[44:47]
    v_cvt_pk_bf16_f32 v110, v60, v61
    v_cvt_pk_bf16_f32 v111, v62, v63
    s_mov_b32 s35, 20480
    buffer_load_dwordx4 v[188:191], v14, s[56:59], s35 offen offset:0
    buffer_load_dwordx4 v[192:195], v14, s[56:59], s35 offen offset:1024
    buffer_load_dwordx4 v[196:199], v14, s[56:59], s35 offen offset:2048
    buffer_load_dwordx4 v[200:203], v14, s[56:59], s35 offen offset:3072
    buffer_load_dwordx4 v[204:207], v15, s[56:59], s35 offen
    s_waitcnt vmcnt(5)
    s_nop 1
    v_mfma_f32_16x16x32_bf16 a[0:3], v[208:211], v[96:99], a[0:3]
    v_mfma_f32_16x16x32_bf16 a[20:23], v[208:211], v[100:103], a[20:23]
    s_nop 7
    v_cvt_pk_bf16_f32 v240, v32, v32
    v_cvt_pk_bf16_f32 v242, v36, v36
    v_cvt_pk_bf16_f32 v244, v40, v40
    v_mfma_f32_16x16x32_bf16 a[40:43], v[208:211], v[104:107], a[40:43]
    v_cvt_pk_bf16_f32 v246, v44, v44
    v_cvt_pk_bf16_f32 v248, v16, v17
    v_cvt_pk_bf16_f32 v249, v18, v19
    v_cvt_pk_bf16_f32 v250, v20, v21
    v_mfma_f32_16x16x32_bf16 a[60:63], v[208:211], v[108:111], a[60:63]
    v_cvt_pk_bf16_f32 v251, v22, v23
    v_cvt_pk_bf16_f32 v252, v24, v25
    v_cvt_pk_bf16_f32 v253, v26, v27
    v_cvt_pk_bf16_f32 v254, v28, v29
    v_mfma_f32_16x16x32_bf16 a[4:7], v[212:215], v[96:99], a[4:7]
    v_cvt_pk_bf16_f32 v255, v30, v31
    v_lshlrev_b32 v240, 16, v240
    v_lshlrev_b32 v242, 16, v242
    v_lshlrev_b32 v244, 16, v244
    v_mfma_f32_16x16x32_bf16 a[24:27], v[212:215], v[100:103], a[24:27]
    v_lshlrev_b32 v246, 16, v246
    v_add_f32 v240, s39, v240
    v_add_f32 v242, s39, v242
    v_add_f32 v244, s39, v244
    v_mfma_f32_16x16x32_bf16 a[44:47], v[212:215], v[104:107], a[44:47]
    v_add_f32 v246, s39, v246
    v_lshlrev_b32 v16, 16, v248
    v_and_b32 v17, 0xffff0000, v248
    v_lshlrev_b32 v18, 16, v249
    v_mfma_f32_16x16x32_bf16 a[64:67], v[212:215], v[108:111], a[64:67]
    v_and_b32 v19, 0xffff0000, v249
    v_lshlrev_b32 v20, 16, v250
    v_and_b32 v21, 0xffff0000, v250
    v_lshlrev_b32 v22, 16, v251
    v_mfma_f32_16x16x32_bf16 a[8:11], v[216:219], v[96:99], a[8:11]
    v_and_b32 v23, 0xffff0000, v251
    v_lshlrev_b32 v24, 16, v252
    v_and_b32 v25, 0xffff0000, v252
    v_lshlrev_b32 v26, 16, v253
    v_mfma_f32_16x16x32_bf16 a[28:31], v[216:219], v[100:103], a[28:31]
    v_and_b32 v27, 0xffff0000, v253
    v_lshlrev_b32 v28, 16, v254
    v_and_b32 v29, 0xffff0000, v254
    v_lshlrev_b32 v30, 16, v255
    v_mfma_f32_16x16x32_bf16 v[48:51], v[132:135], a[96:99], 0
    v_and_b32 v31, 0xffff0000, v255
    v_cvt_pk_bf16_f32 v240, v240, v240
    v_cvt_pk_bf16_f32 v242, v242, v242
    v_cvt_pk_bf16_f32 v244, v244, v244
    v_mfma_f32_16x16x32_bf16 v[52:55], v[132:135], a[116:119], 0
    v_cvt_pk_bf16_f32 v246, v246, v246
    v_lshlrev_b32 v240, 16, v240
    v_lshlrev_b32 v242, 16, v242
    v_lshlrev_b32 v244, 16, v244
    v_mfma_f32_16x16x32_bf16 v[56:59], v[132:135], a[136:139], 0
    v_lshlrev_b32 v246, 16, v246
    v_rcp_f32 v240, v240
    v_rcp_f32 v242, v242
    v_rcp_f32 v244, v244
    v_mfma_f32_16x16x32_bf16 v[60:63], v[132:135], a[156:159], 0
    v_rcp_f32 v246, v246
    s_nop 0
    v_pk_mul_f32 v[16:17], v[16:17], v[240:241] op_sel_hi:[1,0]
    v_pk_mul_f32 v[18:19], v[18:19], v[240:241] op_sel_hi:[1,0]
    v_mfma_f32_16x16x32_bf16 v[64:67], v[148:151], a[96:99], 0
    v_pk_mul_f32 v[20:21], v[20:21], v[242:243] op_sel_hi:[1,0]
    v_pk_mul_f32 v[22:23], v[22:23], v[242:243] op_sel_hi:[1,0]
    v_pk_mul_f32 v[24:25], v[24:25], v[244:245] op_sel_hi:[1,0]
    v_pk_mul_f32 v[26:27], v[26:27], v[244:245] op_sel_hi:[1,0]
    v_mfma_f32_16x16x32_bf16 v[68:71], v[148:151], a[116:119], 0
    v_pk_mul_f32 v[28:29], v[28:29], v[246:247] op_sel_hi:[1,0]
    v_pk_mul_f32 v[30:31], v[30:31], v[246:247] op_sel_hi:[1,0]
    v_cvt_pk_bf16_f32 v80, v16, v17
    v_cvt_pk_bf16_f32 v81, v18, v19
    v_mfma_f32_16x16x32_bf16 v[72:75], v[148:151], a[136:139], 0
    v_cvt_pk_bf16_f32 v84, v20, v21
    v_cvt_pk_bf16_f32 v85, v22, v23
    v_cvt_pk_bf16_f32 v88, v24, v25
    v_mfma_f32_16x16x32_bf16 v[76:79], v[148:151], a[156:159], 0
    v_cvt_pk_bf16_f32 v89, v26, v27
    v_cvt_pk_bf16_f32 v92, v28, v29
    v_cvt_pk_bf16_f32 v93, v30, v31
    s_nop 1
    v_mfma_f32_16x16x32_bf16 a[48:51], v[216:219], v[104:107], a[48:51]
    v_mfma_f32_16x16x32_bf16 a[68:71], v[216:219], v[108:111], a[68:71]
    s_nop 7
    v_cvt_pk_bf16_f32 v240, v64, v64
    v_cvt_pk_bf16_f32 v242, v68, v68
    v_cvt_pk_bf16_f32 v244, v72, v72
    v_cvt_pk_bf16_f32 v246, v76, v76
    v_cvt_pk_bf16_f32 v248, v48, v49
    v_cvt_pk_bf16_f32 v249, v50, v51
    v_cvt_pk_bf16_f32 v250, v52, v53
    v_mfma_f32_16x16x32_bf16 a[12:15], v[220:223], v[96:99], a[12:15]
    v_cvt_pk_bf16_f32 v251, v54, v55
    v_cvt_pk_bf16_f32 v252, v56, v57
    v_cvt_pk_bf16_f32 v253, v58, v59
    v_cvt_pk_bf16_f32 v254, v60, v61
    v_cvt_pk_bf16_f32 v255, v62, v63
    v_lshlrev_b32 v240, 16, v240
    v_lshlrev_b32 v242, 16, v242
    v_lshlrev_b32 v244, 16, v244
    v_mfma_f32_16x16x32_bf16 a[32:35], v[220:223], v[100:103], a[32:35]
    v_lshlrev_b32 v246, 16, v246
    v_add_f32 v240, s39, v240
    v_add_f32 v242, s39, v242
    v_add_f32 v244, s39, v244
    v_add_f32 v246, s39, v246
    v_lshlrev_b32 v48, 16, v248
    v_and_b32 v49, 0xffff0000, v248
    v_lshlrev_b32 v50, 16, v249
    v_mfma_f32_16x16x32_bf16 a[52:55], v[220:223], v[104:107], a[52:55]
    v_and_b32 v51, 0xffff0000, v249
    v_lshlrev_b32 v52, 16, v250
    v_and_b32 v53, 0xffff0000, v250
    v_lshlrev_b32 v54, 16, v251
    v_and_b32 v55, 0xffff0000, v251
    v_lshlrev_b32 v56, 16, v252
    v_and_b32 v57, 0xffff0000, v252
    v_mfma_f32_16x16x32_bf16 a[72:75], v[220:223], v[108:111], a[72:75]
    v_lshlrev_b32 v58, 16, v253
    v_and_b32 v59, 0xffff0000, v253
    v_lshlrev_b32 v60, 16, v254
    v_and_b32 v61, 0xffff0000, v254
    v_lshlrev_b32 v62, 16, v255
    v_and_b32 v63, 0xffff0000, v255
    v_cvt_pk_bf16_f32 v240, v240, v240
    v_mfma_f32_16x16x32_bf16 a[16:19], v[224:227], v[96:99], a[16:19]
    v_cvt_pk_bf16_f32 v242, v242, v242
    v_cvt_pk_bf16_f32 v244, v244, v244
    v_cvt_pk_bf16_f32 v246, v246, v246
    v_lshlrev_b32 v240, 16, v240
    v_lshlrev_b32 v242, 16, v242
    v_lshlrev_b32 v244, 16, v244
    v_lshlrev_b32 v246, 16, v246
    v_mfma_f32_16x16x32_bf16 a[36:39], v[224:227], v[100:103], a[36:39]
    v_rcp_f32 v240, v240
    v_rcp_f32 v242, v242
    v_rcp_f32 v244, v244
    v_rcp_f32 v246, v246
    s_nop 0
    v_pk_mul_f32 v[48:49], v[48:49], v[240:241] op_sel_hi:[1,0]
    v_pk_mul_f32 v[50:51], v[50:51], v[240:241] op_sel_hi:[1,0]
    v_mfma_f32_16x16x32_bf16 a[56:59], v[224:227], v[104:107], a[56:59]
    v_pk_mul_f32 v[52:53], v[52:53], v[242:243] op_sel_hi:[1,0]
    v_pk_mul_f32 v[54:55], v[54:55], v[242:243] op_sel_hi:[1,0]
    v_pk_mul_f32 v[56:57], v[56:57], v[244:245] op_sel_hi:[1,0]
    v_pk_mul_f32 v[58:59], v[58:59], v[244:245] op_sel_hi:[1,0]
    v_pk_mul_f32 v[60:61], v[60:61], v[246:247] op_sel_hi:[1,0]
    v_pk_mul_f32 v[62:63], v[62:63], v[246:247] op_sel_hi:[1,0]
    v_cvt_pk_bf16_f32 v82, v48, v49
    v_mfma_f32_16x16x32_bf16 a[76:79], v[224:227], v[108:111], a[76:79]
    v_cvt_pk_bf16_f32 v83, v50, v51
    v_cvt_pk_bf16_f32 v86, v52, v53
    v_cvt_pk_bf16_f32 v87, v54, v55
    v_cvt_pk_bf16_f32 v90, v56, v57
    v_cvt_pk_bf16_f32 v91, v58, v59
    v_cvt_pk_bf16_f32 v94, v60, v61
    v_cvt_pk_bf16_f32 v95, v62, v63
    s_waitcnt vmcnt(0)
    s_nop 1
    v_mfma_f32_16x16x32_bf16 a[0:3], v[188:191], v[80:83], a[0:3]
    v_mfma_f32_16x16x32_bf16 a[20:23], v[188:191], v[84:87], a[20:23]
    v_mfma_f32_16x16x32_bf16 a[40:43], v[188:191], v[88:91], a[40:43]
    v_mfma_f32_16x16x32_bf16 a[60:63], v[188:191], v[92:95], a[60:63]
    v_mfma_f32_16x16x32_bf16 a[4:7], v[192:195], v[80:83], a[4:7]
    v_mfma_f32_16x16x32_bf16 a[24:27], v[192:195], v[84:87], a[24:27]
    v_mfma_f32_16x16x32_bf16 a[44:47], v[192:195], v[88:91], a[44:47]
    v_mfma_f32_16x16x32_bf16 a[64:67], v[192:195], v[92:95], a[64:67]
    v_mfma_f32_16x16x32_bf16 a[8:11], v[196:199], v[80:83], a[8:11]
    v_mfma_f32_16x16x32_bf16 a[28:31], v[196:199], v[84:87], a[28:31]
    v_mfma_f32_16x16x32_bf16 a[48:51], v[196:199], v[88:91], a[48:51]
    v_mfma_f32_16x16x32_bf16 a[68:71], v[196:199], v[92:95], a[68:71]
    v_mfma_f32_16x16x32_bf16 a[12:15], v[200:203], v[80:83], a[12:15]
    v_mfma_f32_16x16x32_bf16 a[32:35], v[200:203], v[84:87], a[32:35]
    v_mfma_f32_16x16x32_bf16 a[52:55], v[200:203], v[88:91], a[52:55]
    v_mfma_f32_16x16x32_bf16 a[72:75], v[200:203], v[92:95], a[72:75]
    v_mfma_f32_16x16x32_bf16 a[16:19], v[204:207], v[80:83], a[16:19]
    v_mfma_f32_16x16x32_bf16 a[36:39], v[204:207], v[84:87], a[36:39]
    v_mfma_f32_16x16x32_bf16 a[56:59], v[204:207], v[88:91], a[56:59]
    v_mfma_f32_16x16x32_bf16 a[76:79], v[204:207], v[92:95], a[76:79]
    s_lshl_b32 s33, s28, 2
    s_add_u32 s33, s33, s30
    s_lshl_b32 s34, s33, 4
    v_and_b32 v15, 15, v1
    v_add_u32 v15, s34, v15
    v_lshlrev_b32 v123, 2, v15
    s_mov_b32 s34, 0
    buffer_load_dword v238, v123, s[44:47], s34 offen
    s_add_u32 s34, s34, 8192
    buffer_load_dword v239, v123, s[44:47], s34 offen
    s_add_u32 s34, s34, 8192
    buffer_load_dword v114, v123, s[44:47], s34 offen
    s_add_u32 s34, s34, 8192
    buffer_load_dword v115, v123, s[44:47], s34 offen
    s_add_u32 s34, s34, 8192
    buffer_load_dword v116, v123, s[44:47], s34 offen
    s_add_u32 s34, s34, 8192
    buffer_load_dword v117, v123, s[44:47], s34 offen
    s_add_u32 s34, s34, 8192
    buffer_load_dword v118, v123, s[44:47], s34 offen
    s_add_u32 s34, s34, 8192
    buffer_load_dword v119, v123, s[44:47], s34 offen
    s_add_u32 s34, s34, 8192
    v_mul_u32_u24 v15, 1280, v15
    v_lshrrev_b32 v125, 4, v1
    v_lshlrev_b32 v125, 3, v125
    v_add_u32 v15, v15, v125
    s_mul_i32 s34, s29, 160
    v_add_u32 v124, s34, v15
    s_barrier
    s_nop 7
    s_nop 1
    s_mul_i32 s33, s30, 20480
    v_lshlrev_b32 v2, 4, v1
    v_add_u32 v3, s33, v2
    ds_write_b128 v3, a[0:3] offset:0
    ds_write_b128 v3, a[4:7] offset:1024
    ds_write_b128 v3, a[8:11] offset:2048
    ds_write_b128 v3, a[12:15] offset:3072
    ds_write_b128 v3, a[16:19] offset:4096
    ds_write_b128 v3, a[20:23] offset:5120
    ds_write_b128 v3, a[24:27] offset:6144
    ds_write_b128 v3, a[28:31] offset:7168
    ds_write_b128 v3, a[32:35] offset:8192
    ds_write_b128 v3, a[36:39] offset:9216
    ds_write_b128 v3, a[40:43] offset:10240
    ds_write_b128 v3, a[44:47] offset:11264
    ds_write_b128 v3, a[48:51] offset:12288
    ds_write_b128 v3, a[52:55] offset:13312
    ds_write_b128 v3, a[56:59] offset:14336
    ds_write_b128 v3, a[60:63] offset:15360
    ds_write_b128 v3, a[64:67] offset:16384
    ds_write_b128 v3, a[68:71] offset:17408
    ds_write_b128 v3, a[72:75] offset:18432
    ds_write_b128 v3, a[76:79] offset:19456
    s_waitcnt lgkmcnt(0)
    s_barrier
    s_mul_i32 s33, s30, 5120
    v_add_u32 v3, s33, v2
    v_add_u32 v4, 40960, v3
    ds_read_b128 v[32:35], v3 offset:0
    ds_read_b128 v[36:39], v3 offset:1024
    ds_read_b128 v[40:43], v3 offset:2048
    ds_read_b128 v[44:47], v3 offset:3072
    ds_read_b128 v[48:51], v3 offset:4096
    ds_read_b128 v[52:55], v3 offset:20480
    ds_read_b128 v[56:59], v3 offset:21504
    ds_read_b128 v[60:63], v3 offset:22528
    ds_read_b128 v[64:67], v3 offset:23552
    ds_read_b128 v[68:71], v3 offset:24576
    s_waitcnt lgkmcnt(0)
    ds_read_b128 v[72:75], v4 offset:0
    ds_read_b128 v[76:79], v4 offset:1024
    ds_read_b128 v[80:83], v4 offset:2048
    ds_read_b128 v[84:87], v4 offset:3072
    ds_read_b128 v[88:91], v4 offset:4096
    ds_read_b128 v[92:95], v4 offset:20480
    ds_read_b128 v[96:99], v4 offset:21504
    ds_read_b128 v[100:103], v4 offset:22528
    ds_read_b128 v[104:107], v4 offset:23552
    ds_read_b128 v[108:111], v4 offset:24576
    s_waitcnt lgkmcnt(0)
    v_pk_add_f32 v[32:33], v[32:33], v[52:53]
    v_pk_add_f32 v[72:73], v[72:73], v[92:93]
    v_pk_add_f32 v[34:35], v[34:35], v[54:55]
    v_pk_add_f32 v[74:75], v[74:75], v[94:95]
    v_pk_add_f32 v[36:37], v[36:37], v[56:57]
    v_pk_add_f32 v[76:77], v[76:77], v[96:97]
    v_pk_add_f32 v[38:39], v[38:39], v[58:59]
    v_pk_add_f32 v[78:79], v[78:79], v[98:99]
    v_pk_add_f32 v[40:41], v[40:41], v[60:61]
    v_pk_add_f32 v[80:81], v[80:81], v[100:101]
    v_pk_add_f32 v[42:43], v[42:43], v[62:63]
    v_pk_add_f32 v[82:83], v[82:83], v[102:103]
    v_pk_add_f32 v[44:45], v[44:45], v[64:65]
    v_pk_add_f32 v[84:85], v[84:85], v[104:105]
    v_pk_add_f32 v[46:47], v[46:47], v[66:67]
    v_pk_add_f32 v[86:87], v[86:87], v[106:107]
    v_pk_add_f32 v[48:49], v[48:49], v[68:69]
    v_pk_add_f32 v[88:89], v[88:89], v[108:109]
    v_pk_add_f32 v[50:51], v[50:51], v[70:71]
    v_pk_add_f32 v[90:91], v[90:91], v[110:111]
    v_pk_add_f32 v[8:9], v[32:33], v[72:73]
    v_pk_add_f32 v[10:11], v[34:35], v[74:75]
    v_pk_add_f32 v[12:13], v[36:37], v[76:77]
    v_pk_add_f32 v[14:15], v[38:39], v[78:79]
    v_pk_add_f32 v[16:17], v[40:41], v[80:81]
    v_pk_add_f32 v[18:19], v[42:43], v[82:83]
    v_pk_add_f32 v[20:21], v[44:45], v[84:85]
    v_pk_add_f32 v[22:23], v[46:47], v[86:87]
    v_pk_add_f32 v[24:25], v[48:49], v[88:89]
    v_pk_add_f32 v[26:27], v[50:51], v[90:91]
    s_waitcnt vmcnt(0)
    v_add_f32 v238, v238, v239
    v_add_f32 v114, v114, v115
    v_add_f32 v116, v116, v117
    v_add_f32 v118, v118, v119
    s_mov_b32 s38, 0x3fb8aa3b
    v_add_f32 v238, v238, v114
    v_add_f32 v116, v116, v118
    s_nop 0
    v_add_f32 v122, v238, v116
    s_nop 0
    v_cvt_pk_bf16_f32 v122, v122, v122
    s_nop 0
    v_lshlrev_b32 v122, 16, v122
    s_nop 0
    v_mul_f32 v122, s38, v122
    s_nop 0
    v_sub_f32 v122, 0, v122
    s_nop 0
    v_exp_f32 v122, v122
    s_nop 1
    v_add_f32 v122, 1.0, v122
    s_nop 0
    v_rcp_f32 v122, v122
    s_nop 1
    v_cvt_pk_bf16_f32 v122, v122, v122
    s_nop 0
    v_lshlrev_b32 v122, 16, v122
    s_nop 0
    v_sub_f32 v123, 1.0, v122
    v_cvt_pk_bf16_f32 v32, v8, v9
    v_cvt_pk_bf16_f32 v33, v10, v11
    v_cvt_pk_bf16_f32 v34, v12, v13
    v_cvt_pk_bf16_f32 v35, v14, v15
    v_cvt_pk_bf16_f32 v36, v16, v17
    v_cvt_pk_bf16_f32 v37, v18, v19
    v_cvt_pk_bf16_f32 v38, v20, v21
    v_cvt_pk_bf16_f32 v39, v22, v23
    v_cvt_pk_bf16_f32 v40, v24, v25
    v_cvt_pk_bf16_f32 v41, v26, v27
    v_cvt_pk_bf16_f32 v123, v123, v123
    v_lshlrev_b32 v8, 16, v32
    v_and_b32 v9, 0xffff0000, v32
    v_lshlrev_b32 v10, 16, v33
    v_and_b32 v11, 0xffff0000, v33
    v_lshlrev_b32 v44, 16, v228
    v_and_b32 v45, 0xffff0000, v228
    v_lshlrev_b32 v46, 16, v229
    v_and_b32 v47, 0xffff0000, v229
    v_lshlrev_b32 v12, 16, v34
    v_and_b32 v13, 0xffff0000, v34
    v_lshlrev_b32 v14, 16, v35
    v_and_b32 v15, 0xffff0000, v35
    v_lshlrev_b32 v48, 16, v230
    v_and_b32 v49, 0xffff0000, v230
    v_lshlrev_b32 v50, 16, v231
    v_and_b32 v51, 0xffff0000, v231
    v_lshlrev_b32 v16, 16, v36
    v_and_b32 v17, 0xffff0000, v36
    v_lshlrev_b32 v18, 16, v37
    v_and_b32 v19, 0xffff0000, v37
    v_lshlrev_b32 v52, 16, v232
    v_and_b32 v53, 0xffff0000, v232
    v_lshlrev_b32 v54, 16, v233
    v_and_b32 v55, 0xffff0000, v233
    v_lshlrev_b32 v20, 16, v38
    v_and_b32 v21, 0xffff0000, v38
    v_lshlrev_b32 v22, 16, v39
    v_and_b32 v23, 0xffff0000, v39
    v_lshlrev_b32 v56, 16, v234
    v_and_b32 v57, 0xffff0000, v234
    v_lshlrev_b32 v58, 16, v235
    v_and_b32 v59, 0xffff0000, v235
    v_lshlrev_b32 v24, 16, v40
    v_and_b32 v25, 0xffff0000, v40
    v_lshlrev_b32 v26, 16, v41
    v_and_b32 v27, 0xffff0000, v41
    v_lshlrev_b32 v60, 16, v236
    v_and_b32 v61, 0xffff0000, v236
    v_lshlrev_b32 v62, 16, v237
    v_and_b32 v63, 0xffff0000, v237
    v_lshlrev_b32 v123, 16, v123
    v_mul_f32 v8, v122, v8
    v_mul_f32 v9, v122, v9
    v_mul_f32 v10, v122, v10
    v_mul_f32 v11, v122, v11
    v_mul_f32 v12, v122, v12
    v_mul_f32 v13, v122, v13
    v_mul_f32 v14, v122, v14
    v_mul_f32 v15, v122, v15
    v_mul_f32 v16, v122, v16
    v_mul_f32 v17, v122, v17
    v_mul_f32 v18, v122, v18
    v_mul_f32 v19, v122, v19
    v_mul_f32 v20, v122, v20
    v_mul_f32 v21, v122, v21
    v_mul_f32 v22, v122, v22
    v_mul_f32 v23, v122, v23
    v_mul_f32 v24, v122, v24
    v_mul_f32 v25, v122, v25
    v_mul_f32 v26, v122, v26
    v_mul_f32 v27, v122, v27
    v_mul_f32 v44, v123, v44
    v_mul_f32 v45, v123, v45
    v_mul_f32 v46, v123, v46
    v_mul_f32 v47, v123, v47
    v_mul_f32 v48, v123, v48
    v_mul_f32 v49, v123, v49
    v_mul_f32 v50, v123, v50
    v_mul_f32 v51, v123, v51
    v_mul_f32 v52, v123, v52
    v_mul_f32 v53, v123, v53
    v_mul_f32 v54, v123, v54
    v_mul_f32 v55, v123, v55
    v_mul_f32 v56, v123, v56
    v_mul_f32 v57, v123, v57
    v_mul_f32 v58, v123, v58
    v_mul_f32 v59, v123, v59
    v_mul_f32 v60, v123, v60
    v_mul_f32 v61, v123, v61
    v_mul_f32 v62, v123, v62
    v_mul_f32 v63, v123, v63
    v_cvt_pk_bf16_f32 v32, v8, v9
    v_cvt_pk_bf16_f32 v33, v10, v11
    v_cvt_pk_bf16_f32 v112, v44, v45
    v_cvt_pk_bf16_f32 v113, v46, v47
    v_cvt_pk_bf16_f32 v34, v12, v13
    v_cvt_pk_bf16_f32 v35, v14, v15
    v_cvt_pk_bf16_f32 v114, v48, v49
    v_cvt_pk_bf16_f32 v115, v50, v51
    v_cvt_pk_bf16_f32 v36, v16, v17
    v_cvt_pk_bf16_f32 v37, v18, v19
    v_cvt_pk_bf16_f32 v116, v52, v53
    v_cvt_pk_bf16_f32 v117, v54, v55
    v_cvt_pk_bf16_f32 v38, v20, v21
    v_cvt_pk_bf16_f32 v39, v22, v23
    v_cvt_pk_bf16_f32 v118, v56, v57
    v_cvt_pk_bf16_f32 v119, v58, v59
    v_cvt_pk_bf16_f32 v40, v24, v25
    v_cvt_pk_bf16_f32 v41, v26, v27
    v_cvt_pk_bf16_f32 v120, v60, v61
    v_cvt_pk_bf16_f32 v121, v62, v63
    v_lshlrev_b32 v8, 16, v32
    v_and_b32 v9, 0xffff0000, v32
    v_lshlrev_b32 v10, 16, v33
    v_and_b32 v11, 0xffff0000, v33
    v_lshlrev_b32 v44, 16, v112
    v_and_b32 v45, 0xffff0000, v112
    v_lshlrev_b32 v46, 16, v113
    v_and_b32 v47, 0xffff0000, v113
    v_lshlrev_b32 v12, 16, v34
    v_and_b32 v13, 0xffff0000, v34
    v_lshlrev_b32 v14, 16, v35
    v_and_b32 v15, 0xffff0000, v35
    v_lshlrev_b32 v48, 16, v114
    v_and_b32 v49, 0xffff0000, v114
    v_lshlrev_b32 v50, 16, v115
    v_and_b32 v51, 0xffff0000, v115
    v_lshlrev_b32 v16, 16, v36
    v_and_b32 v17, 0xffff0000, v36
    v_lshlrev_b32 v18, 16, v37
    v_and_b32 v19, 0xffff0000, v37
    v_lshlrev_b32 v52, 16, v116
    v_and_b32 v53, 0xffff0000, v116
    v_lshlrev_b32 v54, 16, v117
    v_and_b32 v55, 0xffff0000, v117
    v_lshlrev_b32 v20, 16, v38
    v_and_b32 v21, 0xffff0000, v38
    v_lshlrev_b32 v22, 16, v39
    v_and_b32 v23, 0xffff0000, v39
    v_lshlrev_b32 v56, 16, v118
    v_and_b32 v57, 0xffff0000, v118
    v_lshlrev_b32 v58, 16, v119
    v_and_b32 v59, 0xffff0000, v119
    v_lshlrev_b32 v24, 16, v40
    v_and_b32 v25, 0xffff0000, v40
    v_lshlrev_b32 v26, 16, v41
    v_and_b32 v27, 0xffff0000, v41
    v_lshlrev_b32 v60, 16, v120
    v_and_b32 v61, 0xffff0000, v120
    v_lshlrev_b32 v62, 16, v121
    v_and_b32 v63, 0xffff0000, v121
    v_pk_add_f32 v[8:9], v[8:9], v[44:45]
    v_pk_add_f32 v[10:11], v[10:11], v[46:47]
    v_pk_add_f32 v[12:13], v[12:13], v[48:49]
    v_pk_add_f32 v[14:15], v[14:15], v[50:51]
    v_pk_add_f32 v[16:17], v[16:17], v[52:53]
    v_pk_add_f32 v[18:19], v[18:19], v[54:55]
    v_pk_add_f32 v[20:21], v[20:21], v[56:57]
    v_pk_add_f32 v[22:23], v[22:23], v[58:59]
    v_pk_add_f32 v[24:25], v[24:25], v[60:61]
    v_pk_add_f32 v[26:27], v[26:27], v[62:63]
    v_cvt_pk_bf16_f32 v32, v8, v9
    v_cvt_pk_bf16_f32 v33, v10, v11
    v_cvt_pk_bf16_f32 v34, v12, v13
    v_cvt_pk_bf16_f32 v35, v14, v15
    v_cvt_pk_bf16_f32 v36, v16, v17
    v_cvt_pk_bf16_f32 v37, v18, v19
    v_cvt_pk_bf16_f32 v38, v20, v21
    v_cvt_pk_bf16_f32 v39, v22, v23
    v_cvt_pk_bf16_f32 v40, v24, v25
    v_cvt_pk_bf16_f32 v41, v26, v27
    buffer_store_dwordx2 v[32:33], v124, s[48:51], 0 offen offset:0
    buffer_store_dwordx2 v[34:35], v124, s[48:51], 0 offen offset:32
    buffer_store_dwordx2 v[36:37], v124, s[48:51], 0 offen offset:64
    buffer_store_dwordx2 v[38:39], v124, s[48:51], 0 offen offset:96
    buffer_store_dwordx2 v[40:41], v124, s[48:51], 0 offen offset:128
KM_fin:
KM_done:
    s_endpgm
.section .rodata,"a"
.p2align 6
.amdhsa_kernel k1_kernel
  .amdhsa_next_free_vgpr 248
  .amdhsa_next_free_sgpr 102
  .amdhsa_accum_offset 248
  .amdhsa_group_segment_fixed_size 0
  .amdhsa_kernarg_size 96
  .amdhsa_user_sgpr_count 2
  .amdhsa_user_sgpr_kernarg_segment_ptr 1
  .amdhsa_system_sgpr_workgroup_id_x 1
.end_amdhsa_kernel

.section .rodata,"a"
.p2align 6
.amdhsa_kernel km_kernel
  .amdhsa_next_free_vgpr 496
  .amdhsa_next_free_sgpr 102
  .amdhsa_accum_offset 256
  .amdhsa_group_segment_fixed_size 0
  .amdhsa_kernarg_size 96
  .amdhsa_user_sgpr_count 2
  .amdhsa_user_sgpr_kernarg_segment_ptr 1
  .amdhsa_system_sgpr_workgroup_id_x 1
.end_amdhsa_kernel
```
